```python
import torch

def _softmax(x, axis=-1):
    return torch.softmax(x, dim=axis)
def _gelu(x):
    return torch.nn.functional.gelu(x, approximate="tanh")
def _silu(x):
    return torch.nn.functional.silu(x)
def _sigmoid(x):
    return torch.sigmoid(x)
def _layernorm(x, axis=-1, eps=1e-5):
    m = x.mean(dim=axis, keepdim=True)
    v = x.var(dim=axis, keepdim=True, unbiased=False)
    return (x - m) / torch.sqrt(v + eps)
def _scatter_add(tgt, idx, src, axis=0):
    return tgt.clone().index_add_(axis, idx, src)
def _segment_sum(src, seg, n):
    out = torch.zeros((n,) + src.shape[1:], dtype=src.dtype)
    return out.index_add_(0, seg, src)
def _pad(x, pw):
    flat = tuple(v for pair in reversed(pw) for v in pair)
    return torch.nn.functional.pad(x, flat)

kernel_name = 'sequential_preLN__linear_attn_block__mixer_s_mlp__prompt'

def setup_inputs():

    _w = (lambda a: (lambda t: t.to(torch.bfloat16) if t.is_floating_point() else t)(torch.as_tensor(a)))
    def _A_setup():
        B, S, D = 1, 2048, 640
        return {
            "x": _w((lambda *s: torch.randn(*s, dtype=torch.bfloat16) * 0.05)(B, S, D)),
            "wqkv": _w((lambda *s: torch.randn(*s, dtype=torch.bfloat16) * 0.05)(D, 3 * D)),
            "wo": _w((lambda *s: torch.randn(*s, dtype=torch.bfloat16) * 0.05)(D, D)),
        }
    _A_in = _A_setup()

    def _B_setup():
        B, S, D, F = 1, 2048, 640, 1728
        return {
            "x":  _w((lambda *s: torch.randn(*s, dtype=torch.bfloat16) * 0.05)(B, S, D)),
            "w1": _w((lambda *s: torch.randn(*s, dtype=torch.bfloat16) * 3.2)(D, D) * (D ** -0.5)),
            "w2": _w((lambda *s: torch.randn(*s, dtype=torch.bfloat16) * 3.2)(D, D) * (D ** -0.5)),
            "w3": _w((lambda *s: torch.randn(*s, dtype=torch.bfloat16) * 3.2)(D, F) * (D ** -0.5)),
            "w4": _w((lambda *s: torch.randn(*s, dtype=torch.bfloat16) * 3.2)(F, D) * (F ** -0.5)),
        }
    _B_in = _B_setup()

    return {
        "A_x": _A_in["x"],
        "A_wqkv": _A_in["wqkv"],
        "A_wo": _A_in["wo"],
        "B_x": _B_in["x"],
        "B_w1": _B_in["w1"],
        "B_w2": _B_in["w2"],
        "B_w3": _B_in["w3"],
        "B_w4": _B_in["w4"],
    }

def reference(A_x, A_wqkv, A_wo, B_x, B_w1, B_w2, B_w3, B_w4):
    def _A_ref(x, wqkv, wo):
        B, S, D = x.shape
        H = 32; Dh = D // H
        qkv = (lambda x, *d: x.permute(*d))((x @ wqkv).reshape(B, S, 3, H, Dh), 2, 0, 3, 1, 4)
        q, k, v = qkv[0], qkv[1], qkv[2]
        phi = lambda t: torch.where(t > 0, t + 1, torch.exp(t)) + 1e-6
        pq, pk = phi(q), phi(k)
        kv = torch.einsum("bhsd,bhse->bhde", pk, v)
        z = torch.einsum("bhsd->bhd", pk)
        num = torch.einsum("bhqd,bhde->bhqe", pq, kv)
        den = torch.einsum("bhqd,bhd->bhq", pq, z)[..., None] + 1e-6
        o = num / den
        return (lambda x, *d: x.permute(*d))(o, 0, 2, 1, 3).reshape(B, S, D) @ wo

    def _B_ref(x, w1, w2, w3, w4):
        B, S, D = x.shape
        h = _gelu(_layernorm(x, axis=-1) @ w1)
        c = D // 4
        g0 = _pad(h[:, :, 0*c:1*c], ((0, 0), (1, 0), (0, 0)))[:, :S, :]
        g1 = _pad(h[:, :, 1*c:2*c], ((0, 0), (0, 1), (0, 0)))[:, 1:, :]
        g2 = _pad(h[:, :, 2*c:3*c], ((0, 0), (2, 0), (0, 0)))[:, :S, :]
        g3 = _pad(h[:, :, 3*c:   ], ((0, 0), (0, 2), (0, 0)))[:, 2:, :]
        hs = torch.concatenate([g0, g1, g2, g3], axis=-1) @ w2
        x1 = x + hs
        h2 = _gelu(_layernorm(x1, axis=-1) @ w3) @ w4
        return x1 + h2

    x = A_x
    h = x + _A_ref(_layernorm(x, axis=-1), A_wqkv, A_wo)
    h2 = h + _B_ref(_layernorm(h, axis=-1), B_w1, B_w2, B_w3, B_w4)
    return h2
```

```asm
; @launch kernel=k1_kernel grid=(256,1,1) block=(512,1,1) lds=163840
; @launch kernel=kp_kernel grid=(256,1,1) block=(256,1,1) lds=163840
.amdgcn_target "amdgcn-amd-amdhsa--gfx950"
.text
.globl k1_kernel
.p2align 8
.type k1_kernel,@function
k1_kernel:
    s_cmp_ge_u32 s2, 256
    s_cbranch_scc1 K1_END
    s_load_dwordx4 s[4:7], s[0:1], 0
    s_load_dwordx4 s[8:11], s[0:1], 72
    s_load_dwordx8 s[52:59], s[0:1], 32
    s_load_dwordx2 s[60:61], s[0:1], 16
    s_and_b32 s46, s2, 7
    s_lshr_b32 s47, s2, 3
    s_lshr_b32 s40, s47, 4
    s_lshl_b32 s46, s46, 1
    s_add_u32 s40, s40, s46
    s_and_b32 s41, s47, 15
    v_lshrrev_b32 v1, 6, v0
    v_and_b32 v2, 15, v0
    v_bfe_u32 v3, v0, 4, 2
    v_readfirstlane_b32 s42, v1
    v_and_b32 v1, 63, v0
    s_nop 0
    s_cmp_lt_u32 s42, 4
    s_cbranch_scc1 K1_COMPUTE
    s_sub_u32 s42, s42, 4
    v_subrev_u32 v0, 256, v0
    s_mul_i32 s48, s41, 80
    s_xor_b32 s49, s41, 1
    s_mul_i32 s49, s49, 80
    s_lshl_b32 s50, s42, 8
    v_add_u32 v4, s50, v1
    v_add_u32 v4, 0, v4
    v_mul_u32_u24 v5, 4370, v4
    v_lshrrev_b32 v5, 16, v5
    v_mul_u32_u24 v6, 15, v5
    v_sub_u32 v6, v4, v6
    v_and_b32 v7, 1, v5
    v_bfe_u32 v8, v5, 1, 2
    v_lshl_or_b32 v7, v7, 2, v8
    v_and_b32 v5, 0x78, v5
    v_or_b32 v5, v5, v7
    v_mul_u32_u24 v5, 3840, v5
    v_lshl_add_u32 v5, v6, 4, v5
    v_mov_b32 v7, s48
    v_mov_b32 v8, s49
    v_cmp_gt_u32 vcc, 5, v6
    s_nop 1
    v_cndmask_b32 v7, v7, v8, vcc
    v_mov_b32 v8, 1200
    v_cndmask_b32 v8, v8, 0, vcc
    v_add3_u32 v5, v5, v7, v8
    v_mov_b32 v8, 1200
    v_cmp_lt_u32 vcc, 9, v6
    s_nop 1
    v_cndmask_b32 v8, 0, v8, vcc
    v_add_u32 v16, v5, v8
    v_add_u32 v4, s50, v1
    v_add_u32 v4, 64, v4
    v_mul_u32_u24 v5, 4370, v4
    v_lshrrev_b32 v5, 16, v5
    v_mul_u32_u24 v6, 15, v5
    v_sub_u32 v6, v4, v6
    v_and_b32 v7, 1, v5
    v_bfe_u32 v8, v5, 1, 2
    v_lshl_or_b32 v7, v7, 2, v8
    v_and_b32 v5, 0x78, v5
    v_or_b32 v5, v5, v7
    v_mul_u32_u24 v5, 3840, v5
    v_lshl_add_u32 v5, v6, 4, v5
    v_mov_b32 v7, s48
    v_mov_b32 v8, s49
    v_cmp_gt_u32 vcc, 5, v6
    s_nop 1
    v_cndmask_b32 v7, v7, v8, vcc
    v_mov_b32 v8, 1200
    v_cndmask_b32 v8, v8, 0, vcc
    v_add3_u32 v5, v5, v7, v8
    v_mov_b32 v8, 1200
    v_cmp_lt_u32 vcc, 9, v6
    s_nop 1
    v_cndmask_b32 v8, 0, v8, vcc
    v_add_u32 v17, v5, v8
    v_add_u32 v4, s50, v1
    v_add_u32 v4, 128, v4
    v_mul_u32_u24 v5, 4370, v4
    v_lshrrev_b32 v5, 16, v5
    v_mul_u32_u24 v6, 15, v5
    v_sub_u32 v6, v4, v6
    v_and_b32 v7, 1, v5
    v_bfe_u32 v8, v5, 1, 2
    v_lshl_or_b32 v7, v7, 2, v8
    v_and_b32 v5, 0x78, v5
    v_or_b32 v5, v5, v7
    v_mul_u32_u24 v5, 3840, v5
    v_lshl_add_u32 v5, v6, 4, v5
    v_mov_b32 v7, s48
    v_mov_b32 v8, s49
    v_cmp_gt_u32 vcc, 5, v6
    s_nop 1
    v_cndmask_b32 v7, v7, v8, vcc
    v_mov_b32 v8, 1200
    v_cndmask_b32 v8, v8, 0, vcc
    v_add3_u32 v5, v5, v7, v8
    v_mov_b32 v8, 1200
    v_cmp_lt_u32 vcc, 9, v6
    s_nop 1
    v_cndmask_b32 v8, 0, v8, vcc
    v_add_u32 v18, v5, v8
    v_add_u32 v4, s50, v1
    v_add_u32 v4, 192, v4
    v_mul_u32_u24 v5, 4370, v4
    v_lshrrev_b32 v5, 16, v5
    v_mul_u32_u24 v6, 15, v5
    v_sub_u32 v6, v4, v6
    v_and_b32 v7, 1, v5
    v_bfe_u32 v8, v5, 1, 2
    v_lshl_or_b32 v7, v7, 2, v8
    v_and_b32 v5, 0x78, v5
    v_or_b32 v5, v5, v7
    v_mul_u32_u24 v5, 3840, v5
    v_lshl_add_u32 v5, v6, 4, v5
    v_mov_b32 v7, s48
    v_mov_b32 v8, s49
    v_cmp_gt_u32 vcc, 5, v6
    s_nop 1
    v_cndmask_b32 v7, v7, v8, vcc
    v_mov_b32 v8, 1200
    v_cndmask_b32 v8, v8, 0, vcc
    v_add3_u32 v5, v5, v7, v8
    v_mov_b32 v8, 1200
    v_cmp_lt_u32 vcc, 9, v6
    s_nop 1
    v_cndmask_b32 v8, 0, v8, vcc
    v_add_u32 v19, v5, v8
    v_lshrrev_b32 v4, 3, v1
    v_and_b32 v5, 7, v1
    v_xor_b32 v5, v5, v4
    s_lshl_b32 s48, s40, 7
    s_lshl_b32 s49, s42, 5
    s_add_u32 s48, s48, s49
    v_add_u32 v4, s48, v4
    v_mul_u32_u24 v4, 1280, v4
    v_lshl_add_u32 v20, v5, 4, v4
    s_lshl_b32 s43, s42, 12
    s_mul_i32 s51, s2, 6554
    s_lshr_b32 s51, s51, 16
    s_mul_i32 s51, s51, 10
    s_sub_u32 s51, s2, s51
    s_mov_b32 s33, s51
    s_waitcnt lgkmcnt(0)
    s_mov_b32 s12, s4
    s_mov_b32 s13, s5
    s_mov_b32 s14, 2621440
    s_mov_b32 s15, 0x00020000
    s_mov_b32 s16, s6
    s_mov_b32 s17, s7
    s_mov_b32 s18, 2457600
    s_mov_b32 s19, 0x00020000
    s_mov_b32 s28, s8
    s_mov_b32 s29, s9
    s_mov_b32 s30, 256
    s_mov_b32 s31, 0x00020000
    s_lshl_b32 s48, s41, 2
    v_mov_b32 v12, s48
    v_mov_b32 v11, 1
    s_mov_b32 s48, 128
    v_writelane_b32 v12, s48, 1
    s_mov_b32 s50, s40
    s_xor_b32 s32, s40, 1
    s_or_b32 s32, s32, s41
    s_add_u32 s44, s33, 0
    s_sub_u32 s45, s44, 10
    s_cmp_ge_u32 s44, 10
    s_cselect_b32 s45, s45, s44
    s_mul_i32 s44, s45, 245760
    s_lshl_b32 s45, s45, 7
    s_add_u32 m0, s43, 15360
    s_add_u32 s48, s45, 0
    buffer_load_dwordx4 v20, s[12:15], s48 offen lds
    s_add_u32 m0, s43, 0
    s_nop 0
    buffer_load_dwordx4 v16, s[16:19], s44 offen lds
    s_add_u32 m0, s43, 16384
    s_add_u32 s48, s45, 10240
    buffer_load_dwordx4 v20, s[12:15], s48 offen lds
    s_add_u32 m0, s43, 1024
    s_nop 0
    buffer_load_dwordx4 v17, s[16:19], s44 offen lds
    s_add_u32 m0, s43, 17408
    s_add_u32 s48, s45, 20480
    buffer_load_dwordx4 v20, s[12:15], s48 offen lds
    s_add_u32 m0, s43, 2048
    s_nop 0
    buffer_load_dwordx4 v18, s[16:19], s44 offen lds
    s_add_u32 m0, s43, 18432
    s_add_u32 s48, s45, 30720
    buffer_load_dwordx4 v20, s[12:15], s48 offen lds
    s_cmp_eq_u32 s42, 3
    s_cbranch_scc1 K1_G0
    s_add_u32 m0, s43, 3072
    s_nop 0
    buffer_load_dwordx4 v19, s[16:19], s44 offen lds
K1_G0:
    s_add_u32 s44, s33, 1
    s_sub_u32 s45, s44, 10
    s_cmp_ge_u32 s44, 10
    s_cselect_b32 s45, s45, s44
    s_mul_i32 s44, s45, 245760
    s_lshl_b32 s45, s45, 7
    s_add_u32 m0, s43, 47104
    s_add_u32 s48, s45, 0
    buffer_load_dwordx4 v20, s[12:15], s48 offen lds
    s_add_u32 m0, s43, 31744
    s_nop 0
    buffer_load_dwordx4 v16, s[16:19], s44 offen lds
    s_add_u32 m0, s43, 48128
    s_add_u32 s48, s45, 10240
    buffer_load_dwordx4 v20, s[12:15], s48 offen lds
    s_add_u32 m0, s43, 32768
    s_nop 0
    buffer_load_dwordx4 v17, s[16:19], s44 offen lds
    s_add_u32 m0, s43, 49152
    s_add_u32 s48, s45, 20480
    buffer_load_dwordx4 v20, s[12:15], s48 offen lds
    s_add_u32 m0, s43, 33792
    s_nop 0
    buffer_load_dwordx4 v18, s[16:19], s44 offen lds
    s_add_u32 m0, s43, 50176
    s_add_u32 s48, s45, 30720
    buffer_load_dwordx4 v20, s[12:15], s48 offen lds
    s_cmp_eq_u32 s42, 3
    s_cbranch_scc1 K1_G1
    s_add_u32 m0, s43, 34816
    s_nop 0
    buffer_load_dwordx4 v19, s[16:19], s44 offen lds
K1_G1:
    s_add_u32 s20, s10, 18219008
    s_addc_u32 s21, s11, 0
    s_mov_b32 s22, 8192
    s_mov_b32 s23, 0x00020000
    s_add_u32 s92, s10, 18284544
    s_addc_u32 s93, s11, 0
    s_mov_b32 s94, 9472
    s_mov_b32 s95, 0x00020000
    s_mul_i32 s48, s41, 3360
    s_add_u32 s24, s10, s48
    s_addc_u32 s25, s11, 0
    s_add_u32 s24, s24, 17825792
    s_addc_u32 s25, s25, 0
    s_mov_b32 s26, 3360
    s_mov_b32 s27, 0x00020000
    s_waitcnt vmcnt(7)
    s_barrier
    s_cmp_lg_u32 s42, 0
    s_cbranch_scc1 K1_NOZ
    s_mov_b64 exec, 31
    s_lshl_b32 s48, s2, 2
    v_lshl_add_u32 v8, v0, 10, s48
    v_mov_b32 v4, 0
    buffer_store_dword v4, v8, s[20:23], 0 offen
    s_mov_b64 exec, -1
    v_lshlrev_b32 v8, 4, v0
    v_mov_b32 v4, 0
    v_mov_b32 v5, 0
    v_mov_b32 v6, 0
    v_mov_b32 v7, 0
    s_cmp_lg_u32 s50, 0
    s_cbranch_scc1 K1_NOZ1
    buffer_store_dwordx4 v[4:7], v8, s[24:27], 0 offen offset:0 sc1
    buffer_store_dwordx4 v[4:7], v8, s[24:27], 0 offen offset:1024 sc1
    buffer_store_dwordx4 v[4:7], v8, s[24:27], 0 offen offset:2048 sc1
    buffer_store_dwordx4 v[4:7], v8, s[24:27], 0 offen offset:3072 sc1
    s_nop 1
K1_NOZ1:
    s_cmp_lg_u32 s32, 0
    s_cbranch_scc1 K1_NOZ
    s_mov_b32 s48, 0
    buffer_store_dwordx4 v[4:7], v8, s[92:95], s48 offen sc1
    s_mov_b32 s48, 1024
    buffer_store_dwordx4 v[4:7], v8, s[92:95], s48 offen sc1
    s_mov_b32 s48, 2048
    buffer_store_dwordx4 v[4:7], v8, s[92:95], s48 offen sc1
    s_mov_b32 s48, 3072
    buffer_store_dwordx4 v[4:7], v8, s[92:95], s48 offen sc1
    s_mov_b32 s48, 4096
    buffer_store_dwordx4 v[4:7], v8, s[92:95], s48 offen sc1
    s_mov_b32 s48, 5120
    buffer_store_dwordx4 v[4:7], v8, s[92:95], s48 offen sc1
    s_mov_b32 s48, 6144
    buffer_store_dwordx4 v[4:7], v8, s[92:95], s48 offen sc1
    s_mov_b32 s48, 7168
    buffer_store_dwordx4 v[4:7], v8, s[92:95], s48 offen sc1
    s_mov_b32 s48, 8192
    buffer_store_dwordx4 v[4:7], v8, s[92:95], s48 offen sc1
    s_mov_b32 s48, 9216
    buffer_store_dwordx4 v[4:7], v8, s[92:95], s48 offen sc1
    s_nop 1
K1_NOZ:
    s_add_u32 s44, s33, 2
    s_sub_u32 s45, s44, 10
    s_cmp_ge_u32 s44, 10
    s_cselect_b32 s45, s45, s44
    s_mul_i32 s44, s45, 245760
    s_lshl_b32 s45, s45, 7
    s_add_u32 m0, s43, 78848
    s_add_u32 s48, s45, 0
    buffer_load_dwordx4 v20, s[12:15], s48 offen lds
    s_add_u32 m0, s43, 63488
    s_nop 0
    buffer_load_dwordx4 v16, s[16:19], s44 offen lds
    s_add_u32 m0, s43, 79872
    s_add_u32 s48, s45, 10240
    buffer_load_dwordx4 v20, s[12:15], s48 offen lds
    s_add_u32 m0, s43, 64512
    s_nop 0
    buffer_load_dwordx4 v17, s[16:19], s44 offen lds
    s_add_u32 m0, s43, 80896
    s_add_u32 s48, s45, 20480
    buffer_load_dwordx4 v20, s[12:15], s48 offen lds
    s_add_u32 m0, s43, 65536
    s_nop 0
    buffer_load_dwordx4 v18, s[16:19], s44 offen lds
    s_add_u32 m0, s43, 81920
    s_add_u32 s48, s45, 30720
    buffer_load_dwordx4 v20, s[12:15], s48 offen lds
    s_cmp_eq_u32 s42, 3
    s_cbranch_scc1 K1_G2
    s_add_u32 m0, s43, 66560
    s_nop 0
    buffer_load_dwordx4 v19, s[16:19], s44 offen lds
K1_G2:
    s_waitcnt vmcnt(7)
    s_barrier
    s_add_u32 s44, s33, 3
    s_sub_u32 s45, s44, 10
    s_cmp_ge_u32 s44, 10
    s_cselect_b32 s45, s45, s44
    s_mul_i32 s44, s45, 245760
    s_lshl_b32 s45, s45, 7
    s_add_u32 m0, s43, 110592
    s_add_u32 s48, s45, 0
    buffer_load_dwordx4 v20, s[12:15], s48 offen lds
    s_add_u32 m0, s43, 95232
    s_nop 0
    buffer_load_dwordx4 v16, s[16:19], s44 offen lds
    s_add_u32 m0, s43, 111616
    s_add_u32 s48, s45, 10240
    buffer_load_dwordx4 v20, s[12:15], s48 offen lds
    s_add_u32 m0, s43, 96256
    s_nop 0
    buffer_load_dwordx4 v17, s[16:19], s44 offen lds
    s_add_u32 m0, s43, 112640
    s_add_u32 s48, s45, 20480
    buffer_load_dwordx4 v20, s[12:15], s48 offen lds
    s_add_u32 m0, s43, 97280
    s_nop 0
    buffer_load_dwordx4 v18, s[16:19], s44 offen lds
    s_add_u32 m0, s43, 113664
    s_add_u32 s48, s45, 30720
    buffer_load_dwordx4 v20, s[12:15], s48 offen lds
    s_cmp_eq_u32 s42, 3
    s_cbranch_scc1 K1_G3
    s_add_u32 m0, s43, 98304
    s_nop 0
    buffer_load_dwordx4 v19, s[16:19], s44 offen lds
K1_G3:
    s_waitcnt vmcnt(7)
    s_barrier
    s_add_u32 s44, s33, 4
    s_sub_u32 s45, s44, 10
    s_cmp_ge_u32 s44, 10
    s_cselect_b32 s45, s45, s44
    s_mul_i32 s44, s45, 245760
    s_lshl_b32 s45, s45, 7
    s_add_u32 m0, s43, 15360
    s_add_u32 s48, s45, 0
    buffer_load_dwordx4 v20, s[12:15], s48 offen lds
    s_add_u32 m0, s43, 0
    s_nop 0
    buffer_load_dwordx4 v16, s[16:19], s44 offen lds
    s_add_u32 m0, s43, 16384
    s_add_u32 s48, s45, 10240
    buffer_load_dwordx4 v20, s[12:15], s48 offen lds
    s_add_u32 m0, s43, 1024
    s_nop 0
    buffer_load_dwordx4 v17, s[16:19], s44 offen lds
    s_add_u32 m0, s43, 17408
    s_add_u32 s48, s45, 20480
    buffer_load_dwordx4 v20, s[12:15], s48 offen lds
    s_add_u32 m0, s43, 2048
    s_nop 0
    buffer_load_dwordx4 v18, s[16:19], s44 offen lds
    s_add_u32 m0, s43, 18432
    s_add_u32 s48, s45, 30720
    buffer_load_dwordx4 v20, s[12:15], s48 offen lds
    s_cmp_eq_u32 s42, 3
    s_cbranch_scc1 K1_G4
    s_add_u32 m0, s43, 3072
    s_nop 0
    buffer_load_dwordx4 v19, s[16:19], s44 offen lds
K1_G4:
    s_waitcnt vmcnt(7)
    s_barrier
    s_add_u32 s44, s33, 5
    s_sub_u32 s45, s44, 10
    s_cmp_ge_u32 s44, 10
    s_cselect_b32 s45, s45, s44
    s_mul_i32 s44, s45, 245760
    s_lshl_b32 s45, s45, 7
    s_add_u32 m0, s43, 47104
    s_add_u32 s48, s45, 0
    buffer_load_dwordx4 v20, s[12:15], s48 offen lds
    s_add_u32 m0, s43, 31744
    s_nop 0
    buffer_load_dwordx4 v16, s[16:19], s44 offen lds
    s_add_u32 m0, s43, 48128
    s_add_u32 s48, s45, 10240
    buffer_load_dwordx4 v20, s[12:15], s48 offen lds
    s_add_u32 m0, s43, 32768
    s_nop 0
    buffer_load_dwordx4 v17, s[16:19], s44 offen lds
    s_add_u32 m0, s43, 49152
    s_add_u32 s48, s45, 20480
    buffer_load_dwordx4 v20, s[12:15], s48 offen lds
    s_add_u32 m0, s43, 33792
    s_nop 0
    buffer_load_dwordx4 v18, s[16:19], s44 offen lds
    s_add_u32 m0, s43, 50176
    s_add_u32 s48, s45, 30720
    buffer_load_dwordx4 v20, s[12:15], s48 offen lds
    s_cmp_eq_u32 s42, 3
    s_cbranch_scc1 K1_G5
    s_add_u32 m0, s43, 34816
    s_nop 0
    buffer_load_dwordx4 v19, s[16:19], s44 offen lds
K1_G5:
    s_cmp_lg_u32 s42, 0
    s_cbranch_scc1 K1_NOP
    s_cmp_eq_u32 s50, 0
    s_cselect_b32 s48, 1, 0
    s_cmp_eq_u32 s32, 0
    s_cselect_b32 s49, 2, 0
    s_or_b32 s48, s48, s49
    s_cmp_eq_u32 s48, 0
    s_cbranch_scc1 K1_NOP
    v_mov_b32 v13, 1
    s_mov_b32 exec_lo, s48
    s_mov_b32 exec_hi, 0
    buffer_store_dword v13, v12, s[28:31], 0 offen offset:64 sc1
    s_mov_b64 exec, -1
    s_nop 1
K1_NOP:
    s_waitcnt vmcnt(7)
    s_barrier
    s_add_u32 s44, s33, 6
    s_sub_u32 s45, s44, 10
    s_cmp_ge_u32 s44, 10
    s_cselect_b32 s45, s45, s44
    s_mul_i32 s44, s45, 245760
    s_lshl_b32 s45, s45, 7
    s_add_u32 m0, s43, 78848
    s_add_u32 s48, s45, 0
    buffer_load_dwordx4 v20, s[12:15], s48 offen lds
    s_add_u32 m0, s43, 63488
    s_nop 0
    buffer_load_dwordx4 v16, s[16:19], s44 offen lds
    s_add_u32 m0, s43, 79872
    s_add_u32 s48, s45, 10240
    buffer_load_dwordx4 v20, s[12:15], s48 offen lds
    s_add_u32 m0, s43, 64512
    s_nop 0
    buffer_load_dwordx4 v17, s[16:19], s44 offen lds
    s_add_u32 m0, s43, 80896
    s_add_u32 s48, s45, 20480
    buffer_load_dwordx4 v20, s[12:15], s48 offen lds
    s_add_u32 m0, s43, 65536
    s_nop 0
    buffer_load_dwordx4 v18, s[16:19], s44 offen lds
    s_add_u32 m0, s43, 81920
    s_add_u32 s48, s45, 30720
    buffer_load_dwordx4 v20, s[12:15], s48 offen lds
    s_cmp_eq_u32 s42, 3
    s_cbranch_scc1 K1_G6
    s_add_u32 m0, s43, 66560
    s_nop 0
    buffer_load_dwordx4 v19, s[16:19], s44 offen lds
K1_G6:
    s_waitcnt vmcnt(7)
    s_barrier
    s_add_u32 s44, s33, 7
    s_sub_u32 s45, s44, 10
    s_cmp_ge_u32 s44, 10
    s_cselect_b32 s45, s45, s44
    s_mul_i32 s44, s45, 245760
    s_lshl_b32 s45, s45, 7
    s_add_u32 m0, s43, 110592
    s_add_u32 s48, s45, 0
    buffer_load_dwordx4 v20, s[12:15], s48 offen lds
    s_add_u32 m0, s43, 95232
    s_nop 0
    buffer_load_dwordx4 v16, s[16:19], s44 offen lds
    s_add_u32 m0, s43, 111616
    s_add_u32 s48, s45, 10240
    buffer_load_dwordx4 v20, s[12:15], s48 offen lds
    s_add_u32 m0, s43, 96256
    s_nop 0
    buffer_load_dwordx4 v17, s[16:19], s44 offen lds
    s_add_u32 m0, s43, 112640
    s_add_u32 s48, s45, 20480
    buffer_load_dwordx4 v20, s[12:15], s48 offen lds
    s_add_u32 m0, s43, 97280
    s_nop 0
    buffer_load_dwordx4 v18, s[16:19], s44 offen lds
    s_add_u32 m0, s43, 113664
    s_add_u32 s48, s45, 30720
    buffer_load_dwordx4 v20, s[12:15], s48 offen lds
    s_cmp_eq_u32 s42, 3
    s_cbranch_scc1 K1_G7
    s_add_u32 m0, s43, 98304
    s_nop 0
    buffer_load_dwordx4 v19, s[16:19], s44 offen lds
K1_G7:
    s_waitcnt vmcnt(7)
    s_barrier
    s_add_u32 s44, s33, 8
    s_sub_u32 s45, s44, 10
    s_cmp_ge_u32 s44, 10
    s_cselect_b32 s45, s45, s44
    s_mul_i32 s44, s45, 245760
    s_lshl_b32 s45, s45, 7
    s_add_u32 m0, s43, 15360
    s_add_u32 s48, s45, 0
    buffer_load_dwordx4 v20, s[12:15], s48 offen lds
    s_add_u32 m0, s43, 0
    s_nop 0
    buffer_load_dwordx4 v16, s[16:19], s44 offen lds
    s_add_u32 m0, s43, 16384
    s_add_u32 s48, s45, 10240
    buffer_load_dwordx4 v20, s[12:15], s48 offen lds
    s_add_u32 m0, s43, 1024
    s_nop 0
    buffer_load_dwordx4 v17, s[16:19], s44 offen lds
    s_add_u32 m0, s43, 17408
    s_add_u32 s48, s45, 20480
    buffer_load_dwordx4 v20, s[12:15], s48 offen lds
    s_add_u32 m0, s43, 2048
    s_nop 0
    buffer_load_dwordx4 v18, s[16:19], s44 offen lds
    s_add_u32 m0, s43, 18432
    s_add_u32 s48, s45, 30720
    buffer_load_dwordx4 v20, s[12:15], s48 offen lds
    s_cmp_eq_u32 s42, 3
    s_cbranch_scc1 K1_G8
    s_add_u32 m0, s43, 3072
    s_nop 0
    buffer_load_dwordx4 v19, s[16:19], s44 offen lds
K1_G8:
    s_add_u32 s64, s10, 20971520
    s_addc_u32 s65, s11, 0
    s_mov_b32 s66, 6881280
    s_mov_b32 s67, 0x00020000
    v_bfe_u32 v4, v0, 3, 2
    v_bfe_u32 v5, v0, 5, 1
    v_and_b32 v6, 7, v0
    v_lshrrev_b32 v7, 1, v4
    v_lshlrev_b32 v7, 1, v7
    v_xor_b32 v6, v6, v7
    v_lshlrev_b32 v6, 4, v6
    v_xor_b32 v7, 64, v6
    s_lshl_b32 s48, s2, 2
    s_add_u32 s48, s48, s42
    s_mov_b32 s34, 0x7f000000
    s_mov_b32 s49, 1280
    s_mov_b32 s51, 40
    s_cmp_ge_u32 s48, 1140
    s_cbranch_scc1 K1_Q0_W4
    s_cmp_ge_u32 s48, 600
    s_cbranch_scc1 K1_Q0_W3
    s_mul_i32 s62, s48, 328
    s_lshr_b32 s62, s62, 16
    s_mul_i32 s63, s62, 200
    s_sub_u32 s48, s48, s63
    s_mul_i32 s63, s62, 800
    s_cmp_eq_u32 s62, 1
    s_cselect_b32 s36, s52, s54
    s_cselect_b32 s37, s53, s55
    s_cmp_eq_u32 s62, 0
    s_cselect_b32 s36, s60, s36
    s_cselect_b32 s37, s61, s37
    s_mov_b32 s38, 819200
    s_mov_b32 s68, 6554
    s_mov_b32 s69, 10
    s_branch K1_Q0_DIV
K1_Q0_W3:
    s_sub_u32 s48, s48, 600
    s_mov_b32 s63, 2400
    s_mov_b32 s36, s56
    s_mov_b32 s37, s57
    s_mov_b32 s38, 2211840
    s_mov_b32 s49, 3456
    s_mov_b32 s51, 108
    s_mov_b32 s68, 2428
    s_mov_b32 s69, 27
    s_mov_b32 s62, 3
    s_branch K1_Q0_DIV
K1_Q0_W4:
    s_sub_u32 s48, s48, 1140
    s_mov_b32 s63, 4560
    s_mov_b32 s36, s58
    s_mov_b32 s37, s59
    s_mov_b32 s38, 2211840
    s_mov_b32 s68, 6554
    s_mov_b32 s69, 10
    s_mov_b32 s62, 4
K1_Q0_DIV:
    s_mov_b32 s39, 0x00020000
    s_mul_i32 s68, s48, s68
    s_lshr_b32 s68, s68, 16
    s_mul_i32 s69, s68, s69
    s_sub_u32 s69, s48, s69
    s_mul_i32 s48, s68, s51
    s_lshl_b32 s51, s69, 2
    s_add_u32 s48, s48, s51
    s_add_u32 s48, s48, s63
    s_lshl_b32 s46, s48, 10
    s_lshl_b32 s48, s69, 8
    s_add_u32 s51, s48, 2560
    s_cmp_eq_u32 s62, 3
    s_cselect_b32 s51, s51, 0x7f000000
    s_cmp_eq_u32 s62, 1
    s_cselect_b32 s34, s48, s51
    s_cmp_eq_u32 s62, 0
    s_cbranch_scc1 K1_Q0_WO
    s_lshl_b32 s68, s68, 5
    s_mov_b32 s48, 4
    s_mov_b32 s51, 1
    s_mov_b32 s63, 8
    s_branch K1_Q0_MAP
K1_Q0_WO:
    s_mul_i32 s62, s68, 52429
    s_lshr_b32 s62, s62, 18
    s_mul_i32 s63, s62, 5
    s_sub_u32 s63, s68, s63
    s_mul_i32 s68, s62, 160
    s_mul_i32 s62, s63, 40
    s_cmp_eq_u32 s63, 4
    s_cselect_b32 s62, 16, s62
    s_cselect_b32 s48, 80, 20
    s_cselect_b32 s51, 20, 1
    s_cselect_b32 s63, 1, 4
    s_add_u32 s68, s68, s62
K1_Q0_MAP:
K1_Q0_SKIP:
    s_lshl_b32 s48, s2, 2
    s_add_u32 s48, s48, s42
    s_mov_b32 s35, 0x7f000000
    s_add_u32 s48, s48, 1024
    s_cmp_ge_u32 s48, 1680
    s_cbranch_scc1 K1_Q1_SKIP
    s_mov_b32 s49, 1280
    s_mov_b32 s51, 40
    s_cmp_ge_u32 s48, 1140
    s_cbranch_scc1 K1_Q1_W4
    s_cmp_ge_u32 s48, 600
    s_cbranch_scc1 K1_Q1_W3
    s_mul_i32 s62, s48, 328
    s_lshr_b32 s62, s62, 16
    s_mul_i32 s63, s62, 200
    s_sub_u32 s48, s48, s63
    s_mul_i32 s63, s62, 800
    s_cmp_eq_u32 s62, 1
    s_cselect_b32 s36, s52, s54
    s_cselect_b32 s37, s53, s55
    s_cmp_eq_u32 s62, 0
    s_cselect_b32 s36, s60, s36
    s_cselect_b32 s37, s61, s37
    s_mov_b32 s38, 819200
    s_mov_b32 s68, 6554
    s_mov_b32 s69, 10
    s_branch K1_Q1_DIV
K1_Q1_W3:
    s_sub_u32 s48, s48, 600
    s_mov_b32 s63, 2400
    s_mov_b32 s36, s56
    s_mov_b32 s37, s57
    s_mov_b32 s38, 2211840
    s_mov_b32 s49, 3456
    s_mov_b32 s51, 108
    s_mov_b32 s68, 2428
    s_mov_b32 s69, 27
    s_mov_b32 s62, 3
    s_branch K1_Q1_DIV
K1_Q1_W4:
    s_sub_u32 s48, s48, 1140
    s_mov_b32 s63, 4560
    s_mov_b32 s36, s58
    s_mov_b32 s37, s59
    s_mov_b32 s38, 2211840
    s_mov_b32 s68, 6554
    s_mov_b32 s69, 10
    s_mov_b32 s62, 4
K1_Q1_DIV:
    s_mov_b32 s39, 0x00020000
    s_mul_i32 s68, s48, s68
    s_lshr_b32 s68, s68, 16
    s_mul_i32 s69, s68, s69
    s_sub_u32 s69, s48, s69
    s_mul_i32 s48, s68, s51
    s_lshl_b32 s51, s69, 2
    s_add_u32 s48, s48, s51
    s_add_u32 s48, s48, s63
    s_lshl_b32 s47, s48, 10
    s_lshl_b32 s48, s69, 8
    s_add_u32 s51, s48, 2560
    s_cmp_eq_u32 s62, 3
    s_cselect_b32 s51, s51, 0x7f000000
    s_cmp_eq_u32 s62, 1
    s_cselect_b32 s35, s48, s51
    s_cmp_eq_u32 s62, 0
    s_cbranch_scc1 K1_Q1_WO
    s_lshl_b32 s68, s68, 5
    s_mov_b32 s48, 4
    s_mov_b32 s51, 1
    s_mov_b32 s63, 8
    s_branch K1_Q1_MAP
K1_Q1_WO:
    s_mul_i32 s62, s68, 52429
    s_lshr_b32 s62, s62, 18
    s_mul_i32 s63, s62, 5
    s_sub_u32 s63, s68, s63
    s_mul_i32 s68, s62, 160
    s_mul_i32 s62, s63, 40
    s_cmp_eq_u32 s63, 4
    s_cselect_b32 s62, 16, s62
    s_cselect_b32 s48, 80, 20
    s_cselect_b32 s51, 20, 1
    s_cselect_b32 s63, 1, 4
    s_add_u32 s68, s68, s62
K1_Q1_MAP:
K1_Q1_SKIP:
    s_waitcnt vmcnt(7)
    s_barrier
    s_add_u32 s44, s33, 9
    s_sub_u32 s45, s44, 10
    s_cmp_ge_u32 s44, 10
    s_cselect_b32 s45, s45, s44
    s_mul_i32 s44, s45, 245760
    s_lshl_b32 s45, s45, 7
    s_add_u32 m0, s43, 47104
    s_add_u32 s48, s45, 0
    buffer_load_dwordx4 v20, s[12:15], s48 offen lds
    s_add_u32 m0, s43, 31744
    s_nop 0
    buffer_load_dwordx4 v16, s[16:19], s44 offen lds
    s_add_u32 m0, s43, 48128
    s_add_u32 s48, s45, 10240
    buffer_load_dwordx4 v20, s[12:15], s48 offen lds
    s_add_u32 m0, s43, 32768
    s_nop 0
    buffer_load_dwordx4 v17, s[16:19], s44 offen lds
    s_add_u32 m0, s43, 49152
    s_add_u32 s48, s45, 20480
    buffer_load_dwordx4 v20, s[12:15], s48 offen lds
    s_add_u32 m0, s43, 33792
    s_nop 0
    buffer_load_dwordx4 v18, s[16:19], s44 offen lds
    s_add_u32 m0, s43, 50176
    s_add_u32 s48, s45, 30720
    buffer_load_dwordx4 v20, s[12:15], s48 offen lds
    s_cmp_eq_u32 s42, 3
    s_cbranch_scc1 K1_G9
    s_add_u32 m0, s43, 34816
    s_nop 0
    buffer_load_dwordx4 v19, s[16:19], s44 offen lds
K1_G9:
    s_waitcnt vmcnt(7)
    s_barrier
    s_waitcnt vmcnt(0)
    s_barrier
    s_barrier
    s_barrier
    v_bfe_u32 v4, v0, 2, 2
    v_lshrrev_b32 v5, 1, v4
    v_and_b32 v6, 1, v3
    v_lshl_or_b32 v5, v6, 1, v5
    v_lshl_add_u32 v4, v3, 3, v4
    v_lshlrev_b32 v4, 7, v4
    v_and_b32 v6, 3, v0
    v_lshl_add_u32 v4, v6, 3, v4
    s_lshl_b32 s62, s42, 13
    s_add_u32 s62, s62, 126976
    v_add_u32 v4, s62, v4
    v_xor_b32 v6, 0, v5
    v_lshl_add_u32 v7, v6, 5, v4
    v_xor_b32 v6, 1, v5
    v_lshl_add_u32 v8, v6, 5, v4
    v_xor_b32 v6, 2, v5
    v_lshl_add_u32 v9, v6, 5, v4
    v_xor_b32 v6, 3, v5
    v_lshl_add_u32 v10, v6, 5, v4
    ds_read_b64_tr_b16 a[0:1], v7 offset:0
    ds_read_b64_tr_b16 a[2:3], v7 offset:512
    ds_read_b64_tr_b16 a[4:5], v8 offset:0
    ds_read_b64_tr_b16 a[6:7], v8 offset:512
    ds_read_b64_tr_b16 a[8:9], v9 offset:0
    ds_read_b64_tr_b16 a[10:11], v9 offset:512
    ds_read_b64_tr_b16 a[12:13], v10 offset:0
    ds_read_b64_tr_b16 a[14:15], v10 offset:512
    ds_read_b64_tr_b16 a[16:17], v7 offset:4096
    ds_read_b64_tr_b16 a[18:19], v7 offset:4608
    ds_read_b64_tr_b16 a[20:21], v8 offset:4096
    ds_read_b64_tr_b16 a[22:23], v8 offset:4608
    ds_read_b64_tr_b16 a[24:25], v9 offset:4096
    ds_read_b64_tr_b16 a[26:27], v9 offset:4608
    ds_read_b64_tr_b16 a[28:29], v10 offset:4096
    ds_read_b64_tr_b16 a[30:31], v10 offset:4608
    s_waitcnt lgkmcnt(0)
    v_lshlrev_b32 v4, 4, v1
    buffer_store_dwordx4 a[0:3], v4, s[64:67], s46 offen offset:0 sc1
    buffer_store_dwordx4 a[4:7], v4, s[64:67], s46 offen offset:1024 sc1
    buffer_store_dwordx4 a[8:11], v4, s[64:67], s46 offen offset:2048 sc1
    buffer_store_dwordx4 a[12:15], v4, s[64:67], s46 offen offset:3072 sc1
    s_cmp_ge_u32 s2, 164
    s_cbranch_scc1 K1_RS_SKIP
    buffer_store_dwordx4 a[16:19], v4, s[64:67], s47 offen offset:0 sc1
    buffer_store_dwordx4 a[20:23], v4, s[64:67], s47 offen offset:1024 sc1
    buffer_store_dwordx4 a[24:27], v4, s[64:67], s47 offen offset:2048 sc1
    buffer_store_dwordx4 a[28:31], v4, s[64:67], s47 offen offset:3072 sc1
K1_RS_SKIP:
    v_mov_b32 v14, 192
    buffer_load_dword v15, v14, s[28:31], 0 offen sc1
    v_mov_b32 v16, 0x3f803f80
    v_mov_b32 v17, 0x3f803f80
    v_mov_b32 v18, 0x3f803f80
    v_mov_b32 v19, 0x3f803f80
    s_nop 1
    v_mfma_f32_16x16x32_bf16 v[20:23], v[16:19], a[0:3], 0
    v_mfma_f32_16x16x32_bf16 v[24:27], v[16:19], a[4:7], 0
    v_mfma_f32_16x16x32_bf16 v[28:31], v[16:19], a[8:11], 0
    v_mfma_f32_16x16x32_bf16 v[32:35], v[16:19], a[12:15], 0
    v_mfma_f32_16x16x32_bf16 v[36:39], v[16:19], a[16:19], 0
    v_mfma_f32_16x16x32_bf16 v[40:43], v[16:19], a[20:23], 0
    v_mfma_f32_16x16x32_bf16 v[44:47], v[16:19], a[24:27], 0
    v_mfma_f32_16x16x32_bf16 v[48:51], v[16:19], a[28:31], 0
    v_lshlrev_b32 v4, 2, v2
    s_mov_b32 s58, 0
    s_nop 5
K1_POLL2:
    s_waitcnt vmcnt(0)
    v_readfirstlane_b32 s48, v15
    s_nop 1
    s_cmp_lg_u32 s48, 0
    s_cbranch_scc1 K1_GO2
    s_add_u32 s58, s58, 1
    s_cmp_gt_u32 s58, 0x100000
    s_cbranch_scc1 K1_GO2
    s_sleep 1
    buffer_load_dword v15, v14, s[28:31], 0 offen sc1
    s_branch K1_POLL2
    s_nop 1
K1_GO2:
    s_mov_b32 exec_lo, 0xffff
    s_mov_b32 exec_hi, 0x0
    buffer_atomic_add_f32 v20, v4, s[92:95], s34 offen offset:0
    buffer_atomic_add_f32 v24, v4, s[92:95], s34 offen offset:64
    buffer_atomic_add_f32 v28, v4, s[92:95], s34 offen offset:128
    buffer_atomic_add_f32 v32, v4, s[92:95], s34 offen offset:192
    buffer_atomic_add_f32 v36, v4, s[92:95], s35 offen offset:0
    buffer_atomic_add_f32 v40, v4, s[92:95], s35 offen offset:64
    buffer_atomic_add_f32 v44, v4, s[92:95], s35 offen offset:128
    buffer_atomic_add_f32 v48, v4, s[92:95], s35 offen offset:192
    s_mov_b64 exec, -1
    s_endpgm
    s_nop 1
K1_COMPUTE:
    v_bfe_u32 v4, v0, 2, 2
    v_and_b32 v5, 3, v0
    v_lshlrev_b32 v6, 2, v3
    v_add_u32 v6, v6, v4
    v_mul_u32_u24 v6, 480, v6
    v_lshl_add_u32 v16, v5, 3, v6
    v_and_b32 v4, 7, v2
    v_xor_b32 v4, v4, v3
    v_lshlrev_b32 v4, 4, v4
    v_lshl_add_u32 v4, v2, 7, v4
    s_lshl_b32 s48, s42, 12
    s_add_u32 s48, s48, 15360
    v_add_u32 v17, s48, v4
    v_xor_b32 v18, 64, v17
    v_add_u32 v19, 2048, v17
    v_add_u32 v20, 2048, v18
    v_mov_b32 v32, 0x3f803f80
    v_mov_b32 v33, 0x3f803f80
    v_mov_b32 v34, 0x3f803f80
    v_mov_b32 v35, 0x3f803f80
    s_lshl_b32 s48, s42, 6
    s_cmp_ge_u32 s42, 2
    s_cselect_b32 s49, 16, 0
    s_sub_u32 s48, s48, s49
    s_cmp_eq_u32 s42, 1
    s_cselect_b32 s49, 16, 32
    s_add_u32 s49, s48, s49
    v_add_u32 v21, s48, v16
    v_add_u32 v22, s49, v16
    s_waitcnt lgkmcnt(0)
    s_add_u32 s64, s10, 20971520
    s_addc_u32 s65, s11, 0
    s_mov_b32 s66, 6881280
    s_mov_b32 s67, 0x00020000
    v_bfe_u32 v4, v0, 3, 2
    v_bfe_u32 v5, v0, 5, 1
    v_and_b32 v6, 7, v0
    v_lshrrev_b32 v7, 1, v4
    v_lshlrev_b32 v7, 1, v7
    v_xor_b32 v6, v6, v7
    v_lshlrev_b32 v6, 4, v6
    v_xor_b32 v7, 64, v6
    s_lshl_b32 s48, s2, 2
    s_add_u32 s48, s48, s42
    s_mov_b32 s34, 0x7f000000
    s_mov_b32 s49, 1280
    s_mov_b32 s51, 40
    s_cmp_ge_u32 s48, 1140
    s_cbranch_scc1 K1_R0_W4
    s_cmp_ge_u32 s48, 600
    s_cbranch_scc1 K1_R0_W3
    s_mul_i32 s62, s48, 328
    s_lshr_b32 s62, s62, 16
    s_mul_i32 s63, s62, 200
    s_sub_u32 s48, s48, s63
    s_mul_i32 s63, s62, 800
    s_cmp_eq_u32 s62, 1
    s_cselect_b32 s36, s52, s54
    s_cselect_b32 s37, s53, s55
    s_cmp_eq_u32 s62, 0
    s_cselect_b32 s36, s60, s36
    s_cselect_b32 s37, s61, s37
    s_mov_b32 s38, 819200
    s_mov_b32 s68, 6554
    s_mov_b32 s69, 10
    s_branch K1_R0_DIV
K1_R0_W3:
    s_sub_u32 s48, s48, 600
    s_mov_b32 s63, 2400
    s_mov_b32 s36, s56
    s_mov_b32 s37, s57
    s_mov_b32 s38, 2211840
    s_mov_b32 s49, 3456
    s_mov_b32 s51, 108
    s_mov_b32 s68, 2428
    s_mov_b32 s69, 27
    s_mov_b32 s62, 3
    s_branch K1_R0_DIV
K1_R0_W4:
    s_sub_u32 s48, s48, 1140
    s_mov_b32 s63, 4560
    s_mov_b32 s36, s58
    s_mov_b32 s37, s59
    s_mov_b32 s38, 2211840
    s_mov_b32 s68, 6554
    s_mov_b32 s69, 10
    s_mov_b32 s62, 4
K1_R0_DIV:
    s_mov_b32 s39, 0x00020000
    s_mul_i32 s68, s48, s68
    s_lshr_b32 s68, s68, 16
    s_mul_i32 s69, s68, s69
    s_sub_u32 s69, s48, s69
    s_mul_i32 s48, s68, s51
    s_lshl_b32 s51, s69, 2
    s_add_u32 s48, s48, s51
    s_add_u32 s48, s48, s63
    s_lshl_b32 s46, s48, 10
    s_lshl_b32 s48, s69, 8
    s_add_u32 s51, s48, 2560
    s_cmp_eq_u32 s62, 3
    s_cselect_b32 s51, s51, 0x7f000000
    s_cmp_eq_u32 s62, 1
    s_cselect_b32 s34, s48, s51
    s_cmp_eq_u32 s62, 0
    s_cbranch_scc1 K1_R0_WO
    s_lshl_b32 s68, s68, 5
    s_mov_b32 s48, 4
    s_mov_b32 s51, 1
    s_mov_b32 s63, 8
    s_branch K1_R0_MAP
K1_R0_WO:
    s_mul_i32 s62, s68, 52429
    s_lshr_b32 s62, s62, 18
    s_mul_i32 s63, s62, 5
    s_sub_u32 s63, s68, s63
    s_mul_i32 s68, s62, 160
    s_mul_i32 s62, s63, 40
    s_cmp_eq_u32 s63, 4
    s_cselect_b32 s62, 16, s62
    s_cselect_b32 s48, 80, 20
    s_cselect_b32 s51, 20, 1
    s_cselect_b32 s63, 1, 4
    s_add_u32 s68, s68, s62
K1_R0_MAP:
    v_mul_lo_u32 v8, v5, s48
    v_mul_lo_u32 v9, v4, s51
    v_add_u32 v8, v8, v9
    v_mul_lo_u32 v8, v8, s49
    v_add_u32 v9, v8, v7
    v_add_u32 v8, v8, v6
    s_mul_i32 s68, s68, s49
    s_lshl_b32 s69, s69, 7
    s_add_u32 s68, s68, s69
    s_mul_i32 s63, s63, s49
    s_lshl_b32 s62, s42, 13
    s_add_u32 m0, s62, 126976
    s_nop 0
    buffer_load_dwordx4 v8, s[36:39], s68 offen nt lds
    s_add_u32 s68, s68, s63
    s_add_u32 m0, s62, 128000
    s_nop 0
    buffer_load_dwordx4 v9, s[36:39], s68 offen nt lds
    s_add_u32 s68, s68, s63
    s_add_u32 m0, s62, 129024
    s_nop 0
    buffer_load_dwordx4 v8, s[36:39], s68 offen nt lds
    s_add_u32 s68, s68, s63
    s_add_u32 m0, s62, 130048
    s_nop 0
    buffer_load_dwordx4 v9, s[36:39], s68 offen nt lds
K1_R0_SKIP:
    s_lshl_b32 s48, s2, 2
    s_add_u32 s48, s48, s42
    s_mov_b32 s35, 0x7f000000
    s_add_u32 s48, s48, 1024
    s_cmp_ge_u32 s48, 1680
    s_cbranch_scc1 K1_R1_SKIP
    s_mov_b32 s49, 1280
    s_mov_b32 s51, 40
    s_cmp_ge_u32 s48, 1140
    s_cbranch_scc1 K1_R1_W4
    s_cmp_ge_u32 s48, 600
    s_cbranch_scc1 K1_R1_W3
    s_mul_i32 s62, s48, 328
    s_lshr_b32 s62, s62, 16
    s_mul_i32 s63, s62, 200
    s_sub_u32 s48, s48, s63
    s_mul_i32 s63, s62, 800
    s_cmp_eq_u32 s62, 1
    s_cselect_b32 s36, s52, s54
    s_cselect_b32 s37, s53, s55
    s_cmp_eq_u32 s62, 0
    s_cselect_b32 s36, s60, s36
    s_cselect_b32 s37, s61, s37
    s_mov_b32 s38, 819200
    s_mov_b32 s68, 6554
    s_mov_b32 s69, 10
    s_branch K1_R1_DIV
K1_R1_W3:
    s_sub_u32 s48, s48, 600
    s_mov_b32 s63, 2400
    s_mov_b32 s36, s56
    s_mov_b32 s37, s57
    s_mov_b32 s38, 2211840
    s_mov_b32 s49, 3456
    s_mov_b32 s51, 108
    s_mov_b32 s68, 2428
    s_mov_b32 s69, 27
    s_mov_b32 s62, 3
    s_branch K1_R1_DIV
K1_R1_W4:
    s_sub_u32 s48, s48, 1140
    s_mov_b32 s63, 4560
    s_mov_b32 s36, s58
    s_mov_b32 s37, s59
    s_mov_b32 s38, 2211840
    s_mov_b32 s68, 6554
    s_mov_b32 s69, 10
    s_mov_b32 s62, 4
K1_R1_DIV:
    s_mov_b32 s39, 0x00020000
    s_mul_i32 s68, s48, s68
    s_lshr_b32 s68, s68, 16
    s_mul_i32 s69, s68, s69
    s_sub_u32 s69, s48, s69
    s_mul_i32 s48, s68, s51
    s_lshl_b32 s51, s69, 2
    s_add_u32 s48, s48, s51
    s_add_u32 s48, s48, s63
    s_lshl_b32 s47, s48, 10
    s_lshl_b32 s48, s69, 8
    s_add_u32 s51, s48, 2560
    s_cmp_eq_u32 s62, 3
    s_cselect_b32 s51, s51, 0x7f000000
    s_cmp_eq_u32 s62, 1
    s_cselect_b32 s35, s48, s51
    s_cmp_eq_u32 s62, 0
    s_cbranch_scc1 K1_R1_WO
    s_lshl_b32 s68, s68, 5
    s_mov_b32 s48, 4
    s_mov_b32 s51, 1
    s_mov_b32 s63, 8
    s_branch K1_R1_MAP
K1_R1_WO:
    s_mul_i32 s62, s68, 52429
    s_lshr_b32 s62, s62, 18
    s_mul_i32 s63, s62, 5
    s_sub_u32 s63, s68, s63
    s_mul_i32 s68, s62, 160
    s_mul_i32 s62, s63, 40
    s_cmp_eq_u32 s63, 4
    s_cselect_b32 s62, 16, s62
    s_cselect_b32 s48, 80, 20
    s_cselect_b32 s51, 20, 1
    s_cselect_b32 s63, 1, 4
    s_add_u32 s68, s68, s62
K1_R1_MAP:
    v_mul_lo_u32 v8, v5, s48
    v_mul_lo_u32 v9, v4, s51
    v_add_u32 v8, v8, v9
    v_mul_lo_u32 v8, v8, s49
    v_add_u32 v9, v8, v7
    v_add_u32 v8, v8, v6
    s_mul_i32 s68, s68, s49
    s_lshl_b32 s69, s69, 7
    s_add_u32 s68, s68, s69
    s_mul_i32 s63, s63, s49
    s_lshl_b32 s62, s42, 13
    s_add_u32 m0, s62, 131072
    s_nop 0
    buffer_load_dwordx4 v8, s[36:39], s68 offen nt lds
    s_add_u32 s68, s68, s63
    s_add_u32 m0, s62, 132096
    s_nop 0
    buffer_load_dwordx4 v9, s[36:39], s68 offen nt lds
    s_add_u32 s68, s68, s63
    s_add_u32 m0, s62, 133120
    s_nop 0
    buffer_load_dwordx4 v8, s[36:39], s68 offen nt lds
    s_add_u32 s68, s68, s63
    s_add_u32 m0, s62, 134144
    s_nop 0
    buffer_load_dwordx4 v9, s[36:39], s68 offen nt lds
K1_R1_SKIP:
    s_mov_b32 s28, s8
    s_mov_b32 s29, s9
    s_mov_b32 s30, 256
    s_mov_b32 s31, 0x00020000
    s_mov_b32 s20, s10
    s_mov_b32 s21, s11
    s_mov_b32 s22, 2621440
    s_mov_b32 s23, 0x00020000
    s_mul_i32 s48, s41, 3360
    s_add_u32 s24, s10, s48
    s_addc_u32 s25, s11, 0
    s_add_u32 s24, s24, 17825792
    s_addc_u32 s25, s25, 0
    s_mov_b32 s26, 3360
    s_mov_b32 s27, 0x00020000
    v_add_u32 v23, 0, v16
    v_add_u32 v24, 0, v17
    v_add_u32 v25, 0, v18
    v_add_u32 v26, 0, v19
    v_add_u32 v27, 0, v20
    v_add_u32 v28, 0, v21
    v_add_u32 v29, 0, v22
    s_barrier
    ds_read_b128 v[36:39], v24
    ds_read_b128 v[40:43], v26
    ds_read_b64_tr_b16 a[0:1], v23 offset:0
    ds_read_b64_tr_b16 a[2:3], v23 offset:240
    ds_read_b64_tr_b16 a[4:5], v23 offset:32
    ds_read_b64_tr_b16 a[6:7], v23 offset:272
    ds_read_b64_tr_b16 a[8:9], v23 offset:64
    ds_read_b64_tr_b16 a[10:11], v23 offset:304
    ds_read_b64_tr_b16 a[12:13], v23 offset:80
    ds_read_b64_tr_b16 a[14:15], v23 offset:320
    ds_read_b64_tr_b16 a[16:17], v23 offset:112
    ds_read_b64_tr_b16 a[18:19], v23 offset:352
    ds_read_b64_tr_b16 a[20:21], v23 offset:144
    ds_read_b64_tr_b16 a[22:23], v23 offset:384
    ds_read_b64_tr_b16 a[24:25], v23 offset:176
    ds_read_b64_tr_b16 a[26:27], v23 offset:416
    ds_read_b64_tr_b16 a[28:29], v23 offset:208
    ds_read_b64_tr_b16 a[30:31], v23 offset:448
    ds_read_b64_tr_b16 v[52:53], v28 offset:0
    ds_read_b64_tr_b16 v[54:55], v28 offset:240
    ds_read_b64_tr_b16 v[56:57], v29 offset:0
    ds_read_b64_tr_b16 v[58:59], v29 offset:240
    s_waitcnt lgkmcnt(0)
    v_mfma_f32_16x16x32_bf16 v[76:79], v[32:35], v[36:39], 0
    ds_read_b128 v[44:47], v25
    v_mfma_f32_16x16x32_bf16 v[84:87], v[36:39], v[36:39], 0
    ds_read_b128 v[48:51], v27
    v_mfma_f32_16x16x32_bf16 v[80:83], v[32:35], v[40:43], 0
    ds_read_b64_tr_b16 a[32:33], v23 offset:7680
    v_mfma_f32_16x16x32_bf16 v[88:91], v[40:43], v[40:43], 0
    ds_read_b64_tr_b16 a[34:35], v23 offset:7920
    v_mfma_f32_16x16x32_bf16 v[104:107], a[0:3], v[36:39], 0
    ds_read_b64_tr_b16 a[36:37], v23 offset:7712
    v_mfma_f32_16x16x32_bf16 v[136:139], a[0:3], v[40:43], 0
    ds_read_b64_tr_b16 a[38:39], v23 offset:7952
    v_mfma_f32_16x16x32_bf16 v[108:111], a[4:7], v[36:39], 0
    ds_read_b64_tr_b16 a[40:41], v23 offset:7744
    ds_read_b64_tr_b16 a[42:43], v23 offset:7984
    v_mfma_f32_16x16x32_bf16 v[140:143], a[4:7], v[40:43], 0
    ds_read_b64_tr_b16 a[44:45], v23 offset:7760
    v_mfma_f32_16x16x32_bf16 v[112:115], a[8:11], v[36:39], 0
    ds_read_b64_tr_b16 a[46:47], v23 offset:8000
    v_mfma_f32_16x16x32_bf16 v[144:147], a[8:11], v[40:43], 0
    ds_read_b64_tr_b16 a[48:49], v23 offset:7792
    v_mfma_f32_16x16x32_bf16 v[116:119], v[36:39], a[12:15], 0
    ds_read_b64_tr_b16 a[50:51], v23 offset:8032
    v_mfma_f32_16x16x32_bf16 v[148:151], v[40:43], a[12:15], 0
    ds_read_b64_tr_b16 a[52:53], v23 offset:7824
    v_mfma_f32_16x16x32_bf16 v[120:123], v[36:39], a[16:19], 0
    ds_read_b64_tr_b16 a[54:55], v23 offset:8064
    ds_read_b64_tr_b16 a[56:57], v23 offset:7856
    v_mfma_f32_16x16x32_bf16 v[152:155], v[40:43], a[16:19], 0
    ds_read_b64_tr_b16 a[58:59], v23 offset:8096
    v_mfma_f32_16x16x32_bf16 v[124:127], v[36:39], a[20:23], 0
    ds_read_b64_tr_b16 a[60:61], v23 offset:7888
    v_mfma_f32_16x16x32_bf16 v[156:159], v[40:43], a[20:23], 0
    ds_read_b64_tr_b16 a[62:63], v23 offset:8128
    v_mfma_f32_16x16x32_bf16 v[128:131], v[36:39], a[24:27], 0
    ds_read_b64_tr_b16 v[60:61], v28 offset:7680
    v_mfma_f32_16x16x32_bf16 v[160:163], v[40:43], a[24:27], 0
    ds_read_b64_tr_b16 v[62:63], v28 offset:7920
    v_mfma_f32_16x16x32_bf16 v[132:135], v[36:39], a[28:31], 0
    ds_read_b64_tr_b16 v[64:65], v29 offset:7680
    ds_read_b64_tr_b16 v[66:67], v29 offset:7920
    v_mfma_f32_16x16x32_bf16 v[164:167], v[40:43], a[28:31], 0
    v_mfma_f32_16x16x32_bf16 v[68:71], v[32:35], v[52:55], 0
    v_mfma_f32_16x16x32_bf16 v[72:75], v[32:35], v[56:59], 0
    s_waitcnt lgkmcnt(0)
    s_barrier
    v_mfma_f32_16x16x32_bf16 v[76:79], v[32:35], v[44:47], v[76:79]
    v_add_u32 v23, 31744, v16
    v_mfma_f32_16x16x32_bf16 v[84:87], v[44:47], v[44:47], v[84:87]
    v_add_u32 v24, 31744, v17
    v_add_u32 v25, 31744, v18
    v_mfma_f32_16x16x32_bf16 v[80:83], v[32:35], v[48:51], v[80:83]
    v_add_u32 v26, 31744, v19
    v_mfma_f32_16x16x32_bf16 v[88:91], v[48:51], v[48:51], v[88:91]
    v_add_u32 v27, 31744, v20
    v_add_u32 v28, 31744, v21
    v_mfma_f32_16x16x32_bf16 v[104:107], a[32:35], v[44:47], v[104:107]
    v_add_u32 v29, 31744, v22
    v_mfma_f32_16x16x32_bf16 v[136:139], a[32:35], v[48:51], v[136:139]
    ds_read_b128 v[36:39], v24
    ds_read_b128 v[40:43], v26
    v_mfma_f32_16x16x32_bf16 v[108:111], a[36:39], v[44:47], v[108:111]
    ds_read_b64_tr_b16 a[0:1], v23 offset:0
    v_mfma_f32_16x16x32_bf16 v[140:143], a[36:39], v[48:51], v[140:143]
    ds_read_b64_tr_b16 a[2:3], v23 offset:240
    ds_read_b64_tr_b16 a[4:5], v23 offset:32
    v_mfma_f32_16x16x32_bf16 v[112:115], a[40:43], v[44:47], v[112:115]
    ds_read_b64_tr_b16 a[6:7], v23 offset:272
    v_mfma_f32_16x16x32_bf16 v[144:147], a[40:43], v[48:51], v[144:147]
    ds_read_b64_tr_b16 a[8:9], v23 offset:64
    ds_read_b64_tr_b16 a[10:11], v23 offset:304
    v_mfma_f32_16x16x32_bf16 v[116:119], v[44:47], a[44:47], v[116:119]
    ds_read_b64_tr_b16 a[12:13], v23 offset:80
    v_mfma_f32_16x16x32_bf16 v[148:151], v[48:51], a[44:47], v[148:151]
    ds_read_b64_tr_b16 a[14:15], v23 offset:320
    ds_read_b64_tr_b16 a[16:17], v23 offset:112
    v_mfma_f32_16x16x32_bf16 v[120:123], v[44:47], a[48:51], v[120:123]
    ds_read_b64_tr_b16 a[18:19], v23 offset:352
    v_mfma_f32_16x16x32_bf16 v[152:155], v[48:51], a[48:51], v[152:155]
    ds_read_b64_tr_b16 a[20:21], v23 offset:144
    ds_read_b64_tr_b16 a[22:23], v23 offset:384
    v_mfma_f32_16x16x32_bf16 v[124:127], v[44:47], a[52:55], v[124:127]
    ds_read_b64_tr_b16 a[24:25], v23 offset:176
    v_mfma_f32_16x16x32_bf16 v[156:159], v[48:51], a[52:55], v[156:159]
    ds_read_b64_tr_b16 a[26:27], v23 offset:416
    ds_read_b64_tr_b16 a[28:29], v23 offset:208
    v_mfma_f32_16x16x32_bf16 v[128:131], v[44:47], a[56:59], v[128:131]
    ds_read_b64_tr_b16 a[30:31], v23 offset:448
    v_mfma_f32_16x16x32_bf16 v[160:163], v[48:51], a[56:59], v[160:163]
    ds_read_b64_tr_b16 v[52:53], v28 offset:0
    ds_read_b64_tr_b16 v[54:55], v28 offset:240
    v_mfma_f32_16x16x32_bf16 v[132:135], v[44:47], a[60:63], v[132:135]
    ds_read_b64_tr_b16 v[56:57], v29 offset:0
    ds_read_b64_tr_b16 v[58:59], v29 offset:240
    v_mfma_f32_16x16x32_bf16 v[164:167], v[48:51], a[60:63], v[164:167]
    v_mfma_f32_16x16x32_bf16 v[68:71], v[32:35], v[60:63], v[68:71]
    v_mfma_f32_16x16x32_bf16 v[72:75], v[32:35], v[64:67], v[72:75]
    s_waitcnt lgkmcnt(0)
    v_mfma_f32_16x16x32_bf16 v[76:79], v[32:35], v[36:39], v[76:79]
    ds_read_b128 v[44:47], v25
    v_mfma_f32_16x16x32_bf16 v[84:87], v[36:39], v[36:39], v[84:87]
    ds_read_b128 v[48:51], v27
    v_mfma_f32_16x16x32_bf16 v[80:83], v[32:35], v[40:43], v[80:83]
    ds_read_b64_tr_b16 a[32:33], v23 offset:7680
    v_mfma_f32_16x16x32_bf16 v[88:91], v[40:43], v[40:43], v[88:91]
    ds_read_b64_tr_b16 a[34:35], v23 offset:7920
    v_mfma_f32_16x16x32_bf16 v[104:107], a[0:3], v[36:39], v[104:107]
    ds_read_b64_tr_b16 a[36:37], v23 offset:7712
    v_mfma_f32_16x16x32_bf16 v[136:139], a[0:3], v[40:43], v[136:139]
    ds_read_b64_tr_b16 a[38:39], v23 offset:7952
    v_mfma_f32_16x16x32_bf16 v[108:111], a[4:7], v[36:39], v[108:111]
    ds_read_b64_tr_b16 a[40:41], v23 offset:7744
    ds_read_b64_tr_b16 a[42:43], v23 offset:7984
    v_mfma_f32_16x16x32_bf16 v[140:143], a[4:7], v[40:43], v[140:143]
    ds_read_b64_tr_b16 a[44:45], v23 offset:7760
    v_mfma_f32_16x16x32_bf16 v[112:115], a[8:11], v[36:39], v[112:115]
    ds_read_b64_tr_b16 a[46:47], v23 offset:8000
    v_mfma_f32_16x16x32_bf16 v[144:147], a[8:11], v[40:43], v[144:147]
    ds_read_b64_tr_b16 a[48:49], v23 offset:7792
    v_mfma_f32_16x16x32_bf16 v[116:119], v[36:39], a[12:15], v[116:119]
    ds_read_b64_tr_b16 a[50:51], v23 offset:8032
    v_mfma_f32_16x16x32_bf16 v[148:151], v[40:43], a[12:15], v[148:151]
    ds_read_b64_tr_b16 a[52:53], v23 offset:7824
    v_mfma_f32_16x16x32_bf16 v[120:123], v[36:39], a[16:19], v[120:123]
    ds_read_b64_tr_b16 a[54:55], v23 offset:8064
    ds_read_b64_tr_b16 a[56:57], v23 offset:7856
    v_mfma_f32_16x16x32_bf16 v[152:155], v[40:43], a[16:19], v[152:155]
    ds_read_b64_tr_b16 a[58:59], v23 offset:8096
    v_mfma_f32_16x16x32_bf16 v[124:127], v[36:39], a[20:23], v[124:127]
    ds_read_b64_tr_b16 a[60:61], v23 offset:7888
    v_mfma_f32_16x16x32_bf16 v[156:159], v[40:43], a[20:23], v[156:159]
    ds_read_b64_tr_b16 a[62:63], v23 offset:8128
    v_mfma_f32_16x16x32_bf16 v[128:131], v[36:39], a[24:27], v[128:131]
    ds_read_b64_tr_b16 v[60:61], v28 offset:7680
    v_mfma_f32_16x16x32_bf16 v[160:163], v[40:43], a[24:27], v[160:163]
    ds_read_b64_tr_b16 v[62:63], v28 offset:7920
    v_mfma_f32_16x16x32_bf16 v[132:135], v[36:39], a[28:31], v[132:135]
    ds_read_b64_tr_b16 v[64:65], v29 offset:7680
    ds_read_b64_tr_b16 v[66:67], v29 offset:7920
    v_mfma_f32_16x16x32_bf16 v[164:167], v[40:43], a[28:31], v[164:167]
    v_mfma_f32_16x16x32_bf16 v[68:71], v[32:35], v[52:55], v[68:71]
    v_mfma_f32_16x16x32_bf16 v[72:75], v[32:35], v[56:59], v[72:75]
    s_waitcnt lgkmcnt(0)
    s_barrier
    v_mfma_f32_16x16x32_bf16 v[76:79], v[32:35], v[44:47], v[76:79]
    v_add_u32 v23, 63488, v16
    v_mfma_f32_16x16x32_bf16 v[84:87], v[44:47], v[44:47], v[84:87]
    v_add_u32 v24, 63488, v17
    v_add_u32 v25, 63488, v18
    v_mfma_f32_16x16x32_bf16 v[80:83], v[32:35], v[48:51], v[80:83]
    v_add_u32 v26, 63488, v19
    v_mfma_f32_16x16x32_bf16 v[88:91], v[48:51], v[48:51], v[88:91]
    v_add_u32 v27, 63488, v20
    v_add_u32 v28, 63488, v21
    v_mfma_f32_16x16x32_bf16 v[104:107], a[32:35], v[44:47], v[104:107]
    v_add_u32 v29, 63488, v22
    v_mfma_f32_16x16x32_bf16 v[136:139], a[32:35], v[48:51], v[136:139]
    ds_read_b128 v[36:39], v24
    ds_read_b128 v[40:43], v26
    v_mfma_f32_16x16x32_bf16 v[108:111], a[36:39], v[44:47], v[108:111]
    ds_read_b64_tr_b16 a[0:1], v23 offset:0
    v_mfma_f32_16x16x32_bf16 v[140:143], a[36:39], v[48:51], v[140:143]
    ds_read_b64_tr_b16 a[2:3], v23 offset:240
    ds_read_b64_tr_b16 a[4:5], v23 offset:32
    v_mfma_f32_16x16x32_bf16 v[112:115], a[40:43], v[44:47], v[112:115]
    ds_read_b64_tr_b16 a[6:7], v23 offset:272
    v_mfma_f32_16x16x32_bf16 v[144:147], a[40:43], v[48:51], v[144:147]
    ds_read_b64_tr_b16 a[8:9], v23 offset:64
    ds_read_b64_tr_b16 a[10:11], v23 offset:304
    v_mfma_f32_16x16x32_bf16 v[116:119], v[44:47], a[44:47], v[116:119]
    ds_read_b64_tr_b16 a[12:13], v23 offset:80
    v_mfma_f32_16x16x32_bf16 v[148:151], v[48:51], a[44:47], v[148:151]
    ds_read_b64_tr_b16 a[14:15], v23 offset:320
    ds_read_b64_tr_b16 a[16:17], v23 offset:112
    v_mfma_f32_16x16x32_bf16 v[120:123], v[44:47], a[48:51], v[120:123]
    ds_read_b64_tr_b16 a[18:19], v23 offset:352
    v_mfma_f32_16x16x32_bf16 v[152:155], v[48:51], a[48:51], v[152:155]
    ds_read_b64_tr_b16 a[20:21], v23 offset:144
    ds_read_b64_tr_b16 a[22:23], v23 offset:384
    v_mfma_f32_16x16x32_bf16 v[124:127], v[44:47], a[52:55], v[124:127]
    ds_read_b64_tr_b16 a[24:25], v23 offset:176
    v_mfma_f32_16x16x32_bf16 v[156:159], v[48:51], a[52:55], v[156:159]
    ds_read_b64_tr_b16 a[26:27], v23 offset:416
    ds_read_b64_tr_b16 a[28:29], v23 offset:208
    v_mfma_f32_16x16x32_bf16 v[128:131], v[44:47], a[56:59], v[128:131]
    ds_read_b64_tr_b16 a[30:31], v23 offset:448
    v_mfma_f32_16x16x32_bf16 v[160:163], v[48:51], a[56:59], v[160:163]
    ds_read_b64_tr_b16 v[52:53], v28 offset:0
    ds_read_b64_tr_b16 v[54:55], v28 offset:240
    v_mfma_f32_16x16x32_bf16 v[132:135], v[44:47], a[60:63], v[132:135]
    ds_read_b64_tr_b16 v[56:57], v29 offset:0
    ds_read_b64_tr_b16 v[58:59], v29 offset:240
    v_mfma_f32_16x16x32_bf16 v[164:167], v[48:51], a[60:63], v[164:167]
    v_mfma_f32_16x16x32_bf16 v[68:71], v[32:35], v[60:63], v[68:71]
    v_mfma_f32_16x16x32_bf16 v[72:75], v[32:35], v[64:67], v[72:75]
    s_waitcnt lgkmcnt(0)
    v_mfma_f32_16x16x32_bf16 v[76:79], v[32:35], v[36:39], v[76:79]
    ds_read_b128 v[44:47], v25
    v_mfma_f32_16x16x32_bf16 v[84:87], v[36:39], v[36:39], v[84:87]
    ds_read_b128 v[48:51], v27
    v_mfma_f32_16x16x32_bf16 v[80:83], v[32:35], v[40:43], v[80:83]
    ds_read_b64_tr_b16 a[32:33], v23 offset:7680
    v_mfma_f32_16x16x32_bf16 v[88:91], v[40:43], v[40:43], v[88:91]
    ds_read_b64_tr_b16 a[34:35], v23 offset:7920
    v_mfma_f32_16x16x32_bf16 v[104:107], a[0:3], v[36:39], v[104:107]
    ds_read_b64_tr_b16 a[36:37], v23 offset:7712
    v_mfma_f32_16x16x32_bf16 v[136:139], a[0:3], v[40:43], v[136:139]
    ds_read_b64_tr_b16 a[38:39], v23 offset:7952
    v_mfma_f32_16x16x32_bf16 v[108:111], a[4:7], v[36:39], v[108:111]
    ds_read_b64_tr_b16 a[40:41], v23 offset:7744
    ds_read_b64_tr_b16 a[42:43], v23 offset:7984
    v_mfma_f32_16x16x32_bf16 v[140:143], a[4:7], v[40:43], v[140:143]
    ds_read_b64_tr_b16 a[44:45], v23 offset:7760
    v_mfma_f32_16x16x32_bf16 v[112:115], a[8:11], v[36:39], v[112:115]
    ds_read_b64_tr_b16 a[46:47], v23 offset:8000
    v_mfma_f32_16x16x32_bf16 v[144:147], a[8:11], v[40:43], v[144:147]
    ds_read_b64_tr_b16 a[48:49], v23 offset:7792
    v_mfma_f32_16x16x32_bf16 v[116:119], v[36:39], a[12:15], v[116:119]
    ds_read_b64_tr_b16 a[50:51], v23 offset:8032
    v_mfma_f32_16x16x32_bf16 v[148:151], v[40:43], a[12:15], v[148:151]
    ds_read_b64_tr_b16 a[52:53], v23 offset:7824
    v_mfma_f32_16x16x32_bf16 v[120:123], v[36:39], a[16:19], v[120:123]
    ds_read_b64_tr_b16 a[54:55], v23 offset:8064
    ds_read_b64_tr_b16 a[56:57], v23 offset:7856
    v_mfma_f32_16x16x32_bf16 v[152:155], v[40:43], a[16:19], v[152:155]
    ds_read_b64_tr_b16 a[58:59], v23 offset:8096
    v_mfma_f32_16x16x32_bf16 v[124:127], v[36:39], a[20:23], v[124:127]
    ds_read_b64_tr_b16 a[60:61], v23 offset:7888
    v_mfma_f32_16x16x32_bf16 v[156:159], v[40:43], a[20:23], v[156:159]
    ds_read_b64_tr_b16 a[62:63], v23 offset:8128
    v_mfma_f32_16x16x32_bf16 v[128:131], v[36:39], a[24:27], v[128:131]
    ds_read_b64_tr_b16 v[60:61], v28 offset:7680
    v_mfma_f32_16x16x32_bf16 v[160:163], v[40:43], a[24:27], v[160:163]
    ds_read_b64_tr_b16 v[62:63], v28 offset:7920
    v_mfma_f32_16x16x32_bf16 v[132:135], v[36:39], a[28:31], v[132:135]
    ds_read_b64_tr_b16 v[64:65], v29 offset:7680
    ds_read_b64_tr_b16 v[66:67], v29 offset:7920
    v_mfma_f32_16x16x32_bf16 v[164:167], v[40:43], a[28:31], v[164:167]
    v_mfma_f32_16x16x32_bf16 v[68:71], v[32:35], v[52:55], v[68:71]
    v_mfma_f32_16x16x32_bf16 v[72:75], v[32:35], v[56:59], v[72:75]
    s_waitcnt lgkmcnt(0)
    s_barrier
    v_mfma_f32_16x16x32_bf16 v[76:79], v[32:35], v[44:47], v[76:79]
    v_add_u32 v23, 95232, v16
    v_mfma_f32_16x16x32_bf16 v[84:87], v[44:47], v[44:47], v[84:87]
    v_add_u32 v24, 95232, v17
    v_add_u32 v25, 95232, v18
    v_mfma_f32_16x16x32_bf16 v[80:83], v[32:35], v[48:51], v[80:83]
    v_add_u32 v26, 95232, v19
    v_mfma_f32_16x16x32_bf16 v[88:91], v[48:51], v[48:51], v[88:91]
    v_add_u32 v27, 95232, v20
    v_add_u32 v28, 95232, v21
    v_mfma_f32_16x16x32_bf16 v[104:107], a[32:35], v[44:47], v[104:107]
    v_add_u32 v29, 95232, v22
    v_mfma_f32_16x16x32_bf16 v[136:139], a[32:35], v[48:51], v[136:139]
    ds_read_b128 v[36:39], v24
    ds_read_b128 v[40:43], v26
    v_mfma_f32_16x16x32_bf16 v[108:111], a[36:39], v[44:47], v[108:111]
    ds_read_b64_tr_b16 a[0:1], v23 offset:0
    v_mfma_f32_16x16x32_bf16 v[140:143], a[36:39], v[48:51], v[140:143]
    ds_read_b64_tr_b16 a[2:3], v23 offset:240
    ds_read_b64_tr_b16 a[4:5], v23 offset:32
    v_mfma_f32_16x16x32_bf16 v[112:115], a[40:43], v[44:47], v[112:115]
    ds_read_b64_tr_b16 a[6:7], v23 offset:272
    v_mfma_f32_16x16x32_bf16 v[144:147], a[40:43], v[48:51], v[144:147]
    ds_read_b64_tr_b16 a[8:9], v23 offset:64
    ds_read_b64_tr_b16 a[10:11], v23 offset:304
    v_mfma_f32_16x16x32_bf16 v[116:119], v[44:47], a[44:47], v[116:119]
    ds_read_b64_tr_b16 a[12:13], v23 offset:80
    v_mfma_f32_16x16x32_bf16 v[148:151], v[48:51], a[44:47], v[148:151]
    ds_read_b64_tr_b16 a[14:15], v23 offset:320
    ds_read_b64_tr_b16 a[16:17], v23 offset:112
    v_mfma_f32_16x16x32_bf16 v[120:123], v[44:47], a[48:51], v[120:123]
    ds_read_b64_tr_b16 a[18:19], v23 offset:352
    v_mfma_f32_16x16x32_bf16 v[152:155], v[48:51], a[48:51], v[152:155]
    ds_read_b64_tr_b16 a[20:21], v23 offset:144
    ds_read_b64_tr_b16 a[22:23], v23 offset:384
    v_mfma_f32_16x16x32_bf16 v[124:127], v[44:47], a[52:55], v[124:127]
    ds_read_b64_tr_b16 a[24:25], v23 offset:176
    v_mfma_f32_16x16x32_bf16 v[156:159], v[48:51], a[52:55], v[156:159]
    ds_read_b64_tr_b16 a[26:27], v23 offset:416
    ds_read_b64_tr_b16 a[28:29], v23 offset:208
    v_mfma_f32_16x16x32_bf16 v[128:131], v[44:47], a[56:59], v[128:131]
    ds_read_b64_tr_b16 a[30:31], v23 offset:448
    v_mfma_f32_16x16x32_bf16 v[160:163], v[48:51], a[56:59], v[160:163]
    ds_read_b64_tr_b16 v[52:53], v28 offset:0
    ds_read_b64_tr_b16 v[54:55], v28 offset:240
    v_mfma_f32_16x16x32_bf16 v[132:135], v[44:47], a[60:63], v[132:135]
    ds_read_b64_tr_b16 v[56:57], v29 offset:0
    ds_read_b64_tr_b16 v[58:59], v29 offset:240
    v_mfma_f32_16x16x32_bf16 v[164:167], v[48:51], a[60:63], v[164:167]
    v_mfma_f32_16x16x32_bf16 v[68:71], v[32:35], v[60:63], v[68:71]
    v_mfma_f32_16x16x32_bf16 v[72:75], v[32:35], v[64:67], v[72:75]
    s_waitcnt lgkmcnt(0)
    v_mfma_f32_16x16x32_bf16 v[76:79], v[32:35], v[36:39], v[76:79]
    ds_read_b128 v[44:47], v25
    v_mfma_f32_16x16x32_bf16 v[84:87], v[36:39], v[36:39], v[84:87]
    ds_read_b128 v[48:51], v27
    v_mfma_f32_16x16x32_bf16 v[80:83], v[32:35], v[40:43], v[80:83]
    ds_read_b64_tr_b16 a[32:33], v23 offset:7680
    v_mfma_f32_16x16x32_bf16 v[88:91], v[40:43], v[40:43], v[88:91]
    ds_read_b64_tr_b16 a[34:35], v23 offset:7920
    v_mfma_f32_16x16x32_bf16 v[104:107], a[0:3], v[36:39], v[104:107]
    ds_read_b64_tr_b16 a[36:37], v23 offset:7712
    v_mfma_f32_16x16x32_bf16 v[136:139], a[0:3], v[40:43], v[136:139]
    ds_read_b64_tr_b16 a[38:39], v23 offset:7952
    v_mfma_f32_16x16x32_bf16 v[108:111], a[4:7], v[36:39], v[108:111]
    ds_read_b64_tr_b16 a[40:41], v23 offset:7744
    ds_read_b64_tr_b16 a[42:43], v23 offset:7984
    v_mfma_f32_16x16x32_bf16 v[140:143], a[4:7], v[40:43], v[140:143]
    ds_read_b64_tr_b16 a[44:45], v23 offset:7760
    v_mfma_f32_16x16x32_bf16 v[112:115], a[8:11], v[36:39], v[112:115]
    ds_read_b64_tr_b16 a[46:47], v23 offset:8000
    v_mfma_f32_16x16x32_bf16 v[144:147], a[8:11], v[40:43], v[144:147]
    ds_read_b64_tr_b16 a[48:49], v23 offset:7792
    v_mfma_f32_16x16x32_bf16 v[116:119], v[36:39], a[12:15], v[116:119]
    ds_read_b64_tr_b16 a[50:51], v23 offset:8032
    v_mfma_f32_16x16x32_bf16 v[148:151], v[40:43], a[12:15], v[148:151]
    ds_read_b64_tr_b16 a[52:53], v23 offset:7824
    v_mfma_f32_16x16x32_bf16 v[120:123], v[36:39], a[16:19], v[120:123]
    ds_read_b64_tr_b16 a[54:55], v23 offset:8064
    ds_read_b64_tr_b16 a[56:57], v23 offset:7856
    v_mfma_f32_16x16x32_bf16 v[152:155], v[40:43], a[16:19], v[152:155]
    ds_read_b64_tr_b16 a[58:59], v23 offset:8096
    v_mfma_f32_16x16x32_bf16 v[124:127], v[36:39], a[20:23], v[124:127]
    ds_read_b64_tr_b16 a[60:61], v23 offset:7888
    v_mfma_f32_16x16x32_bf16 v[156:159], v[40:43], a[20:23], v[156:159]
    ds_read_b64_tr_b16 a[62:63], v23 offset:8128
    v_mfma_f32_16x16x32_bf16 v[128:131], v[36:39], a[24:27], v[128:131]
    ds_read_b64_tr_b16 v[60:61], v28 offset:7680
    v_mfma_f32_16x16x32_bf16 v[160:163], v[40:43], a[24:27], v[160:163]
    ds_read_b64_tr_b16 v[62:63], v28 offset:7920
    v_mfma_f32_16x16x32_bf16 v[132:135], v[36:39], a[28:31], v[132:135]
    ds_read_b64_tr_b16 v[64:65], v29 offset:7680
    ds_read_b64_tr_b16 v[66:67], v29 offset:7920
    v_mfma_f32_16x16x32_bf16 v[164:167], v[40:43], a[28:31], v[164:167]
    v_mfma_f32_16x16x32_bf16 v[68:71], v[32:35], v[52:55], v[68:71]
    v_mfma_f32_16x16x32_bf16 v[72:75], v[32:35], v[56:59], v[72:75]
    s_waitcnt lgkmcnt(0)
    s_barrier
    v_mfma_f32_16x16x32_bf16 v[76:79], v[32:35], v[44:47], v[76:79]
    v_add_u32 v23, 0, v16
    v_mfma_f32_16x16x32_bf16 v[84:87], v[44:47], v[44:47], v[84:87]
    v_add_u32 v24, 0, v17
    v_add_u32 v25, 0, v18
    v_mfma_f32_16x16x32_bf16 v[80:83], v[32:35], v[48:51], v[80:83]
    v_add_u32 v26, 0, v19
    v_mfma_f32_16x16x32_bf16 v[88:91], v[48:51], v[48:51], v[88:91]
    v_add_u32 v27, 0, v20
    v_add_u32 v28, 0, v21
    v_mfma_f32_16x16x32_bf16 v[104:107], a[32:35], v[44:47], v[104:107]
    v_add_u32 v29, 0, v22
    v_mfma_f32_16x16x32_bf16 v[136:139], a[32:35], v[48:51], v[136:139]
    ds_read_b128 v[36:39], v24
    ds_read_b128 v[40:43], v26
    v_mfma_f32_16x16x32_bf16 v[108:111], a[36:39], v[44:47], v[108:111]
    ds_read_b64_tr_b16 a[0:1], v23 offset:0
    v_mfma_f32_16x16x32_bf16 v[140:143], a[36:39], v[48:51], v[140:143]
    ds_read_b64_tr_b16 a[2:3], v23 offset:240
    ds_read_b64_tr_b16 a[4:5], v23 offset:32
    v_mfma_f32_16x16x32_bf16 v[112:115], a[40:43], v[44:47], v[112:115]
    ds_read_b64_tr_b16 a[6:7], v23 offset:272
    v_mfma_f32_16x16x32_bf16 v[144:147], a[40:43], v[48:51], v[144:147]
    ds_read_b64_tr_b16 a[8:9], v23 offset:64
    ds_read_b64_tr_b16 a[10:11], v23 offset:304
    v_mfma_f32_16x16x32_bf16 v[116:119], v[44:47], a[44:47], v[116:119]
    ds_read_b64_tr_b16 a[12:13], v23 offset:80
    v_mfma_f32_16x16x32_bf16 v[148:151], v[48:51], a[44:47], v[148:151]
    ds_read_b64_tr_b16 a[14:15], v23 offset:320
    ds_read_b64_tr_b16 a[16:17], v23 offset:112
    v_mfma_f32_16x16x32_bf16 v[120:123], v[44:47], a[48:51], v[120:123]
    ds_read_b64_tr_b16 a[18:19], v23 offset:352
    v_mfma_f32_16x16x32_bf16 v[152:155], v[48:51], a[48:51], v[152:155]
    ds_read_b64_tr_b16 a[20:21], v23 offset:144
    ds_read_b64_tr_b16 a[22:23], v23 offset:384
    v_mfma_f32_16x16x32_bf16 v[124:127], v[44:47], a[52:55], v[124:127]
    ds_read_b64_tr_b16 a[24:25], v23 offset:176
    v_mfma_f32_16x16x32_bf16 v[156:159], v[48:51], a[52:55], v[156:159]
    ds_read_b64_tr_b16 a[26:27], v23 offset:416
    ds_read_b64_tr_b16 a[28:29], v23 offset:208
    v_mfma_f32_16x16x32_bf16 v[128:131], v[44:47], a[56:59], v[128:131]
    ds_read_b64_tr_b16 a[30:31], v23 offset:448
    v_mfma_f32_16x16x32_bf16 v[160:163], v[48:51], a[56:59], v[160:163]
    ds_read_b64_tr_b16 v[52:53], v28 offset:0
    ds_read_b64_tr_b16 v[54:55], v28 offset:240
    v_mfma_f32_16x16x32_bf16 v[132:135], v[44:47], a[60:63], v[132:135]
    ds_read_b64_tr_b16 v[56:57], v29 offset:0
    ds_read_b64_tr_b16 v[58:59], v29 offset:240
    v_mfma_f32_16x16x32_bf16 v[164:167], v[48:51], a[60:63], v[164:167]
    v_mfma_f32_16x16x32_bf16 v[68:71], v[32:35], v[60:63], v[68:71]
    v_mfma_f32_16x16x32_bf16 v[72:75], v[32:35], v[64:67], v[72:75]
    s_waitcnt lgkmcnt(0)
    v_mfma_f32_16x16x32_bf16 v[76:79], v[32:35], v[36:39], v[76:79]
    ds_read_b128 v[44:47], v25
    v_mfma_f32_16x16x32_bf16 v[84:87], v[36:39], v[36:39], v[84:87]
    ds_read_b128 v[48:51], v27
    v_mfma_f32_16x16x32_bf16 v[80:83], v[32:35], v[40:43], v[80:83]
    ds_read_b64_tr_b16 a[32:33], v23 offset:7680
    v_mfma_f32_16x16x32_bf16 v[88:91], v[40:43], v[40:43], v[88:91]
    ds_read_b64_tr_b16 a[34:35], v23 offset:7920
    v_mfma_f32_16x16x32_bf16 v[104:107], a[0:3], v[36:39], v[104:107]
    ds_read_b64_tr_b16 a[36:37], v23 offset:7712
    v_mfma_f32_16x16x32_bf16 v[136:139], a[0:3], v[40:43], v[136:139]
    ds_read_b64_tr_b16 a[38:39], v23 offset:7952
    v_mfma_f32_16x16x32_bf16 v[108:111], a[4:7], v[36:39], v[108:111]
    ds_read_b64_tr_b16 a[40:41], v23 offset:7744
    ds_read_b64_tr_b16 a[42:43], v23 offset:7984
    v_mfma_f32_16x16x32_bf16 v[140:143], a[4:7], v[40:43], v[140:143]
    ds_read_b64_tr_b16 a[44:45], v23 offset:7760
    v_mfma_f32_16x16x32_bf16 v[112:115], a[8:11], v[36:39], v[112:115]
    ds_read_b64_tr_b16 a[46:47], v23 offset:8000
    v_mfma_f32_16x16x32_bf16 v[144:147], a[8:11], v[40:43], v[144:147]
    ds_read_b64_tr_b16 a[48:49], v23 offset:7792
    v_mfma_f32_16x16x32_bf16 v[116:119], v[36:39], a[12:15], v[116:119]
    ds_read_b64_tr_b16 a[50:51], v23 offset:8032
    v_mfma_f32_16x16x32_bf16 v[148:151], v[40:43], a[12:15], v[148:151]
    ds_read_b64_tr_b16 a[52:53], v23 offset:7824
    v_mfma_f32_16x16x32_bf16 v[120:123], v[36:39], a[16:19], v[120:123]
    ds_read_b64_tr_b16 a[54:55], v23 offset:8064
    ds_read_b64_tr_b16 a[56:57], v23 offset:7856
    v_mfma_f32_16x16x32_bf16 v[152:155], v[40:43], a[16:19], v[152:155]
    ds_read_b64_tr_b16 a[58:59], v23 offset:8096
    v_mfma_f32_16x16x32_bf16 v[124:127], v[36:39], a[20:23], v[124:127]
    ds_read_b64_tr_b16 a[60:61], v23 offset:7888
    v_mfma_f32_16x16x32_bf16 v[156:159], v[40:43], a[20:23], v[156:159]
    ds_read_b64_tr_b16 a[62:63], v23 offset:8128
    v_mfma_f32_16x16x32_bf16 v[128:131], v[36:39], a[24:27], v[128:131]
    ds_read_b64_tr_b16 v[60:61], v28 offset:7680
    v_mfma_f32_16x16x32_bf16 v[160:163], v[40:43], a[24:27], v[160:163]
    ds_read_b64_tr_b16 v[62:63], v28 offset:7920
    v_mfma_f32_16x16x32_bf16 v[132:135], v[36:39], a[28:31], v[132:135]
    ds_read_b64_tr_b16 v[64:65], v29 offset:7680
    ds_read_b64_tr_b16 v[66:67], v29 offset:7920
    v_mfma_f32_16x16x32_bf16 v[164:167], v[40:43], a[28:31], v[164:167]
    v_mfma_f32_16x16x32_bf16 v[68:71], v[32:35], v[52:55], v[68:71]
    v_mfma_f32_16x16x32_bf16 v[72:75], v[32:35], v[56:59], v[72:75]
    s_waitcnt lgkmcnt(0)
    s_waitcnt vmcnt(0)
    s_barrier
    v_mfma_f32_16x16x32_bf16 v[76:79], v[32:35], v[44:47], v[76:79]
    v_add_u32 v23, 31744, v16
    v_mfma_f32_16x16x32_bf16 v[84:87], v[44:47], v[44:47], v[84:87]
    v_add_u32 v24, 31744, v17
    v_add_u32 v25, 31744, v18
    v_mfma_f32_16x16x32_bf16 v[80:83], v[32:35], v[48:51], v[80:83]
    v_add_u32 v26, 31744, v19
    v_mfma_f32_16x16x32_bf16 v[88:91], v[48:51], v[48:51], v[88:91]
    v_add_u32 v27, 31744, v20
    v_add_u32 v28, 31744, v21
    v_mfma_f32_16x16x32_bf16 v[104:107], a[32:35], v[44:47], v[104:107]
    v_add_u32 v29, 31744, v22
    v_mfma_f32_16x16x32_bf16 v[136:139], a[32:35], v[48:51], v[136:139]
    ds_read_b128 v[36:39], v24
    ds_read_b128 v[40:43], v26
    v_mfma_f32_16x16x32_bf16 v[108:111], a[36:39], v[44:47], v[108:111]
    ds_read_b64_tr_b16 a[0:1], v23 offset:0
    v_mfma_f32_16x16x32_bf16 v[140:143], a[36:39], v[48:51], v[140:143]
    ds_read_b64_tr_b16 a[2:3], v23 offset:240
    ds_read_b64_tr_b16 a[4:5], v23 offset:32
    v_mfma_f32_16x16x32_bf16 v[112:115], a[40:43], v[44:47], v[112:115]
    ds_read_b64_tr_b16 a[6:7], v23 offset:272
    v_mfma_f32_16x16x32_bf16 v[144:147], a[40:43], v[48:51], v[144:147]
    ds_read_b64_tr_b16 a[8:9], v23 offset:64
    ds_read_b64_tr_b16 a[10:11], v23 offset:304
    v_mfma_f32_16x16x32_bf16 v[116:119], v[44:47], a[44:47], v[116:119]
    ds_read_b64_tr_b16 a[12:13], v23 offset:80
    v_mfma_f32_16x16x32_bf16 v[148:151], v[48:51], a[44:47], v[148:151]
    ds_read_b64_tr_b16 a[14:15], v23 offset:320
    ds_read_b64_tr_b16 a[16:17], v23 offset:112
    v_mfma_f32_16x16x32_bf16 v[120:123], v[44:47], a[48:51], v[120:123]
    ds_read_b64_tr_b16 a[18:19], v23 offset:352
    v_mfma_f32_16x16x32_bf16 v[152:155], v[48:51], a[48:51], v[152:155]
    ds_read_b64_tr_b16 a[20:21], v23 offset:144
    ds_read_b64_tr_b16 a[22:23], v23 offset:384
    v_mfma_f32_16x16x32_bf16 v[124:127], v[44:47], a[52:55], v[124:127]
    ds_read_b64_tr_b16 a[24:25], v23 offset:176
    v_mfma_f32_16x16x32_bf16 v[156:159], v[48:51], a[52:55], v[156:159]
    ds_read_b64_tr_b16 a[26:27], v23 offset:416
    ds_read_b64_tr_b16 a[28:29], v23 offset:208
    v_mfma_f32_16x16x32_bf16 v[128:131], v[44:47], a[56:59], v[128:131]
    ds_read_b64_tr_b16 a[30:31], v23 offset:448
    v_mfma_f32_16x16x32_bf16 v[160:163], v[48:51], a[56:59], v[160:163]
    ds_read_b64_tr_b16 v[52:53], v28 offset:0
    ds_read_b64_tr_b16 v[54:55], v28 offset:240
    v_mfma_f32_16x16x32_bf16 v[132:135], v[44:47], a[60:63], v[132:135]
    ds_read_b64_tr_b16 v[56:57], v29 offset:0
    ds_read_b64_tr_b16 v[58:59], v29 offset:240
    v_mfma_f32_16x16x32_bf16 v[164:167], v[48:51], a[60:63], v[164:167]
    v_mfma_f32_16x16x32_bf16 v[68:71], v[32:35], v[60:63], v[68:71]
    v_mfma_f32_16x16x32_bf16 v[72:75], v[32:35], v[64:67], v[72:75]
    s_waitcnt lgkmcnt(0)
    v_mfma_f32_16x16x32_bf16 v[76:79], v[32:35], v[36:39], v[76:79]
    ds_read_b128 v[44:47], v25
    v_mfma_f32_16x16x32_bf16 v[84:87], v[36:39], v[36:39], v[84:87]
    ds_read_b128 v[48:51], v27
    v_mfma_f32_16x16x32_bf16 v[80:83], v[32:35], v[40:43], v[80:83]
    ds_read_b64_tr_b16 a[32:33], v23 offset:7680
    v_mfma_f32_16x16x32_bf16 v[88:91], v[40:43], v[40:43], v[88:91]
    ds_read_b64_tr_b16 a[34:35], v23 offset:7920
    v_mfma_f32_16x16x32_bf16 v[104:107], a[0:3], v[36:39], v[104:107]
    ds_read_b64_tr_b16 a[36:37], v23 offset:7712
    v_mfma_f32_16x16x32_bf16 v[136:139], a[0:3], v[40:43], v[136:139]
    ds_read_b64_tr_b16 a[38:39], v23 offset:7952
    v_mfma_f32_16x16x32_bf16 v[108:111], a[4:7], v[36:39], v[108:111]
    ds_read_b64_tr_b16 a[40:41], v23 offset:7744
    ds_read_b64_tr_b16 a[42:43], v23 offset:7984
    v_mfma_f32_16x16x32_bf16 v[140:143], a[4:7], v[40:43], v[140:143]
    ds_read_b64_tr_b16 a[44:45], v23 offset:7760
    v_mfma_f32_16x16x32_bf16 v[112:115], a[8:11], v[36:39], v[112:115]
    ds_read_b64_tr_b16 a[46:47], v23 offset:8000
    v_mfma_f32_16x16x32_bf16 v[144:147], a[8:11], v[40:43], v[144:147]
    ds_read_b64_tr_b16 a[48:49], v23 offset:7792
    v_mfma_f32_16x16x32_bf16 v[116:119], v[36:39], a[12:15], v[116:119]
    ds_read_b64_tr_b16 a[50:51], v23 offset:8032
    v_mfma_f32_16x16x32_bf16 v[148:151], v[40:43], a[12:15], v[148:151]
    ds_read_b64_tr_b16 a[52:53], v23 offset:7824
    v_mfma_f32_16x16x32_bf16 v[120:123], v[36:39], a[16:19], v[120:123]
    ds_read_b64_tr_b16 a[54:55], v23 offset:8064
    ds_read_b64_tr_b16 a[56:57], v23 offset:7856
    v_mfma_f32_16x16x32_bf16 v[152:155], v[40:43], a[16:19], v[152:155]
    ds_read_b64_tr_b16 a[58:59], v23 offset:8096
    v_mfma_f32_16x16x32_bf16 v[124:127], v[36:39], a[20:23], v[124:127]
    ds_read_b64_tr_b16 a[60:61], v23 offset:7888
    v_mfma_f32_16x16x32_bf16 v[156:159], v[40:43], a[20:23], v[156:159]
    ds_read_b64_tr_b16 a[62:63], v23 offset:8128
    v_mfma_f32_16x16x32_bf16 v[128:131], v[36:39], a[24:27], v[128:131]
    ds_read_b64_tr_b16 v[60:61], v28 offset:7680
    v_mfma_f32_16x16x32_bf16 v[160:163], v[40:43], a[24:27], v[160:163]
    ds_read_b64_tr_b16 v[62:63], v28 offset:7920
    v_mfma_f32_16x16x32_bf16 v[132:135], v[36:39], a[28:31], v[132:135]
    ds_read_b64_tr_b16 v[64:65], v29 offset:7680
    ds_read_b64_tr_b16 v[66:67], v29 offset:7920
    v_mfma_f32_16x16x32_bf16 v[164:167], v[40:43], a[28:31], v[164:167]
    v_mfma_f32_16x16x32_bf16 v[68:71], v[32:35], v[52:55], v[68:71]
    v_mfma_f32_16x16x32_bf16 v[72:75], v[32:35], v[56:59], v[72:75]
    s_waitcnt lgkmcnt(0)
    s_barrier
    v_mfma_f32_16x16x32_bf16 v[76:79], v[32:35], v[44:47], v[76:79]
    v_add_u32 v23, 63488, v16
    v_mfma_f32_16x16x32_bf16 v[84:87], v[44:47], v[44:47], v[84:87]
    v_add_u32 v24, 63488, v17
    v_add_u32 v25, 63488, v18
    v_mfma_f32_16x16x32_bf16 v[80:83], v[32:35], v[48:51], v[80:83]
    v_add_u32 v26, 63488, v19
    v_mfma_f32_16x16x32_bf16 v[88:91], v[48:51], v[48:51], v[88:91]
    v_add_u32 v27, 63488, v20
    v_add_u32 v28, 63488, v21
    v_mfma_f32_16x16x32_bf16 v[104:107], a[32:35], v[44:47], v[104:107]
    v_add_u32 v29, 63488, v22
    v_mfma_f32_16x16x32_bf16 v[136:139], a[32:35], v[48:51], v[136:139]
    ds_read_b128 v[36:39], v24
    ds_read_b128 v[40:43], v26
    v_mfma_f32_16x16x32_bf16 v[108:111], a[36:39], v[44:47], v[108:111]
    ds_read_b64_tr_b16 a[0:1], v23 offset:0
    v_mfma_f32_16x16x32_bf16 v[140:143], a[36:39], v[48:51], v[140:143]
    ds_read_b64_tr_b16 a[2:3], v23 offset:240
    ds_read_b64_tr_b16 a[4:5], v23 offset:32
    v_mfma_f32_16x16x32_bf16 v[112:115], a[40:43], v[44:47], v[112:115]
    ds_read_b64_tr_b16 a[6:7], v23 offset:272
    v_mfma_f32_16x16x32_bf16 v[144:147], a[40:43], v[48:51], v[144:147]
    ds_read_b64_tr_b16 a[8:9], v23 offset:64
    ds_read_b64_tr_b16 a[10:11], v23 offset:304
    v_mfma_f32_16x16x32_bf16 v[116:119], v[44:47], a[44:47], v[116:119]
    ds_read_b64_tr_b16 a[12:13], v23 offset:80
    v_mfma_f32_16x16x32_bf16 v[148:151], v[48:51], a[44:47], v[148:151]
    ds_read_b64_tr_b16 a[14:15], v23 offset:320
    ds_read_b64_tr_b16 a[16:17], v23 offset:112
    v_mfma_f32_16x16x32_bf16 v[120:123], v[44:47], a[48:51], v[120:123]
    ds_read_b64_tr_b16 a[18:19], v23 offset:352
    v_mfma_f32_16x16x32_bf16 v[152:155], v[48:51], a[48:51], v[152:155]
    ds_read_b64_tr_b16 a[20:21], v23 offset:144
    ds_read_b64_tr_b16 a[22:23], v23 offset:384
    v_mfma_f32_16x16x32_bf16 v[124:127], v[44:47], a[52:55], v[124:127]
    ds_read_b64_tr_b16 a[24:25], v23 offset:176
    v_mfma_f32_16x16x32_bf16 v[156:159], v[48:51], a[52:55], v[156:159]
    ds_read_b64_tr_b16 a[26:27], v23 offset:416
    ds_read_b64_tr_b16 a[28:29], v23 offset:208
    v_mfma_f32_16x16x32_bf16 v[128:131], v[44:47], a[56:59], v[128:131]
    ds_read_b64_tr_b16 a[30:31], v23 offset:448
    v_mfma_f32_16x16x32_bf16 v[160:163], v[48:51], a[56:59], v[160:163]
    ds_read_b64_tr_b16 v[52:53], v28 offset:0
    ds_read_b64_tr_b16 v[54:55], v28 offset:240
    v_mfma_f32_16x16x32_bf16 v[132:135], v[44:47], a[60:63], v[132:135]
    ds_read_b64_tr_b16 v[56:57], v29 offset:0
    ds_read_b64_tr_b16 v[58:59], v29 offset:240
    v_mfma_f32_16x16x32_bf16 v[164:167], v[48:51], a[60:63], v[164:167]
    v_mfma_f32_16x16x32_bf16 v[68:71], v[32:35], v[60:63], v[68:71]
    v_mfma_f32_16x16x32_bf16 v[72:75], v[32:35], v[64:67], v[72:75]
    s_waitcnt lgkmcnt(0)
    v_mfma_f32_16x16x32_bf16 v[76:79], v[32:35], v[36:39], v[76:79]
    ds_read_b128 v[44:47], v25
    v_mfma_f32_16x16x32_bf16 v[84:87], v[36:39], v[36:39], v[84:87]
    ds_read_b128 v[48:51], v27
    v_mfma_f32_16x16x32_bf16 v[80:83], v[32:35], v[40:43], v[80:83]
    ds_read_b64_tr_b16 a[32:33], v23 offset:7680
    v_mfma_f32_16x16x32_bf16 v[88:91], v[40:43], v[40:43], v[88:91]
    ds_read_b64_tr_b16 a[34:35], v23 offset:7920
    v_mfma_f32_16x16x32_bf16 v[104:107], a[0:3], v[36:39], v[104:107]
    ds_read_b64_tr_b16 a[36:37], v23 offset:7712
    v_mfma_f32_16x16x32_bf16 v[136:139], a[0:3], v[40:43], v[136:139]
    ds_read_b64_tr_b16 a[38:39], v23 offset:7952
    v_mfma_f32_16x16x32_bf16 v[108:111], a[4:7], v[36:39], v[108:111]
    ds_read_b64_tr_b16 a[40:41], v23 offset:7744
    ds_read_b64_tr_b16 a[42:43], v23 offset:7984
    v_mfma_f32_16x16x32_bf16 v[140:143], a[4:7], v[40:43], v[140:143]
    ds_read_b64_tr_b16 a[44:45], v23 offset:7760
    v_mfma_f32_16x16x32_bf16 v[112:115], a[8:11], v[36:39], v[112:115]
    ds_read_b64_tr_b16 a[46:47], v23 offset:8000
    v_mfma_f32_16x16x32_bf16 v[144:147], a[8:11], v[40:43], v[144:147]
    ds_read_b64_tr_b16 a[48:49], v23 offset:7792
    v_mfma_f32_16x16x32_bf16 v[116:119], v[36:39], a[12:15], v[116:119]
    ds_read_b64_tr_b16 a[50:51], v23 offset:8032
    v_mfma_f32_16x16x32_bf16 v[148:151], v[40:43], a[12:15], v[148:151]
    ds_read_b64_tr_b16 a[52:53], v23 offset:7824
    v_mfma_f32_16x16x32_bf16 v[120:123], v[36:39], a[16:19], v[120:123]
    ds_read_b64_tr_b16 a[54:55], v23 offset:8064
    ds_read_b64_tr_b16 a[56:57], v23 offset:7856
    v_mfma_f32_16x16x32_bf16 v[152:155], v[40:43], a[16:19], v[152:155]
    ds_read_b64_tr_b16 a[58:59], v23 offset:8096
    v_mfma_f32_16x16x32_bf16 v[124:127], v[36:39], a[20:23], v[124:127]
    ds_read_b64_tr_b16 a[60:61], v23 offset:7888
    v_mfma_f32_16x16x32_bf16 v[156:159], v[40:43], a[20:23], v[156:159]
    ds_read_b64_tr_b16 a[62:63], v23 offset:8128
    v_mfma_f32_16x16x32_bf16 v[128:131], v[36:39], a[24:27], v[128:131]
    ds_read_b64_tr_b16 v[60:61], v28 offset:7680
    v_mfma_f32_16x16x32_bf16 v[160:163], v[40:43], a[24:27], v[160:163]
    ds_read_b64_tr_b16 v[62:63], v28 offset:7920
    v_mfma_f32_16x16x32_bf16 v[132:135], v[36:39], a[28:31], v[132:135]
    ds_read_b64_tr_b16 v[64:65], v29 offset:7680
    ds_read_b64_tr_b16 v[66:67], v29 offset:7920
    v_mfma_f32_16x16x32_bf16 v[164:167], v[40:43], a[28:31], v[164:167]
    v_mfma_f32_16x16x32_bf16 v[68:71], v[32:35], v[52:55], v[68:71]
    v_mfma_f32_16x16x32_bf16 v[72:75], v[32:35], v[56:59], v[72:75]
    s_waitcnt lgkmcnt(0)
    s_barrier
    v_mfma_f32_16x16x32_bf16 v[76:79], v[32:35], v[44:47], v[76:79]
    v_add_u32 v23, 95232, v16
    v_mfma_f32_16x16x32_bf16 v[84:87], v[44:47], v[44:47], v[84:87]
    v_add_u32 v24, 95232, v17
    v_add_u32 v25, 95232, v18
    v_mfma_f32_16x16x32_bf16 v[80:83], v[32:35], v[48:51], v[80:83]
    v_add_u32 v26, 95232, v19
    v_mfma_f32_16x16x32_bf16 v[88:91], v[48:51], v[48:51], v[88:91]
    v_add_u32 v27, 95232, v20
    v_add_u32 v28, 95232, v21
    v_mfma_f32_16x16x32_bf16 v[104:107], a[32:35], v[44:47], v[104:107]
    v_add_u32 v29, 95232, v22
    v_mfma_f32_16x16x32_bf16 v[136:139], a[32:35], v[48:51], v[136:139]
    ds_read_b128 v[36:39], v24
    ds_read_b128 v[40:43], v26
    v_mfma_f32_16x16x32_bf16 v[108:111], a[36:39], v[44:47], v[108:111]
    ds_read_b64_tr_b16 a[0:1], v23 offset:0
    v_mfma_f32_16x16x32_bf16 v[140:143], a[36:39], v[48:51], v[140:143]
    ds_read_b64_tr_b16 a[2:3], v23 offset:240
    ds_read_b64_tr_b16 a[4:5], v23 offset:32
    v_mfma_f32_16x16x32_bf16 v[112:115], a[40:43], v[44:47], v[112:115]
    ds_read_b64_tr_b16 a[6:7], v23 offset:272
    v_mfma_f32_16x16x32_bf16 v[144:147], a[40:43], v[48:51], v[144:147]
    ds_read_b64_tr_b16 a[8:9], v23 offset:64
    ds_read_b64_tr_b16 a[10:11], v23 offset:304
    v_mfma_f32_16x16x32_bf16 v[116:119], v[44:47], a[44:47], v[116:119]
    ds_read_b64_tr_b16 a[12:13], v23 offset:80
    v_mfma_f32_16x16x32_bf16 v[148:151], v[48:51], a[44:47], v[148:151]
    ds_read_b64_tr_b16 a[14:15], v23 offset:320
    ds_read_b64_tr_b16 a[16:17], v23 offset:112
    v_mfma_f32_16x16x32_bf16 v[120:123], v[44:47], a[48:51], v[120:123]
    ds_read_b64_tr_b16 a[18:19], v23 offset:352
    v_mfma_f32_16x16x32_bf16 v[152:155], v[48:51], a[48:51], v[152:155]
    ds_read_b64_tr_b16 a[20:21], v23 offset:144
    ds_read_b64_tr_b16 a[22:23], v23 offset:384
    v_mfma_f32_16x16x32_bf16 v[124:127], v[44:47], a[52:55], v[124:127]
    ds_read_b64_tr_b16 a[24:25], v23 offset:176
    v_mfma_f32_16x16x32_bf16 v[156:159], v[48:51], a[52:55], v[156:159]
    ds_read_b64_tr_b16 a[26:27], v23 offset:416
    ds_read_b64_tr_b16 a[28:29], v23 offset:208
    v_mfma_f32_16x16x32_bf16 v[128:131], v[44:47], a[56:59], v[128:131]
    ds_read_b64_tr_b16 a[30:31], v23 offset:448
    v_mfma_f32_16x16x32_bf16 v[160:163], v[48:51], a[56:59], v[160:163]
    ds_read_b64_tr_b16 v[52:53], v28 offset:0
    ds_read_b64_tr_b16 v[54:55], v28 offset:240
    v_mfma_f32_16x16x32_bf16 v[132:135], v[44:47], a[60:63], v[132:135]
    ds_read_b64_tr_b16 v[56:57], v29 offset:0
    ds_read_b64_tr_b16 v[58:59], v29 offset:240
    v_mfma_f32_16x16x32_bf16 v[164:167], v[48:51], a[60:63], v[164:167]
    v_mfma_f32_16x16x32_bf16 v[68:71], v[32:35], v[60:63], v[68:71]
    v_mfma_f32_16x16x32_bf16 v[72:75], v[32:35], v[64:67], v[72:75]
    s_waitcnt lgkmcnt(0)
    v_mfma_f32_16x16x32_bf16 v[76:79], v[32:35], v[36:39], v[76:79]
    ds_read_b128 v[44:47], v25
    v_mfma_f32_16x16x32_bf16 v[84:87], v[36:39], v[36:39], v[84:87]
    ds_read_b128 v[48:51], v27
    v_mfma_f32_16x16x32_bf16 v[80:83], v[32:35], v[40:43], v[80:83]
    ds_read_b64_tr_b16 a[32:33], v23 offset:7680
    v_mfma_f32_16x16x32_bf16 v[88:91], v[40:43], v[40:43], v[88:91]
    ds_read_b64_tr_b16 a[34:35], v23 offset:7920
    v_mfma_f32_16x16x32_bf16 v[104:107], a[0:3], v[36:39], v[104:107]
    ds_read_b64_tr_b16 a[36:37], v23 offset:7712
    v_mfma_f32_16x16x32_bf16 v[136:139], a[0:3], v[40:43], v[136:139]
    ds_read_b64_tr_b16 a[38:39], v23 offset:7952
    v_mfma_f32_16x16x32_bf16 v[108:111], a[4:7], v[36:39], v[108:111]
    ds_read_b64_tr_b16 a[40:41], v23 offset:7744
    ds_read_b64_tr_b16 a[42:43], v23 offset:7984
    v_mfma_f32_16x16x32_bf16 v[140:143], a[4:7], v[40:43], v[140:143]
    ds_read_b64_tr_b16 a[44:45], v23 offset:7760
    v_mfma_f32_16x16x32_bf16 v[112:115], a[8:11], v[36:39], v[112:115]
    ds_read_b64_tr_b16 a[46:47], v23 offset:8000
    v_mfma_f32_16x16x32_bf16 v[144:147], a[8:11], v[40:43], v[144:147]
    ds_read_b64_tr_b16 a[48:49], v23 offset:7792
    v_mfma_f32_16x16x32_bf16 v[116:119], v[36:39], a[12:15], v[116:119]
    ds_read_b64_tr_b16 a[50:51], v23 offset:8032
    v_mfma_f32_16x16x32_bf16 v[148:151], v[40:43], a[12:15], v[148:151]
    ds_read_b64_tr_b16 a[52:53], v23 offset:7824
    v_mfma_f32_16x16x32_bf16 v[120:123], v[36:39], a[16:19], v[120:123]
    ds_read_b64_tr_b16 a[54:55], v23 offset:8064
    ds_read_b64_tr_b16 a[56:57], v23 offset:7856
    v_mfma_f32_16x16x32_bf16 v[152:155], v[40:43], a[16:19], v[152:155]
    ds_read_b64_tr_b16 a[58:59], v23 offset:8096
    v_mfma_f32_16x16x32_bf16 v[124:127], v[36:39], a[20:23], v[124:127]
    ds_read_b64_tr_b16 a[60:61], v23 offset:7888
    v_mfma_f32_16x16x32_bf16 v[156:159], v[40:43], a[20:23], v[156:159]
    ds_read_b64_tr_b16 a[62:63], v23 offset:8128
    v_mfma_f32_16x16x32_bf16 v[128:131], v[36:39], a[24:27], v[128:131]
    ds_read_b64_tr_b16 v[60:61], v28 offset:7680
    v_mfma_f32_16x16x32_bf16 v[160:163], v[40:43], a[24:27], v[160:163]
    ds_read_b64_tr_b16 v[62:63], v28 offset:7920
    v_mfma_f32_16x16x32_bf16 v[132:135], v[36:39], a[28:31], v[132:135]
    ds_read_b64_tr_b16 v[64:65], v29 offset:7680
    ds_read_b64_tr_b16 v[66:67], v29 offset:7920
    v_mfma_f32_16x16x32_bf16 v[164:167], v[40:43], a[28:31], v[164:167]
    v_mfma_f32_16x16x32_bf16 v[68:71], v[32:35], v[52:55], v[68:71]
    v_mfma_f32_16x16x32_bf16 v[72:75], v[32:35], v[56:59], v[72:75]
    s_waitcnt lgkmcnt(0)
    s_barrier
    v_mfma_f32_16x16x32_bf16 v[76:79], v[32:35], v[44:47], v[76:79]
    v_add_u32 v23, 0, v16
    v_mfma_f32_16x16x32_bf16 v[84:87], v[44:47], v[44:47], v[84:87]
    v_add_u32 v24, 0, v17
    v_add_u32 v25, 0, v18
    v_mfma_f32_16x16x32_bf16 v[80:83], v[32:35], v[48:51], v[80:83]
    v_add_u32 v26, 0, v19
    v_mfma_f32_16x16x32_bf16 v[88:91], v[48:51], v[48:51], v[88:91]
    v_add_u32 v27, 0, v20
    v_add_u32 v28, 0, v21
    v_mfma_f32_16x16x32_bf16 v[104:107], a[32:35], v[44:47], v[104:107]
    v_add_u32 v29, 0, v22
    v_mfma_f32_16x16x32_bf16 v[136:139], a[32:35], v[48:51], v[136:139]
    ds_read_b128 v[36:39], v24
    ds_read_b128 v[40:43], v26
    v_mfma_f32_16x16x32_bf16 v[108:111], a[36:39], v[44:47], v[108:111]
    ds_read_b64_tr_b16 a[0:1], v23 offset:0
    v_mfma_f32_16x16x32_bf16 v[140:143], a[36:39], v[48:51], v[140:143]
    ds_read_b64_tr_b16 a[2:3], v23 offset:240
    ds_read_b64_tr_b16 a[4:5], v23 offset:32
    v_mfma_f32_16x16x32_bf16 v[112:115], a[40:43], v[44:47], v[112:115]
    ds_read_b64_tr_b16 a[6:7], v23 offset:272
    v_mfma_f32_16x16x32_bf16 v[144:147], a[40:43], v[48:51], v[144:147]
    ds_read_b64_tr_b16 a[8:9], v23 offset:64
    ds_read_b64_tr_b16 a[10:11], v23 offset:304
    v_mfma_f32_16x16x32_bf16 v[116:119], v[44:47], a[44:47], v[116:119]
    ds_read_b64_tr_b16 a[12:13], v23 offset:80
    v_mfma_f32_16x16x32_bf16 v[148:151], v[48:51], a[44:47], v[148:151]
    ds_read_b64_tr_b16 a[14:15], v23 offset:320
    ds_read_b64_tr_b16 a[16:17], v23 offset:112
    v_mfma_f32_16x16x32_bf16 v[120:123], v[44:47], a[48:51], v[120:123]
    ds_read_b64_tr_b16 a[18:19], v23 offset:352
    v_mfma_f32_16x16x32_bf16 v[152:155], v[48:51], a[48:51], v[152:155]
    ds_read_b64_tr_b16 a[20:21], v23 offset:144
    ds_read_b64_tr_b16 a[22:23], v23 offset:384
    v_mfma_f32_16x16x32_bf16 v[124:127], v[44:47], a[52:55], v[124:127]
    ds_read_b64_tr_b16 a[24:25], v23 offset:176
    v_mfma_f32_16x16x32_bf16 v[156:159], v[48:51], a[52:55], v[156:159]
    ds_read_b64_tr_b16 a[26:27], v23 offset:416
    ds_read_b64_tr_b16 a[28:29], v23 offset:208
    v_mfma_f32_16x16x32_bf16 v[128:131], v[44:47], a[56:59], v[128:131]
    ds_read_b64_tr_b16 a[30:31], v23 offset:448
    v_mfma_f32_16x16x32_bf16 v[160:163], v[48:51], a[56:59], v[160:163]
    ds_read_b64_tr_b16 v[52:53], v28 offset:0
    ds_read_b64_tr_b16 v[54:55], v28 offset:240
    v_mfma_f32_16x16x32_bf16 v[132:135], v[44:47], a[60:63], v[132:135]
    ds_read_b64_tr_b16 v[56:57], v29 offset:0
    ds_read_b64_tr_b16 v[58:59], v29 offset:240
    v_mfma_f32_16x16x32_bf16 v[164:167], v[48:51], a[60:63], v[164:167]
    v_mfma_f32_16x16x32_bf16 v[68:71], v[32:35], v[60:63], v[68:71]
    v_mfma_f32_16x16x32_bf16 v[72:75], v[32:35], v[64:67], v[72:75]
    s_waitcnt lgkmcnt(0)
    v_mfma_f32_16x16x32_bf16 v[76:79], v[32:35], v[36:39], v[76:79]
    ds_read_b128 v[44:47], v25
    v_mfma_f32_16x16x32_bf16 v[84:87], v[36:39], v[36:39], v[84:87]
    ds_read_b128 v[48:51], v27
    v_mfma_f32_16x16x32_bf16 v[80:83], v[32:35], v[40:43], v[80:83]
    ds_read_b64_tr_b16 a[32:33], v23 offset:7680
    v_mfma_f32_16x16x32_bf16 v[88:91], v[40:43], v[40:43], v[88:91]
    ds_read_b64_tr_b16 a[34:35], v23 offset:7920
    v_mfma_f32_16x16x32_bf16 v[104:107], a[0:3], v[36:39], v[104:107]
    ds_read_b64_tr_b16 a[36:37], v23 offset:7712
    v_mfma_f32_16x16x32_bf16 v[136:139], a[0:3], v[40:43], v[136:139]
    ds_read_b64_tr_b16 a[38:39], v23 offset:7952
    v_mfma_f32_16x16x32_bf16 v[108:111], a[4:7], v[36:39], v[108:111]
    ds_read_b64_tr_b16 a[40:41], v23 offset:7744
    ds_read_b64_tr_b16 a[42:43], v23 offset:7984
    v_mfma_f32_16x16x32_bf16 v[140:143], a[4:7], v[40:43], v[140:143]
    ds_read_b64_tr_b16 a[44:45], v23 offset:7760
    v_mfma_f32_16x16x32_bf16 v[112:115], a[8:11], v[36:39], v[112:115]
    ds_read_b64_tr_b16 a[46:47], v23 offset:8000
    v_mfma_f32_16x16x32_bf16 v[144:147], a[8:11], v[40:43], v[144:147]
    ds_read_b64_tr_b16 a[48:49], v23 offset:7792
    v_mfma_f32_16x16x32_bf16 v[116:119], v[36:39], a[12:15], v[116:119]
    ds_read_b64_tr_b16 a[50:51], v23 offset:8032
    v_mfma_f32_16x16x32_bf16 v[148:151], v[40:43], a[12:15], v[148:151]
    ds_read_b64_tr_b16 a[52:53], v23 offset:7824
    v_mfma_f32_16x16x32_bf16 v[120:123], v[36:39], a[16:19], v[120:123]
    ds_read_b64_tr_b16 a[54:55], v23 offset:8064
    ds_read_b64_tr_b16 a[56:57], v23 offset:7856
    v_mfma_f32_16x16x32_bf16 v[152:155], v[40:43], a[16:19], v[152:155]
    ds_read_b64_tr_b16 a[58:59], v23 offset:8096
    v_mfma_f32_16x16x32_bf16 v[124:127], v[36:39], a[20:23], v[124:127]
    ds_read_b64_tr_b16 a[60:61], v23 offset:7888
    v_mfma_f32_16x16x32_bf16 v[156:159], v[40:43], a[20:23], v[156:159]
    ds_read_b64_tr_b16 a[62:63], v23 offset:8128
    v_mfma_f32_16x16x32_bf16 v[128:131], v[36:39], a[24:27], v[128:131]
    ds_read_b64_tr_b16 v[60:61], v28 offset:7680
    v_mfma_f32_16x16x32_bf16 v[160:163], v[40:43], a[24:27], v[160:163]
    ds_read_b64_tr_b16 v[62:63], v28 offset:7920
    v_mfma_f32_16x16x32_bf16 v[132:135], v[36:39], a[28:31], v[132:135]
    ds_read_b64_tr_b16 v[64:65], v29 offset:7680
    ds_read_b64_tr_b16 v[66:67], v29 offset:7920
    v_mfma_f32_16x16x32_bf16 v[164:167], v[40:43], a[28:31], v[164:167]
    v_mfma_f32_16x16x32_bf16 v[68:71], v[32:35], v[52:55], v[68:71]
    v_mfma_f32_16x16x32_bf16 v[72:75], v[32:35], v[56:59], v[72:75]
    s_waitcnt lgkmcnt(0)
    s_barrier
    v_mfma_f32_16x16x32_bf16 v[76:79], v[32:35], v[44:47], v[76:79]
    v_add_u32 v23, 31744, v16
    v_mfma_f32_16x16x32_bf16 v[84:87], v[44:47], v[44:47], v[84:87]
    v_add_u32 v24, 31744, v17
    v_add_u32 v25, 31744, v18
    v_mfma_f32_16x16x32_bf16 v[80:83], v[32:35], v[48:51], v[80:83]
    v_add_u32 v26, 31744, v19
    v_mfma_f32_16x16x32_bf16 v[88:91], v[48:51], v[48:51], v[88:91]
    v_add_u32 v27, 31744, v20
    v_add_u32 v28, 31744, v21
    v_mfma_f32_16x16x32_bf16 v[104:107], a[32:35], v[44:47], v[104:107]
    v_add_u32 v29, 31744, v22
    v_mfma_f32_16x16x32_bf16 v[136:139], a[32:35], v[48:51], v[136:139]
    ds_read_b128 v[36:39], v24
    ds_read_b128 v[40:43], v26
    v_mfma_f32_16x16x32_bf16 v[108:111], a[36:39], v[44:47], v[108:111]
    ds_read_b64_tr_b16 a[0:1], v23 offset:0
    v_mfma_f32_16x16x32_bf16 v[140:143], a[36:39], v[48:51], v[140:143]
    ds_read_b64_tr_b16 a[2:3], v23 offset:240
    ds_read_b64_tr_b16 a[4:5], v23 offset:32
    v_mfma_f32_16x16x32_bf16 v[112:115], a[40:43], v[44:47], v[112:115]
    ds_read_b64_tr_b16 a[6:7], v23 offset:272
    v_mfma_f32_16x16x32_bf16 v[144:147], a[40:43], v[48:51], v[144:147]
    ds_read_b64_tr_b16 a[8:9], v23 offset:64
    ds_read_b64_tr_b16 a[10:11], v23 offset:304
    v_mfma_f32_16x16x32_bf16 v[116:119], v[44:47], a[44:47], v[116:119]
    ds_read_b64_tr_b16 a[12:13], v23 offset:80
    v_mfma_f32_16x16x32_bf16 v[148:151], v[48:51], a[44:47], v[148:151]
    ds_read_b64_tr_b16 a[14:15], v23 offset:320
    ds_read_b64_tr_b16 a[16:17], v23 offset:112
    v_mfma_f32_16x16x32_bf16 v[120:123], v[44:47], a[48:51], v[120:123]
    ds_read_b64_tr_b16 a[18:19], v23 offset:352
    v_mfma_f32_16x16x32_bf16 v[152:155], v[48:51], a[48:51], v[152:155]
    ds_read_b64_tr_b16 a[20:21], v23 offset:144
    ds_read_b64_tr_b16 a[22:23], v23 offset:384
    v_mfma_f32_16x16x32_bf16 v[124:127], v[44:47], a[52:55], v[124:127]
    ds_read_b64_tr_b16 a[24:25], v23 offset:176
    v_mfma_f32_16x16x32_bf16 v[156:159], v[48:51], a[52:55], v[156:159]
    ds_read_b64_tr_b16 a[26:27], v23 offset:416
    ds_read_b64_tr_b16 a[28:29], v23 offset:208
    v_mfma_f32_16x16x32_bf16 v[128:131], v[44:47], a[56:59], v[128:131]
    ds_read_b64_tr_b16 a[30:31], v23 offset:448
    v_mfma_f32_16x16x32_bf16 v[160:163], v[48:51], a[56:59], v[160:163]
    ds_read_b64_tr_b16 v[52:53], v28 offset:0
    ds_read_b64_tr_b16 v[54:55], v28 offset:240
    v_mfma_f32_16x16x32_bf16 v[132:135], v[44:47], a[60:63], v[132:135]
    ds_read_b64_tr_b16 v[56:57], v29 offset:0
    ds_read_b64_tr_b16 v[58:59], v29 offset:240
    v_mfma_f32_16x16x32_bf16 v[164:167], v[48:51], a[60:63], v[164:167]
    v_mfma_f32_16x16x32_bf16 v[68:71], v[32:35], v[60:63], v[68:71]
    v_mfma_f32_16x16x32_bf16 v[72:75], v[32:35], v[64:67], v[72:75]
    s_waitcnt lgkmcnt(0)
    v_mfma_f32_16x16x32_bf16 v[76:79], v[32:35], v[36:39], v[76:79]
    ds_read_b128 v[44:47], v25
    v_mfma_f32_16x16x32_bf16 v[84:87], v[36:39], v[36:39], v[84:87]
    ds_read_b128 v[48:51], v27
    v_mfma_f32_16x16x32_bf16 v[80:83], v[32:35], v[40:43], v[80:83]
    ds_read_b64_tr_b16 a[32:33], v23 offset:7680
    v_mfma_f32_16x16x32_bf16 v[88:91], v[40:43], v[40:43], v[88:91]
    ds_read_b64_tr_b16 a[34:35], v23 offset:7920
    v_mfma_f32_16x16x32_bf16 v[104:107], a[0:3], v[36:39], v[104:107]
    ds_read_b64_tr_b16 a[36:37], v23 offset:7712
    v_mfma_f32_16x16x32_bf16 v[136:139], a[0:3], v[40:43], v[136:139]
    ds_read_b64_tr_b16 a[38:39], v23 offset:7952
    v_mfma_f32_16x16x32_bf16 v[108:111], a[4:7], v[36:39], v[108:111]
    ds_read_b64_tr_b16 a[40:41], v23 offset:7744
    ds_read_b64_tr_b16 a[42:43], v23 offset:7984
    v_mfma_f32_16x16x32_bf16 v[140:143], a[4:7], v[40:43], v[140:143]
    ds_read_b64_tr_b16 a[44:45], v23 offset:7760
    v_mfma_f32_16x16x32_bf16 v[112:115], a[8:11], v[36:39], v[112:115]
    ds_read_b64_tr_b16 a[46:47], v23 offset:8000
    v_mfma_f32_16x16x32_bf16 v[144:147], a[8:11], v[40:43], v[144:147]
    ds_read_b64_tr_b16 a[48:49], v23 offset:7792
    v_mfma_f32_16x16x32_bf16 v[116:119], v[36:39], a[12:15], v[116:119]
    ds_read_b64_tr_b16 a[50:51], v23 offset:8032
    v_mfma_f32_16x16x32_bf16 v[148:151], v[40:43], a[12:15], v[148:151]
    ds_read_b64_tr_b16 a[52:53], v23 offset:7824
    v_mfma_f32_16x16x32_bf16 v[120:123], v[36:39], a[16:19], v[120:123]
    ds_read_b64_tr_b16 a[54:55], v23 offset:8064
    ds_read_b64_tr_b16 a[56:57], v23 offset:7856
    v_mfma_f32_16x16x32_bf16 v[152:155], v[40:43], a[16:19], v[152:155]
    ds_read_b64_tr_b16 a[58:59], v23 offset:8096
    v_mfma_f32_16x16x32_bf16 v[124:127], v[36:39], a[20:23], v[124:127]
    ds_read_b64_tr_b16 a[60:61], v23 offset:7888
    v_mfma_f32_16x16x32_bf16 v[156:159], v[40:43], a[20:23], v[156:159]
    ds_read_b64_tr_b16 a[62:63], v23 offset:8128
    v_mfma_f32_16x16x32_bf16 v[128:131], v[36:39], a[24:27], v[128:131]
    ds_read_b64_tr_b16 v[60:61], v28 offset:7680
    v_mfma_f32_16x16x32_bf16 v[160:163], v[40:43], a[24:27], v[160:163]
    ds_read_b64_tr_b16 v[62:63], v28 offset:7920
    v_mfma_f32_16x16x32_bf16 v[132:135], v[36:39], a[28:31], v[132:135]
    ds_read_b64_tr_b16 v[64:65], v29 offset:7680
    ds_read_b64_tr_b16 v[66:67], v29 offset:7920
    v_mfma_f32_16x16x32_bf16 v[164:167], v[40:43], a[28:31], v[164:167]
    v_mfma_f32_16x16x32_bf16 v[68:71], v[32:35], v[52:55], v[68:71]
    v_mfma_f32_16x16x32_bf16 v[72:75], v[32:35], v[56:59], v[72:75]
    s_waitcnt lgkmcnt(0)
    v_mfma_f32_16x16x32_bf16 v[76:79], v[32:35], v[44:47], v[76:79]
    v_mfma_f32_16x16x32_bf16 v[84:87], v[44:47], v[44:47], v[84:87]
    v_mfma_f32_16x16x32_bf16 v[80:83], v[32:35], v[48:51], v[80:83]
    v_mfma_f32_16x16x32_bf16 v[88:91], v[48:51], v[48:51], v[88:91]
    v_mfma_f32_16x16x32_bf16 v[104:107], a[32:35], v[44:47], v[104:107]
    v_mfma_f32_16x16x32_bf16 v[136:139], a[32:35], v[48:51], v[136:139]
    v_mfma_f32_16x16x32_bf16 v[108:111], a[36:39], v[44:47], v[108:111]
    v_mfma_f32_16x16x32_bf16 v[140:143], a[36:39], v[48:51], v[140:143]
    v_mfma_f32_16x16x32_bf16 v[112:115], a[40:43], v[44:47], v[112:115]
    v_mfma_f32_16x16x32_bf16 v[144:147], a[40:43], v[48:51], v[144:147]
    v_mfma_f32_16x16x32_bf16 v[116:119], v[44:47], a[44:47], v[116:119]
    v_mfma_f32_16x16x32_bf16 v[148:151], v[48:51], a[44:47], v[148:151]
    v_mfma_f32_16x16x32_bf16 v[120:123], v[44:47], a[48:51], v[120:123]
    v_mfma_f32_16x16x32_bf16 v[152:155], v[48:51], a[48:51], v[152:155]
    v_mfma_f32_16x16x32_bf16 v[124:127], v[44:47], a[52:55], v[124:127]
    v_mfma_f32_16x16x32_bf16 v[156:159], v[48:51], a[52:55], v[156:159]
    v_mfma_f32_16x16x32_bf16 v[128:131], v[44:47], a[56:59], v[128:131]
    v_mfma_f32_16x16x32_bf16 v[160:163], v[48:51], a[56:59], v[160:163]
    v_mfma_f32_16x16x32_bf16 v[132:135], v[44:47], a[60:63], v[132:135]
    v_mfma_f32_16x16x32_bf16 v[164:167], v[48:51], a[60:63], v[164:167]
    v_mfma_f32_16x16x32_bf16 v[68:71], v[32:35], v[60:63], v[68:71]
    v_mfma_f32_16x16x32_bf16 v[72:75], v[32:35], v[64:67], v[72:75]
    s_nop 7
    v_mov_b32 v12, v76
    v_mov_b32 v14, 0
    s_mov_b32 exec_lo, 0x100001
    s_mov_b32 exec_hi, 0x10000100
    v_mov_b32 v14, v84
    s_mov_b32 exec_lo, 0x200002
    s_mov_b32 exec_hi, 0x20000200
    v_mov_b32 v14, v85
    s_mov_b32 exec_lo, 0x400004
    s_mov_b32 exec_hi, 0x40000400
    v_mov_b32 v14, v86
    s_mov_b32 exec_lo, 0x800008
    s_mov_b32 exec_hi, 0x80000800
    v_mov_b32 v14, v87
    s_mov_b64 exec, -1
    v_mov_b32 v13, v80
    v_mov_b32 v15, 0
    s_mov_b32 exec_lo, 0x100001
    s_mov_b32 exec_hi, 0x10000100
    v_mov_b32 v15, v88
    s_mov_b32 exec_lo, 0x200002
    s_mov_b32 exec_hi, 0x20000200
    v_mov_b32 v15, v89
    s_mov_b32 exec_lo, 0x400004
    s_mov_b32 exec_hi, 0x40000400
    v_mov_b32 v15, v90
    s_mov_b32 exec_lo, 0x800008
    s_mov_b32 exec_hi, 0x80000800
    v_mov_b32 v15, v91
    s_mov_b64 exec, -1
    v_mov_b32 v4, v14
    s_nop 1
    v_permlane32_swap_b32 v14, v4
    v_add_f32 v14, v14, v4
    v_mov_b32 v4, v14
    s_nop 1
    v_permlane16_swap_b32 v14, v4
    v_add_f32 v14, v14, v4
    v_mov_b32 v4, v15
    s_nop 1
    v_permlane32_swap_b32 v15, v4
    v_add_f32 v15, v15, v4
    v_mov_b32 v4, v15
    s_nop 1
    v_permlane16_swap_b32 v15, v4
    v_add_f32 v15, v15, v4
    s_mov_b32 s48, 0x3acccccd
    s_mov_b32 s49, 0x3727c5ac
    v_mul_f32 v12, s48, v12
    v_mul_f32 v14, s48, v14
    v_fma_f32 v14, -v12, v12, v14
    v_max_f32 v14, 0, v14
    v_add_f32 v14, s49, v14
    v_rsq_f32 v14, v14
    s_nop 0
    v_mul_f32 v12, v12, v14
    v_sub_f32 v12, 0, v12
    v_mul_f32 v13, s48, v13
    v_mul_f32 v15, s48, v15
    v_fma_f32 v15, -v13, v13, v15
    v_max_f32 v15, 0, v15
    v_add_f32 v15, s49, v15
    v_rsq_f32 v15, v15
    s_nop 0
    v_mul_f32 v13, v13, v15
    v_sub_f32 v13, 0, v13
    s_lshl_b32 s48, s42, 7
    s_add_u32 s48, s48, 63488
    v_lshl_add_u32 v5, v2, 2, s48
    s_lshl_b32 s48, s42, 8
    s_add_u32 s48, s48, 65536
    v_lshl_add_u32 v6, v2, 2, s48
    v_lshl_add_u32 v7, v3, 4, s48
    s_mov_b32 exec_lo, 0xffff
    s_mov_b32 exec_hi, 0x0
    ds_write_b32 v5, v68 offset:0
    ds_write_b32 v5, v72 offset:64
    ds_write_b32 v6, v14 offset:0
    ds_write_b32 v6, v12 offset:64
    ds_write_b32 v6, v15 offset:128
    ds_write_b32 v6, v13 offset:192
    s_mov_b64 exec, -1
    s_lshl_b32 s48, s41, 2
    v_mov_b32 v10, s48
    buffer_load_dword v11, v10, s[28:31], 0 offen offset:64 sc1
    s_waitcnt lgkmcnt(0)
    s_barrier
    v_lshlrev_b32 v4, 4, v3
    v_lshlrev_b32 v5, 2, v2
    v_add_u32 v4, 63488, v4
    v_add_u32 v5, 63488, v5
    ds_read_b32 v36, v5 offset:192
    ds_read_b32 v38, v5 offset:256
    ds_read_b32 v40, v5 offset:320
    ds_read_b32 v42, v5 offset:384
    ds_read_b32 v44, v5 offset:448
    ds_read_b128 v[46:49], v7 offset:0
    ds_read_b128 v[50:53], v7 offset:64
    ds_read_b128 v[54:57], v7 offset:128
    ds_read_b128 v[58:61], v7 offset:192
    ds_read_b128 v[62:65], v4 offset:0
    ds_read_b128 v[66:69], v4 offset:64
    ds_read_b128 v[70:73], v4 offset:128
    s_mov_b32 s52, 0x3fb8aa3b
    s_mov_b32 s53, 0x3fb8aa3b
    s_mov_b32 s54, 0x358637bd
    s_mov_b32 s55, 0x358637bd
    s_waitcnt lgkmcnt(3)
    s_mov_b32 s56, 0x00ff00ff
    s_mov_b32 s57, 0x00ff00ff
    v_pk_mul_f32 v[94:95], v[50:51], v[36:37] op_sel_hi:[1,0]
    v_pk_fma_f32 v[116:117], v[116:117], v[46:47], v[94:95]
    v_pk_mul_f32 v[96:97], v[52:53], v[36:37] op_sel_hi:[1,0]
    v_pk_fma_f32 v[118:119], v[118:119], v[48:49], v[96:97]
    v_min_f32 v98, 0, v116
    v_min_f32 v99, 0, v117
    v_min_f32 v100, 0, v118
    v_min_f32 v101, 0, v119
    v_pk_mul_f32 v[98:99], v[98:99], s[52:53]
    v_pk_mul_f32 v[100:101], v[100:101], s[52:53]
    v_max_f32 v116, 0, v116
    v_max_f32 v117, 0, v117
    v_max_f32 v118, 0, v118
    v_max_f32 v119, 0, v119
    v_exp_f32 v98, v98
    v_exp_f32 v99, v99
    v_exp_f32 v100, v100
    v_exp_f32 v101, v101
    v_pk_add_f32 v[116:117], v[116:117], s[54:55]
    v_pk_add_f32 v[118:119], v[118:119], s[54:55]
    v_pk_add_f32 v[116:117], v[116:117], v[98:99]
    v_pk_add_f32 v[118:119], v[118:119], v[100:101]
    v_cvt_pk_bf16_f32 v74, v116, v117
    v_cvt_pk_bf16_f32 v75, v118, v119
    v_pk_mul_f32 v[94:95], v[58:59], v[36:37] op_sel_hi:[1,0]
    v_pk_fma_f32 v[148:149], v[148:149], v[54:55], v[94:95]
    v_pk_mul_f32 v[96:97], v[60:61], v[36:37] op_sel_hi:[1,0]
    v_pk_fma_f32 v[150:151], v[150:151], v[56:57], v[96:97]
    v_min_f32 v98, 0, v148
    v_min_f32 v99, 0, v149
    v_min_f32 v100, 0, v150
    v_min_f32 v101, 0, v151
    v_pk_mul_f32 v[98:99], v[98:99], s[52:53]
    v_pk_mul_f32 v[100:101], v[100:101], s[52:53]
    v_max_f32 v148, 0, v148
    v_max_f32 v149, 0, v149
    v_max_f32 v150, 0, v150
    v_max_f32 v151, 0, v151
    v_exp_f32 v98, v98
    v_exp_f32 v99, v99
    v_exp_f32 v100, v100
    v_exp_f32 v101, v101
    v_pk_add_f32 v[148:149], v[148:149], s[54:55]
    v_pk_add_f32 v[150:151], v[150:151], s[54:55]
    v_pk_add_f32 v[148:149], v[148:149], v[98:99]
    v_pk_add_f32 v[150:151], v[150:151], v[100:101]
    v_cvt_pk_bf16_f32 v76, v148, v149
    v_cvt_pk_bf16_f32 v77, v150, v151
    v_pk_mul_f32 v[94:95], v[50:51], v[38:39] op_sel_hi:[1,0]
    v_pk_fma_f32 v[120:121], v[120:121], v[46:47], v[94:95]
    v_pk_mul_f32 v[96:97], v[52:53], v[38:39] op_sel_hi:[1,0]
    v_pk_fma_f32 v[122:123], v[122:123], v[48:49], v[96:97]
    v_min_f32 v98, 0, v120
    v_min_f32 v99, 0, v121
    v_min_f32 v100, 0, v122
    v_min_f32 v101, 0, v123
    v_pk_mul_f32 v[98:99], v[98:99], s[52:53]
    v_pk_mul_f32 v[100:101], v[100:101], s[52:53]
    v_max_f32 v120, 0, v120
    v_max_f32 v121, 0, v121
    v_max_f32 v122, 0, v122
    v_max_f32 v123, 0, v123
    v_exp_f32 v98, v98
    v_exp_f32 v99, v99
    v_exp_f32 v100, v100
    v_exp_f32 v101, v101
    v_pk_add_f32 v[120:121], v[120:121], s[54:55]
    v_pk_add_f32 v[122:123], v[122:123], s[54:55]
    v_pk_add_f32 v[120:121], v[120:121], v[98:99]
    v_pk_add_f32 v[122:123], v[122:123], v[100:101]
    v_cvt_pk_bf16_f32 v78, v120, v121
    v_cvt_pk_bf16_f32 v79, v122, v123
    v_pk_mul_f32 v[94:95], v[58:59], v[38:39] op_sel_hi:[1,0]
    v_pk_fma_f32 v[152:153], v[152:153], v[54:55], v[94:95]
    v_pk_mul_f32 v[96:97], v[60:61], v[38:39] op_sel_hi:[1,0]
    v_pk_fma_f32 v[154:155], v[154:155], v[56:57], v[96:97]
    v_min_f32 v98, 0, v152
    v_min_f32 v99, 0, v153
    v_min_f32 v100, 0, v154
    v_min_f32 v101, 0, v155
    v_pk_mul_f32 v[98:99], v[98:99], s[52:53]
    v_pk_mul_f32 v[100:101], v[100:101], s[52:53]
    v_max_f32 v152, 0, v152
    v_max_f32 v153, 0, v153
    v_max_f32 v154, 0, v154
    v_max_f32 v155, 0, v155
    v_exp_f32 v98, v98
    v_exp_f32 v99, v99
    v_exp_f32 v100, v100
    v_exp_f32 v101, v101
    v_pk_add_f32 v[152:153], v[152:153], s[54:55]
    v_pk_add_f32 v[154:155], v[154:155], s[54:55]
    v_pk_add_f32 v[152:153], v[152:153], v[98:99]
    v_pk_add_f32 v[154:155], v[154:155], v[100:101]
    v_cvt_pk_bf16_f32 v80, v152, v153
    v_cvt_pk_bf16_f32 v81, v154, v155
    v_pk_mul_f32 v[94:95], v[50:51], v[40:41] op_sel_hi:[1,0]
    v_pk_fma_f32 v[124:125], v[124:125], v[46:47], v[94:95]
    v_pk_mul_f32 v[96:97], v[52:53], v[40:41] op_sel_hi:[1,0]
    v_pk_fma_f32 v[126:127], v[126:127], v[48:49], v[96:97]
    v_mov_b32 v4, v124
    v_mov_b32 v5, v125
    v_mov_b32 v6, v126
    v_mov_b32 v7, v127
    v_min_f32 v98, 0, v4
    v_min_f32 v99, 0, v5
    v_min_f32 v100, 0, v6
    v_min_f32 v101, 0, v7
    v_pk_mul_f32 v[98:99], v[98:99], s[52:53]
    v_pk_mul_f32 v[100:101], v[100:101], s[52:53]
    v_max_f32 v4, 0, v4
    v_max_f32 v5, 0, v5
    v_max_f32 v6, 0, v6
    v_max_f32 v7, 0, v7
    v_exp_f32 v98, v98
    v_exp_f32 v99, v99
    v_exp_f32 v100, v100
    v_exp_f32 v101, v101
    v_pk_add_f32 v[4:5], v[4:5], s[54:55]
    v_pk_add_f32 v[6:7], v[6:7], s[54:55]
    v_pk_add_f32 v[4:5], v[4:5], v[98:99]
    v_pk_add_f32 v[6:7], v[6:7], v[100:101]
    v_cndmask_b32 v124, v124, v4, s[56:57]
    v_cndmask_b32 v125, v125, v5, s[56:57]
    v_cndmask_b32 v126, v126, v6, s[56:57]
    v_cndmask_b32 v127, v127, v7, s[56:57]
    v_cvt_pk_bf16_f32 v82, v124, v125
    v_cvt_pk_bf16_f32 v83, v126, v127
    v_pk_mul_f32 v[94:95], v[58:59], v[40:41] op_sel_hi:[1,0]
    v_pk_fma_f32 v[156:157], v[156:157], v[54:55], v[94:95]
    v_pk_mul_f32 v[96:97], v[60:61], v[40:41] op_sel_hi:[1,0]
    v_pk_fma_f32 v[158:159], v[158:159], v[56:57], v[96:97]
    v_mov_b32 v4, v156
    v_mov_b32 v5, v157
    v_mov_b32 v6, v158
    v_mov_b32 v7, v159
    v_min_f32 v98, 0, v4
    v_min_f32 v99, 0, v5
    v_min_f32 v100, 0, v6
    v_min_f32 v101, 0, v7
    v_pk_mul_f32 v[98:99], v[98:99], s[52:53]
    v_pk_mul_f32 v[100:101], v[100:101], s[52:53]
    v_max_f32 v4, 0, v4
    v_max_f32 v5, 0, v5
    v_max_f32 v6, 0, v6
    v_max_f32 v7, 0, v7
    v_exp_f32 v98, v98
    v_exp_f32 v99, v99
    v_exp_f32 v100, v100
    v_exp_f32 v101, v101
    v_pk_add_f32 v[4:5], v[4:5], s[54:55]
    v_pk_add_f32 v[6:7], v[6:7], s[54:55]
    v_pk_add_f32 v[4:5], v[4:5], v[98:99]
    v_pk_add_f32 v[6:7], v[6:7], v[100:101]
    v_cndmask_b32 v156, v156, v4, s[56:57]
    v_cndmask_b32 v157, v157, v5, s[56:57]
    v_cndmask_b32 v158, v158, v6, s[56:57]
    v_cndmask_b32 v159, v159, v7, s[56:57]
    v_cvt_pk_bf16_f32 v84, v156, v157
    v_cvt_pk_bf16_f32 v85, v158, v159
    v_pk_mul_f32 v[94:95], v[50:51], v[42:43] op_sel_hi:[1,0]
    v_pk_fma_f32 v[128:129], v[128:129], v[46:47], v[94:95]
    v_pk_mul_f32 v[96:97], v[52:53], v[42:43] op_sel_hi:[1,0]
    v_pk_fma_f32 v[130:131], v[130:131], v[48:49], v[96:97]
    v_cvt_pk_bf16_f32 v86, v128, v129
    v_cvt_pk_bf16_f32 v87, v130, v131
    v_pk_mul_f32 v[94:95], v[58:59], v[42:43] op_sel_hi:[1,0]
    v_pk_fma_f32 v[160:161], v[160:161], v[54:55], v[94:95]
    v_pk_mul_f32 v[96:97], v[60:61], v[42:43] op_sel_hi:[1,0]
    v_pk_fma_f32 v[162:163], v[162:163], v[56:57], v[96:97]
    v_cvt_pk_bf16_f32 v88, v160, v161
    v_cvt_pk_bf16_f32 v89, v162, v163
    v_pk_mul_f32 v[94:95], v[50:51], v[44:45] op_sel_hi:[1,0]
    v_pk_fma_f32 v[132:133], v[132:133], v[46:47], v[94:95]
    v_pk_mul_f32 v[96:97], v[52:53], v[44:45] op_sel_hi:[1,0]
    v_pk_fma_f32 v[134:135], v[134:135], v[48:49], v[96:97]
    v_cvt_pk_bf16_f32 v90, v132, v133
    v_cvt_pk_bf16_f32 v91, v134, v135
    v_pk_mul_f32 v[94:95], v[58:59], v[44:45] op_sel_hi:[1,0]
    v_pk_fma_f32 v[164:165], v[164:165], v[54:55], v[94:95]
    v_pk_mul_f32 v[96:97], v[60:61], v[44:45] op_sel_hi:[1,0]
    v_pk_fma_f32 v[166:167], v[166:167], v[56:57], v[96:97]
    v_cvt_pk_bf16_f32 v92, v164, v165
    v_cvt_pk_bf16_f32 v93, v166, v167
    v_mfma_f32_16x16x32_bf16 a[0:3], v[74:77], v[82:85], 0
    v_mfma_f32_16x16x32_bf16 a[4:7], v[74:77], v[86:89], 0
    v_mfma_f32_16x16x32_bf16 a[8:11], v[78:81], v[82:85], 0
    v_mfma_f32_16x16x32_bf16 a[12:15], v[78:81], v[86:89], 0
    v_mfma_f32_16x16x32_bf16 a[16:19], v[78:81], v[90:93], 0
    v_mfma_f32_16x16x32_bf16 a[20:23], v[82:85], v[86:89], 0
    v_mfma_f32_16x16x32_bf16 a[24:27], v[82:85], v[90:93], 0
    v_mfma_f32_16x16x32_bf16 a[28:31], v[74:77], v[32:35], 0
    v_mfma_f32_16x16x32_bf16 a[32:35], v[78:81], v[32:35], 0
    v_mfma_f32_16x16x32_bf16 a[36:39], v[82:85], v[32:35], 0
    s_mul_i32 s48, s42, 3584
    s_add_u32 s48, s48, 64384
    v_mul_u32_u24 v6, 80, v2
    v_lshl_add_u32 v6, v3, 4, v6
    v_add_u32 v6, s48, v6
    s_mov_b32 exec_lo, 0xff00ff00
    s_mov_b32 exec_hi, 0xff00ff00
    ds_write_b128 v6, a[0:3] offset:2560
    s_mov_b32 exec_lo, 0xfff0fff
    s_mov_b32 exec_hi, 0xfff0fff
    ds_write_b128 v6, a[4:7] offset:3840
    s_mov_b32 exec_lo, 0xff00
    s_mov_b32 exec_hi, 0x0
    ds_write_b128 v6, a[8:11] offset:2624
    s_mov_b32 exec_lo, 0xf0000fff
    s_mov_b32 exec_hi, 0xf000f000
    ds_write_b128 v6, a[12:15] offset:3904
    s_mov_b32 exec_lo, 0xffff0000
    s_mov_b32 exec_hi, 0xffffffff
    ds_write_b128 v6, a[16:19] offset:5184
    s_mov_b32 exec_lo, 0xf000f000
    s_mov_b32 exec_hi, 0x0
    ds_write_b128 v6, a[20:23] offset:3968
    s_mov_b32 exec_lo, 0xffffffff
    s_mov_b32 exec_hi, 0x0
    ds_write_b128 v6, a[24:27] offset:5248
    s_mov_b32 exec_lo, 0x10001
    s_mov_b32 exec_hi, 0x10001
    ds_write_b128 v6, a[28:31] offset:4800
    s_mov_b32 exec_lo, 0x1
    s_mov_b32 exec_hi, 0x0
    ds_write_b128 v6, a[32:35] offset:4864
    s_mov_b32 exec_lo, 0x10000
    s_mov_b32 exec_hi, 0x10001
    ds_write_b128 v6, a[32:35] offset:6464
    s_mov_b32 exec_lo, 0x10001
    s_mov_b32 exec_hi, 0x0
    ds_write_b128 v6, a[36:39] offset:6528
    s_mov_b64 exec, -1
    s_waitcnt lgkmcnt(0)
    s_barrier
    v_lshlrev_b32 v6, 2, v0
    v_add_u32 v7, 67584, v6
    ds_read_b32 v36, v7 offset:0
    ds_read_b32 v37, v7 offset:3584
    ds_read_b32 v38, v7 offset:7168
    ds_read_b32 v39, v7 offset:10752
    ds_read_b32 v40, v7 offset:1024
    ds_read_b32 v41, v7 offset:4608
    ds_read_b32 v42, v7 offset:8192
    ds_read_b32 v43, v7 offset:11776
    ds_read_b32 v44, v7 offset:2048
    ds_read_b32 v45, v7 offset:5632
    ds_read_b32 v46, v7 offset:9216
    ds_read_b32 v47, v7 offset:12800
    ds_read_b32 v48, v7 offset:3072
    ds_read_b32 v49, v7 offset:6656
    ds_read_b32 v50, v7 offset:10240
    ds_read_b32 v51, v7 offset:13824
    s_mov_b32 s58, 0
    s_nop 1
K1_POLL:
    s_waitcnt vmcnt(0)
    v_readfirstlane_b32 s48, v11
    s_nop 1
    s_cmp_lg_u32 s48, 0
    s_cbranch_scc1 K1_GO
    s_add_u32 s58, s58, 1
    s_cmp_gt_u32 s58, 0x100000
    s_cbranch_scc1 K1_GO
    s_sleep 1
    buffer_load_dword v11, v10, s[28:31], 0 offen offset:64 sc1
    s_branch K1_POLL
    s_nop 1
K1_GO:
    s_waitcnt lgkmcnt(0)
    v_add_f32 v36, v36, v37
    v_add_f32 v38, v38, v39
    v_add_f32 v36, v36, v38
    buffer_atomic_add_f32 v36, v6, s[24:27], 0 offen offset:0
    v_add_f32 v40, v40, v41
    v_add_f32 v42, v42, v43
    v_add_f32 v40, v40, v42
    buffer_atomic_add_f32 v40, v6, s[24:27], 0 offen offset:1024
    v_add_f32 v44, v44, v45
    v_add_f32 v46, v46, v47
    v_add_f32 v44, v44, v46
    buffer_atomic_add_f32 v44, v6, s[24:27], 0 offen offset:2048
    v_add_f32 v48, v48, v49
    v_add_f32 v50, v50, v51
    v_add_f32 v48, v48, v50
    buffer_atomic_add_f32 v48, v6, s[24:27], 0 offen offset:3072
    s_lshl_b32 s48, s40, 3
    s_lshl_b32 s49, s42, 1
    s_add_u32 s48, s48, s49
    s_mul_i32 s48, s48, 20480
    s_xor_b32 s49, s41, 1
    s_mul_i32 s49, s49, 1280
    s_add_u32 s48, s48, s49
    s_mov_b32 s45, 20480
    v_and_b32 v9, 1, v3
    v_lshrrev_b32 v8, 1, v3
    v_lshl_add_u32 v8, v9, 1, v8
    v_lshlrev_b32 v8, 8, v8
    v_lshl_add_u32 v8, v2, 4, v8
    v_add_u32 v8, s48, v8
    v_lshlrev_b32 v9, 3, v9
    v_lshl_add_u32 v9, v2, 4, v9
    v_add_u32 v9, s48, v9
    v_mov_b32 v4, v12
    v_mov_b32 v5, v14
    v_mov_b32 v6, v13
    v_mov_b32 v7, v15
    v_pk_mul_f32 v[94:95], v[62:63], v[4:5] op_sel_hi:[1,0]
    v_pk_fma_f32 v[104:105], v[104:105], v[4:5], v[94:95] op_sel:[0,1,0] op_sel_hi:[1,1,1]
    v_pk_mul_f32 v[96:97], v[64:65], v[4:5] op_sel_hi:[1,0]
    v_pk_fma_f32 v[106:107], v[106:107], v[4:5], v[96:97] op_sel:[0,1,0] op_sel_hi:[1,1,1]
    v_min_f32 v98, 0, v104
    v_min_f32 v99, 0, v105
    v_min_f32 v100, 0, v106
    v_min_f32 v101, 0, v107
    v_pk_mul_f32 v[98:99], v[98:99], s[52:53]
    v_pk_mul_f32 v[100:101], v[100:101], s[52:53]
    v_max_f32 v104, 0, v104
    v_max_f32 v105, 0, v105
    v_max_f32 v106, 0, v106
    v_max_f32 v107, 0, v107
    v_exp_f32 v98, v98
    v_exp_f32 v99, v99
    v_exp_f32 v100, v100
    v_exp_f32 v101, v101
    v_pk_add_f32 v[104:105], v[104:105], s[54:55]
    v_pk_add_f32 v[106:107], v[106:107], s[54:55]
    v_pk_add_f32 v[104:105], v[104:105], v[98:99]
    v_pk_add_f32 v[106:107], v[106:107], v[100:101]
    v_cvt_pk_bf16_f32 v76, v104, v105
    v_cvt_pk_bf16_f32 v77, v106, v107
    v_pk_mul_f32 v[94:95], v[66:67], v[4:5] op_sel_hi:[1,0]
    v_pk_fma_f32 v[108:109], v[108:109], v[4:5], v[94:95] op_sel:[0,1,0] op_sel_hi:[1,1,1]
    v_pk_mul_f32 v[96:97], v[68:69], v[4:5] op_sel_hi:[1,0]
    v_pk_fma_f32 v[110:111], v[110:111], v[4:5], v[96:97] op_sel:[0,1,0] op_sel_hi:[1,1,1]
    v_min_f32 v98, 0, v108
    v_min_f32 v99, 0, v109
    v_min_f32 v100, 0, v110
    v_min_f32 v101, 0, v111
    v_pk_mul_f32 v[98:99], v[98:99], s[52:53]
    v_pk_mul_f32 v[100:101], v[100:101], s[52:53]
    v_max_f32 v108, 0, v108
    v_max_f32 v109, 0, v109
    v_max_f32 v110, 0, v110
    v_max_f32 v111, 0, v111
    v_exp_f32 v98, v98
    v_exp_f32 v99, v99
    v_exp_f32 v100, v100
    v_exp_f32 v101, v101
    v_pk_add_f32 v[108:109], v[108:109], s[54:55]
    v_pk_add_f32 v[110:111], v[110:111], s[54:55]
    v_pk_add_f32 v[108:109], v[108:109], v[98:99]
    v_pk_add_f32 v[110:111], v[110:111], v[100:101]
    v_cvt_pk_bf16_f32 v78, v108, v109
    v_cvt_pk_bf16_f32 v79, v110, v111
    s_nop 0
    v_permlane16_swap_b32 v76, v78
    v_permlane16_swap_b32 v77, v79
    buffer_store_dwordx4 v[76:79], v8, s[20:23], 0 offen sc1
    v_pk_mul_f32 v[94:95], v[70:71], v[4:5] op_sel_hi:[1,0]
    v_pk_fma_f32 v[112:113], v[112:113], v[4:5], v[94:95] op_sel:[0,1,0] op_sel_hi:[1,1,1]
    v_pk_mul_f32 v[96:97], v[72:73], v[4:5] op_sel_hi:[1,0]
    v_pk_fma_f32 v[114:115], v[114:115], v[4:5], v[96:97] op_sel:[0,1,0] op_sel_hi:[1,1,1]
    v_min_f32 v98, 0, v112
    v_min_f32 v99, 0, v113
    v_min_f32 v100, 0, v114
    v_min_f32 v101, 0, v115
    v_pk_mul_f32 v[98:99], v[98:99], s[52:53]
    v_pk_mul_f32 v[100:101], v[100:101], s[52:53]
    v_max_f32 v112, 0, v112
    v_max_f32 v113, 0, v113
    v_max_f32 v114, 0, v114
    v_max_f32 v115, 0, v115
    v_exp_f32 v98, v98
    v_exp_f32 v99, v99
    v_exp_f32 v100, v100
    v_exp_f32 v101, v101
    v_pk_add_f32 v[112:113], v[112:113], s[54:55]
    v_pk_add_f32 v[114:115], v[114:115], s[54:55]
    v_pk_add_f32 v[112:113], v[112:113], v[98:99]
    v_pk_add_f32 v[114:115], v[114:115], v[100:101]
    v_cvt_pk_bf16_f32 v80, v112, v113
    v_cvt_pk_bf16_f32 v81, v114, v115
    s_mov_b32 exec_lo, 0xffffffff
    s_mov_b32 exec_hi, 0x0
    buffer_store_dwordx2 v[80:81], v9, s[20:23], 0 offen offset:1024 sc1
    s_mov_b64 exec, -1
    v_pk_mul_f32 v[94:95], v[62:63], v[6:7] op_sel_hi:[1,0]
    v_pk_fma_f32 v[136:137], v[136:137], v[6:7], v[94:95] op_sel:[0,1,0] op_sel_hi:[1,1,1]
    v_pk_mul_f32 v[96:97], v[64:65], v[6:7] op_sel_hi:[1,0]
    v_pk_fma_f32 v[138:139], v[138:139], v[6:7], v[96:97] op_sel:[0,1,0] op_sel_hi:[1,1,1]
    v_min_f32 v98, 0, v136
    v_min_f32 v99, 0, v137
    v_min_f32 v100, 0, v138
    v_min_f32 v101, 0, v139
    v_pk_mul_f32 v[98:99], v[98:99], s[52:53]
    v_pk_mul_f32 v[100:101], v[100:101], s[52:53]
    v_max_f32 v136, 0, v136
    v_max_f32 v137, 0, v137
    v_max_f32 v138, 0, v138
    v_max_f32 v139, 0, v139
    v_exp_f32 v98, v98
    v_exp_f32 v99, v99
    v_exp_f32 v100, v100
    v_exp_f32 v101, v101
    v_pk_add_f32 v[136:137], v[136:137], s[54:55]
    v_pk_add_f32 v[138:139], v[138:139], s[54:55]
    v_pk_add_f32 v[136:137], v[136:137], v[98:99]
    v_pk_add_f32 v[138:139], v[138:139], v[100:101]
    v_cvt_pk_bf16_f32 v84, v136, v137
    v_cvt_pk_bf16_f32 v85, v138, v139
    v_pk_mul_f32 v[94:95], v[66:67], v[6:7] op_sel_hi:[1,0]
    v_pk_fma_f32 v[140:141], v[140:141], v[6:7], v[94:95] op_sel:[0,1,0] op_sel_hi:[1,1,1]
    v_pk_mul_f32 v[96:97], v[68:69], v[6:7] op_sel_hi:[1,0]
    v_pk_fma_f32 v[142:143], v[142:143], v[6:7], v[96:97] op_sel:[0,1,0] op_sel_hi:[1,1,1]
    v_min_f32 v98, 0, v140
    v_min_f32 v99, 0, v141
    v_min_f32 v100, 0, v142
    v_min_f32 v101, 0, v143
    v_pk_mul_f32 v[98:99], v[98:99], s[52:53]
    v_pk_mul_f32 v[100:101], v[100:101], s[52:53]
    v_max_f32 v140, 0, v140
    v_max_f32 v141, 0, v141
    v_max_f32 v142, 0, v142
    v_max_f32 v143, 0, v143
    v_exp_f32 v98, v98
    v_exp_f32 v99, v99
    v_exp_f32 v100, v100
    v_exp_f32 v101, v101
    v_pk_add_f32 v[140:141], v[140:141], s[54:55]
    v_pk_add_f32 v[142:143], v[142:143], s[54:55]
    v_pk_add_f32 v[140:141], v[140:141], v[98:99]
    v_pk_add_f32 v[142:143], v[142:143], v[100:101]
    v_cvt_pk_bf16_f32 v86, v140, v141
    v_cvt_pk_bf16_f32 v87, v142, v143
    s_nop 0
    v_permlane16_swap_b32 v84, v86
    v_permlane16_swap_b32 v85, v87
    buffer_store_dwordx4 v[84:87], v8, s[20:23], s45 offen sc1
    v_pk_mul_f32 v[94:95], v[70:71], v[6:7] op_sel_hi:[1,0]
    v_pk_fma_f32 v[144:145], v[144:145], v[6:7], v[94:95] op_sel:[0,1,0] op_sel_hi:[1,1,1]
    v_pk_mul_f32 v[96:97], v[72:73], v[6:7] op_sel_hi:[1,0]
    v_pk_fma_f32 v[146:147], v[146:147], v[6:7], v[96:97] op_sel:[0,1,0] op_sel_hi:[1,1,1]
    v_min_f32 v98, 0, v144
    v_min_f32 v99, 0, v145
    v_min_f32 v100, 0, v146
    v_min_f32 v101, 0, v147
    v_pk_mul_f32 v[98:99], v[98:99], s[52:53]
    v_pk_mul_f32 v[100:101], v[100:101], s[52:53]
    v_max_f32 v144, 0, v144
    v_max_f32 v145, 0, v145
    v_max_f32 v146, 0, v146
    v_max_f32 v147, 0, v147
    v_exp_f32 v98, v98
    v_exp_f32 v99, v99
    v_exp_f32 v100, v100
    v_exp_f32 v101, v101
    v_pk_add_f32 v[144:145], v[144:145], s[54:55]
    v_pk_add_f32 v[146:147], v[146:147], s[54:55]
    v_pk_add_f32 v[144:145], v[144:145], v[98:99]
    v_pk_add_f32 v[146:147], v[146:147], v[100:101]
    v_cvt_pk_bf16_f32 v88, v144, v145
    v_cvt_pk_bf16_f32 v89, v146, v147
    s_mov_b32 exec_lo, 0xffffffff
    s_mov_b32 exec_hi, 0x0
    buffer_store_dwordx2 v[88:89], v9, s[20:23], s45 offen offset:1024 sc1
    s_mov_b64 exec, -1
K1_END:
    s_endpgm
.globl kp_kernel
.p2align 8
.type kp_kernel,@function
kp_kernel:
    s_cmp_ge_u32 s2, 256
    s_cbranch_scc1 KP_END
    s_load_dwordx2 s[4:5], s[0:1], 0
    s_load_dwordx2 s[6:7], s[0:1], 64
    s_load_dwordx2 s[8:9], s[0:1], 80
    s_and_b32 s46, s2, 7
    s_lshr_b32 s47, s2, 3
    s_lshr_b32 s40, s47, 3
    s_lshl_b32 s48, s46, 2
    s_add_u32 s40, s40, s48
    s_and_b32 s41, s47, 7
    s_lshr_b32 s43, s47, 4
    s_lshl_b32 s48, s46, 1
    s_add_u32 s43, s43, s48
    s_and_b32 s44, s47, 15
    s_mul_i32 s45, s44, 27
    s_lshr_b32 s45, s45, 2
    v_lshrrev_b32 v4, 6, v0
    v_and_b32 v1, 63, v0
    v_lshlrev_b32 v1, 4, v1
    v_readfirstlane_b32 s42, v4
    v_and_b32 v2, 15, v0
    v_bfe_u32 v3, v0, 4, 2
    s_mul_i32 s48, s40, 81920
    s_mul_i32 s49, s42, 5120
    s_add_u32 s48, s48, s49
    v_add_u32 v4, s48, v1
    s_add_u32 s48, s42, 0
    s_and_b32 s48, s48, 3
    s_mul_i32 s50, s48, 20480
    s_add_u32 s48, s42, 1
    s_and_b32 s48, s48, 3
    s_mul_i32 s51, s48, 20480
    s_add_u32 s48, s42, 2
    s_and_b32 s48, s48, 3
    s_mul_i32 s52, s48, 20480
    s_add_u32 s48, s42, 3
    s_and_b32 s48, s48, 3
    s_mul_i32 s53, s48, 20480
    s_waitcnt lgkmcnt(0)
    s_mov_b32 s12, s8
    s_mov_b32 s13, s9
    s_mov_b32 s14, 37748736
    s_mov_b32 s15, 0x00020000
    s_getreg_b32 s48, hwreg(HW_REG_XCC_ID)
    s_add_u32 s48, s48, 1
    v_mov_b32 v7, s48
    s_lshl_b32 s49, s46, 7
    s_add_u32 s75, s49, 18223104
    s_lshl_b32 s49, s47, 2
    s_add_u32 s49, s49, s75
    v_mov_b32 v6, s49
    v_mov_b32 v25, v6
    v_mov_b32 v26, v7
    s_mul_i32 s48, s42, 13440
    s_add_u32 s48, s48, 17825792
    buffer_load_dwordx4 v[192:195], v1, s[12:15], s48 offen offset:0
    buffer_load_dwordx4 v[196:199], v1, s[12:15], s48 offen offset:1024
    buffer_load_dwordx4 v[200:203], v1, s[12:15], s48 offen offset:2048
    buffer_load_dwordx4 v[204:207], v1, s[12:15], s48 offen offset:3072
    s_add_u32 s48, s48, 4096
    buffer_load_dwordx4 v[208:211], v1, s[12:15], s48 offen offset:0
    buffer_load_dwordx4 v[212:215], v1, s[12:15], s48 offen offset:1024
    buffer_load_dwordx4 v[216:219], v1, s[12:15], s48 offen offset:2048
    buffer_load_dwordx4 v[220:223], v1, s[12:15], s48 offen offset:3072
    s_add_u32 s48, s48, 4096
    buffer_load_dwordx4 v[224:227], v1, s[12:15], s48 offen offset:0
    buffer_load_dwordx4 v[228:231], v1, s[12:15], s48 offen offset:1024
    buffer_load_dwordx4 v[232:235], v1, s[12:15], s48 offen offset:2048
    buffer_load_dwordx4 v[236:239], v1, s[12:15], s48 offen offset:3072
    s_add_u32 s48, s48, 4096
    buffer_load_dwordx4 v[240:243], v1, s[12:15], s48 offen offset:0
    buffer_load_dwordx4 v[244:247], v1, s[12:15], s48 offen offset:1024
    s_add_u32 s76, s51, 0
    buffer_load_dwordx4 v[52:55], v4, s[12:15], s76 offen offset:0
    s_add_u32 s76, s51, 0
    buffer_load_dwordx4 v[56:59], v4, s[12:15], s76 offen offset:1024
    s_add_u32 s76, s51, 0
    buffer_load_dwordx4 v[60:63], v4, s[12:15], s76 offen offset:2048
    s_add_u32 s76, s51, 0
    buffer_load_dwordx4 v[64:67], v4, s[12:15], s76 offen offset:3072
    s_add_u32 s20, s8, 20971520
    s_addc_u32 s21, s9, 0
    s_mov_b32 s22, 6881280
    s_mov_b32 s23, 0x00020000
    s_mov_b32 s24, s4
    s_mov_b32 s25, s5
    s_mov_b32 s26, 2621440
    s_mov_b32 s27, 0x00020000
    s_add_u32 s16, s8, 5242880
    s_addc_u32 s17, s9, 0
    s_mov_b32 s18, 2621440
    s_mov_b32 s19, 0x00020000
    s_mov_b32 s28, s6
    s_mov_b32 s29, s7
    s_mov_b32 s30, 2621440
    s_mov_b32 s31, 0x00020000
    s_mul_i32 s48, s42, 204800
    s_mul_i32 s49, s41, 5120
    s_add_u32 s48, s48, s49
    v_add_u32 v5, s48, v1
    s_add_u32 s76, s51, 4096
    buffer_load_dwordx4 v[68:71], v4, s[12:15], s76 offen offset:0
    s_add_u32 s48, s42, 1
    s_and_b32 s48, s48, 3
    s_mul_i32 s48, s48, 15360
    s_add_u32 s48, s48, 102400
    v_add_u32 v8, s48, v1
    s_add_u32 s48, s42, 2
    s_and_b32 s48, s48, 3
    s_mul_i32 s48, s48, 15360
    s_add_u32 s48, s48, 107520
    v_add_u32 v9, s48, v1
    s_add_u32 s48, s42, 3
    s_and_b32 s48, s48, 3
    s_mul_i32 s48, s48, 15360
    s_add_u32 s48, s48, 112640
    v_add_u32 v10, s48, v1
    s_mul_i32 s48, s42, 15360
    s_add_u32 s48, s48, 102400
    v_add_u32 v11, s48, v1
    s_lshl_b32 s48, s40, 2
    s_add_u32 s48, s48, s42
    s_mul_i32 s48, s48, 20480
    s_mul_i32 s49, s41, 2560
    s_add_u32 s48, s48, s49
    v_and_b32 v6, 1, v3
    v_lshrrev_b32 v7, 1, v3
    v_lshl_add_u32 v12, v6, 1, v7
    v_lshlrev_b32 v12, 8, v12
    v_lshl_add_u32 v12, v2, 4, v12
    v_add_u32 v12, s48, v12
    s_add_u32 s76, s52, 0
    buffer_load_dwordx4 v[72:75], v4, s[12:15], s76 offen offset:0
    v_lshlrev_b32 v13, 8, v7
    v_lshl_add_u32 v13, v6, 3, v13
    v_lshl_add_u32 v13, v2, 4, v13
    v_add_u32 v13, s48, v13
    s_lshl_b32 s48, s40, 12
    s_lshl_b32 s49, s42, 7
    s_add_u32 s48, s48, s49
    v_lshlrev_b32 v14, 10, v3
    v_lshl_add_u32 v14, v2, 3, v14
    v_add_u32 v14, s48, v14
    s_lshl_b32 s49, s41, 9
    s_add_u32 s48, s48, s49
    v_lshlrev_b32 v15, 3, v2
    v_add_u32 v15, s48, v15
    v_mov_b32 v28, 0xc0135761
    s_add_u32 s76, s52, 0
    buffer_load_dwordx4 v[76:79], v4, s[12:15], s76 offen offset:1024
    s_mov_b32 s58, 0xbdd2d3e8
    s_mov_b32 s62, 0x3acccccd
    s_mov_b32 s63, 0x3727c5ac
    s_mov_b32 s64, 0x358637bd
    v_lshlrev_b32 v29, 4, v3
    v_lshrrev_b32 v6, 4, v1
    s_lshl_b32 s48, s42, 6
    v_add_u32 v6, s48, v6
    s_mul_i32 s48, s40, 81920
    s_mul_i32 s49, s41, 160
    s_add_u32 s55, s48, s49
    v_add_u32 v7, 0, v6
    v_mul_u32_u24 v16, 6554, v7
    v_lshrrev_b32 v16, 16, v16
    v_mul_u32_u24 v17, 10, v16
    v_sub_u32 v17, v7, v17
    v_mul_u32_u24 v16, 1280, v16
    v_lshl_add_u32 v19, v17, 4, v16
    s_add_u32 s76, s52, 0
    buffer_load_dwordx4 v[80:83], v4, s[12:15], s76 offen offset:2048
    v_add_u32 v7, 256, v6
    v_mul_u32_u24 v16, 6554, v7
    v_lshrrev_b32 v16, 16, v16
    v_mul_u32_u24 v17, 10, v16
    v_sub_u32 v17, v7, v17
    v_mul_u32_u24 v16, 1280, v16
    v_lshl_add_u32 v20, v17, 4, v16
    v_add_u32 v7, 512, v6
    v_mul_u32_u24 v16, 6554, v7
    v_lshrrev_b32 v16, 16, v16
    s_add_u32 s76, s52, 0
    buffer_load_dwordx4 v[84:87], v4, s[12:15], s76 offen offset:3072
    v_mul_u32_u24 v17, 10, v16
    v_sub_u32 v17, v7, v17
    v_mul_u32_u24 v16, 1280, v16
    v_lshl_add_u32 v21, v17, 4, v16
    v_accvgpr_write_b32 a100, 0
    v_accvgpr_write_b32 a101, 0
    v_accvgpr_write_b32 a102, 0
    v_accvgpr_write_b32 a103, 0
    v_accvgpr_write_b32 a104, 0
    v_accvgpr_write_b32 a105, 0
    s_add_u32 s76, s52, 4096
    buffer_load_dwordx4 v[88:91], v4, s[12:15], s76 offen offset:0
    v_accvgpr_write_b32 a106, 0
    v_accvgpr_write_b32 a107, 0
    v_accvgpr_write_b32 a108, 0
    v_accvgpr_write_b32 a109, 0
    v_accvgpr_write_b32 a110, 0
    v_accvgpr_write_b32 a111, 0
    v_accvgpr_write_b32 a112, 0
    v_accvgpr_write_b32 a113, 0
    v_accvgpr_write_b32 a114, 0
    v_accvgpr_write_b32 a115, 0
    s_add_u32 s76, s53, 0
    buffer_load_dwordx4 v[92:95], v4, s[12:15], s76 offen offset:0
    v_accvgpr_write_b32 a116, 0
    v_accvgpr_write_b32 a117, 0
    v_accvgpr_write_b32 a118, 0
    v_accvgpr_write_b32 a119, 0
    v_accvgpr_write_b32 a120, 0
    v_accvgpr_write_b32 a121, 0
    v_accvgpr_write_b32 a122, 0
    v_accvgpr_write_b32 a123, 0
    v_accvgpr_write_b32 a124, 0
    v_accvgpr_write_b32 a125, 0
    s_add_u32 s76, s53, 0
    buffer_load_dwordx4 v[96:99], v4, s[12:15], s76 offen offset:1024
    v_accvgpr_write_b32 a126, 0
    v_accvgpr_write_b32 a127, 0
    v_accvgpr_write_b32 a128, 0
    v_accvgpr_write_b32 a129, 0
    v_accvgpr_write_b32 a130, 0
    v_accvgpr_write_b32 a131, 0
    v_accvgpr_write_b32 a132, 0
    v_accvgpr_write_b32 a133, 0
    v_accvgpr_write_b32 a134, 0
    v_accvgpr_write_b32 a135, 0
    s_add_u32 s76, s53, 0
    buffer_load_dwordx4 v[100:103], v4, s[12:15], s76 offen offset:2048
    v_accvgpr_write_b32 a136, 0
    v_accvgpr_write_b32 a137, 0
    v_accvgpr_write_b32 a138, 0
    v_accvgpr_write_b32 a139, 0
    v_accvgpr_write_b32 a140, 0
    v_accvgpr_write_b32 a141, 0
    v_accvgpr_write_b32 a142, 0
    v_accvgpr_write_b32 a143, 0
    v_accvgpr_write_b32 a144, 0
    v_accvgpr_write_b32 a145, 0
    s_add_u32 s76, s53, 0
    buffer_load_dwordx4 v[104:107], v4, s[12:15], s76 offen offset:3072
    v_accvgpr_write_b32 a146, 0
    v_accvgpr_write_b32 a147, 0
    v_accvgpr_write_b32 a148, 0
    v_accvgpr_write_b32 a149, 0
    v_accvgpr_write_b32 a150, 0
    v_accvgpr_write_b32 a151, 0
    v_accvgpr_write_b32 a152, 0
    v_accvgpr_write_b32 a153, 0
    v_accvgpr_write_b32 a154, 0
    v_accvgpr_write_b32 a155, 0
    s_add_u32 s76, s53, 4096
    buffer_load_dwordx4 v[108:111], v4, s[12:15], s76 offen offset:0
    v_accvgpr_write_b32 a156, 0
    v_accvgpr_write_b32 a157, 0
    v_accvgpr_write_b32 a158, 0
    v_accvgpr_write_b32 a159, 0
    v_accvgpr_write_b32 a160, 0
    v_accvgpr_write_b32 a161, 0
    v_accvgpr_write_b32 a162, 0
    v_accvgpr_write_b32 a163, 0
    v_accvgpr_write_b32 a164, 0
    v_accvgpr_write_b32 a165, 0
    s_add_u32 s76, s50, 0
    buffer_load_dwordx4 v[32:35], v4, s[12:15], s76 offen offset:0
    v_accvgpr_write_b32 a166, 0
    v_accvgpr_write_b32 a167, 0
    v_accvgpr_write_b32 a168, 0
    v_accvgpr_write_b32 a169, 0
    v_accvgpr_write_b32 a170, 0
    v_accvgpr_write_b32 a171, 0
    v_accvgpr_write_b32 a172, 0
    v_accvgpr_write_b32 a173, 0
    v_accvgpr_write_b32 a174, 0
    v_accvgpr_write_b32 a175, 0
    s_add_u32 s76, s50, 0
    buffer_load_dwordx4 v[36:39], v4, s[12:15], s76 offen offset:1024
    v_accvgpr_write_b32 a176, 0
    v_accvgpr_write_b32 a177, 0
    v_accvgpr_write_b32 a178, 0
    v_accvgpr_write_b32 a179, 0
    v_accvgpr_write_b32 a180, 0
    v_accvgpr_write_b32 a181, 0
    v_accvgpr_write_b32 a182, 0
    v_accvgpr_write_b32 a183, 0
    v_accvgpr_write_b32 a184, 0
    v_accvgpr_write_b32 a185, 0
    s_add_u32 s76, s50, 0
    buffer_load_dwordx4 v[40:43], v4, s[12:15], s76 offen offset:2048
    v_accvgpr_write_b32 a186, 0
    v_accvgpr_write_b32 a187, 0
    v_accvgpr_write_b32 a188, 0
    v_accvgpr_write_b32 a189, 0
    v_accvgpr_write_b32 a190, 0
    v_accvgpr_write_b32 a191, 0
    v_accvgpr_write_b32 a192, 0
    v_accvgpr_write_b32 a193, 0
    v_accvgpr_write_b32 a194, 0
    v_accvgpr_write_b32 a195, 0
    s_add_u32 s76, s50, 0
    buffer_load_dwordx4 v[44:47], v4, s[12:15], s76 offen offset:3072
    s_mul_i32 s48, s42, 7168
    s_add_u32 s48, s48, 102400
    v_lshrrev_b32 v6, 1, v1
    v_add_u32 v6, s48, v6
    s_sub_u32 s48, s48, 64
    v_mul_u32_u24 v16, 40, v2
    v_add3_u32 v16, v16, v29, s48
    v_and_b32 v7, 3, v2
    v_mul_u32_u24 v18, 800, v7
    v_add3_u32 v18, v18, v29, s48
    v_lshrrev_b32 v7, 2, v2
    v_mul_u32_u24 v7, 40, v7
    v_add_u32 v17, v18, v7
    s_add_u32 s76, s50, 4096
    buffer_load_dwordx4 v[48:51], v4, s[12:15], s76 offen offset:0
    s_waitcnt vmcnt(20)
    v_cvt_pk_bf16_f32 v192, v192, v193
    v_cvt_pk_bf16_f32 v193, v194, v195
    ds_write_b64 v6, v[192:193] offset:0
    v_cvt_pk_bf16_f32 v196, v196, v197
    v_cvt_pk_bf16_f32 v197, v198, v199
    ds_write_b64 v6, v[196:197] offset:512
    v_cvt_pk_bf16_f32 v200, v200, v201
    v_cvt_pk_bf16_f32 v201, v202, v203
    ds_write_b64 v6, v[200:201] offset:1024
    v_cvt_pk_bf16_f32 v204, v204, v205
    v_cvt_pk_bf16_f32 v205, v206, v207
    ds_write_b64 v6, v[204:205] offset:1536
    v_cvt_pk_bf16_f32 v208, v208, v209
    v_cvt_pk_bf16_f32 v209, v210, v211
    ds_write_b64 v6, v[208:209] offset:2048
    v_cvt_pk_bf16_f32 v212, v212, v213
    v_cvt_pk_bf16_f32 v213, v214, v215
    ds_write_b64 v6, v[212:213] offset:2560
    v_cvt_pk_bf16_f32 v216, v216, v217
    v_cvt_pk_bf16_f32 v217, v218, v219
    ds_write_b64 v6, v[216:217] offset:3072
    v_cvt_pk_bf16_f32 v220, v220, v221
    v_cvt_pk_bf16_f32 v221, v222, v223
    ds_write_b64 v6, v[220:221] offset:3584
    v_cvt_pk_bf16_f32 v224, v224, v225
    v_cvt_pk_bf16_f32 v225, v226, v227
    ds_write_b64 v6, v[224:225] offset:4096
    v_cvt_pk_bf16_f32 v228, v228, v229
    v_cvt_pk_bf16_f32 v229, v230, v231
    ds_write_b64 v6, v[228:229] offset:4608
    v_cvt_pk_bf16_f32 v232, v232, v233
    v_cvt_pk_bf16_f32 v233, v234, v235
    ds_write_b64 v6, v[232:233] offset:5120
    v_cvt_pk_bf16_f32 v236, v236, v237
    v_cvt_pk_bf16_f32 v237, v238, v239
    ds_write_b64 v6, v[236:237] offset:5632
    v_cvt_pk_bf16_f32 v240, v240, v241
    v_cvt_pk_bf16_f32 v241, v242, v243
    ds_write_b64 v6, v[240:241] offset:6144
    v_cvt_pk_bf16_f32 v244, v244, v245
    v_cvt_pk_bf16_f32 v245, v246, v247
    ds_write_b64 v6, v[244:245] offset:6656
    s_waitcnt lgkmcnt(0)
    s_mov_b32 exec_lo, 0xffffffff
    s_mov_b32 exec_hi, 0xffff
    ds_read_b64 a[100:101], v16 offset:64
    s_mov_b32 exec_lo, 0xffffffff
    s_mov_b32 exec_hi, 0x0
    ds_read_b64 a[102:103], v16 offset:72
    s_mov_b32 exec_lo, 0x0
    s_mov_b32 exec_hi, 0xffff0000
    ds_read_b64 a[104:105], v16 offset:864
    s_mov_b32 exec_lo, 0x0
    s_mov_b32 exec_hi, 0xffffffff
    ds_read_b64 a[106:107], v16 offset:872
    s_mov_b32 exec_lo, 0xffff
    s_mov_b32 exec_hi, 0x0
    ds_read_b64 a[108:109], v16 offset:928
    s_mov_b32 exec_lo, 0xffff
    s_mov_b32 exec_hi, 0x0
    ds_read_b64 a[110:111], v16 offset:936
    s_mov_b32 exec_lo, 0xffff0000
    s_mov_b32 exec_hi, 0xffffffff
    ds_read_b64 a[112:113], v16 offset:1728
    s_mov_b32 exec_lo, 0xffff0000
    s_mov_b32 exec_hi, 0xffff
    ds_read_b64 a[114:115], v16 offset:1736
    s_mov_b32 exec_lo, 0x0
    s_mov_b32 exec_hi, 0xffff0000
    ds_read_b64 a[118:119], v16 offset:2536
    s_mov_b32 exec_lo, 0xffffffff
    s_mov_b32 exec_hi, 0x0
    ds_read_b64 a[120:121], v16 offset:2592
    s_mov_b32 exec_lo, 0xffffffff
    s_mov_b32 exec_hi, 0x0
    ds_read_b64 a[122:123], v16 offset:2600
    s_mov_b32 exec_lo, 0x0
    s_mov_b32 exec_hi, 0xffffffff
    ds_read_b64 a[124:125], v16 offset:3392
    s_mov_b32 exec_lo, 0x0
    s_mov_b32 exec_hi, 0xffffffff
    ds_read_b64 a[126:127], v16 offset:3400
    s_mov_b32 exec_lo, 0xffff
    s_mov_b32 exec_hi, 0x0
    ds_read_b64 a[128:129], v16 offset:3456
    s_mov_b32 exec_lo, 0xffff0000
    s_mov_b32 exec_hi, 0xffff
    ds_read_b64 a[132:133], v16 offset:4256
    s_mov_b32 exec_lo, 0xffffffff
    s_mov_b32 exec_hi, 0xffff
    ds_read_b64 a[134:135], v16 offset:4264
    s_mov_b32 exec_lo, 0x0
    s_mov_b32 exec_hi, 0xffff0000
    ds_read_b64 a[136:137], v16 offset:5056
    s_mov_b32 exec_lo, 0x0
    s_mov_b32 exec_hi, 0xffff0000
    ds_read_b64 a[138:139], v16 offset:5064
    s_mov_b32 exec_lo, 0xffffffff
    s_mov_b32 exec_hi, 0x0
    ds_read_b64 a[140:141], v16 offset:5120
    s_mov_b32 exec_lo, 0xffff
    s_mov_b32 exec_hi, 0x0
    ds_read_b64 a[142:143], v16 offset:5128
    s_mov_b32 exec_lo, 0x0
    s_mov_b32 exec_hi, 0xffffffff
    ds_read_b64 a[144:145], v16 offset:5920
    s_mov_b32 exec_lo, 0xffff0000
    s_mov_b32 exec_hi, 0xffffffff
    ds_read_b64 a[146:147], v16 offset:5928
    s_mov_b32 exec_lo, 0x11111111
    s_mov_b32 exec_hi, 0x22221111
    ds_read_b64 a[148:149], v17 offset:704
    s_mov_b32 exec_lo, 0x11111111
    s_mov_b32 exec_hi, 0x22222222
    ds_read_b64 a[150:151], v17 offset:712
    s_mov_b32 exec_lo, 0x44442222
    s_mov_b32 exec_hi, 0x44444444
    ds_read_b64 a[152:153], v17 offset:768
    s_mov_b32 exec_lo, 0x44442222
    s_mov_b32 exec_hi, 0x88884444
    ds_read_b64 a[154:155], v17 offset:776
    s_mov_b32 exec_lo, 0x88888888
    s_mov_b32 exec_hi, 0x0
    ds_read_b64 a[156:157], v17 offset:832
    s_mov_b32 exec_lo, 0x88888888
    s_mov_b32 exec_hi, 0x0
    ds_read_b64 a[158:159], v17 offset:840
    s_mov_b32 exec_lo, 0x0
    s_mov_b32 exec_hi, 0x11111111
    ds_read_b64 a[160:161], v17 offset:4032
    s_mov_b32 exec_lo, 0x0
    s_mov_b32 exec_hi, 0x11111111
    ds_read_b64 a[162:163], v17 offset:4040
    s_mov_b32 exec_lo, 0x22221111
    s_mov_b32 exec_hi, 0x44442222
    ds_read_b64 a[164:165], v17 offset:4096
    s_mov_b32 exec_lo, 0x22222222
    s_mov_b32 exec_hi, 0x44442222
    ds_read_b64 a[166:167], v17 offset:4104
    s_mov_b32 exec_lo, 0x44444444
    s_mov_b32 exec_hi, 0x88888888
    ds_read_b64 a[168:169], v17 offset:4160
    s_mov_b32 exec_lo, 0x88884444
    s_mov_b32 exec_hi, 0x88888888
    ds_read_b64 a[170:171], v17 offset:4168
    s_mov_b32 exec_lo, 0x11111111
    s_mov_b32 exec_hi, 0x22221111
    ds_read_b64 a[172:173], v18 offset:864
    s_mov_b32 exec_lo, 0x11111111
    s_mov_b32 exec_hi, 0x22222222
    ds_read_b64 a[174:175], v18 offset:872
    s_mov_b32 exec_lo, 0x44442222
    s_mov_b32 exec_hi, 0x44444444
    ds_read_b64 a[176:177], v18 offset:928
    s_mov_b32 exec_lo, 0x44442222
    s_mov_b32 exec_hi, 0x88884444
    ds_read_b64 a[178:179], v18 offset:936
    s_mov_b32 exec_lo, 0x88888888
    s_mov_b32 exec_hi, 0x0
    ds_read_b64 a[180:181], v18 offset:992
    s_mov_b32 exec_lo, 0x88888888
    s_mov_b32 exec_hi, 0x0
    ds_read_b64 a[182:183], v18 offset:1000
    s_mov_b32 exec_lo, 0x0
    s_mov_b32 exec_hi, 0x11111111
    ds_read_b64 a[184:185], v18 offset:4192
    s_mov_b32 exec_lo, 0x0
    s_mov_b32 exec_hi, 0x11111111
    ds_read_b64 a[186:187], v18 offset:4200
    s_mov_b32 exec_lo, 0x22221111
    s_mov_b32 exec_hi, 0x44442222
    ds_read_b64 a[188:189], v18 offset:4256
    s_mov_b32 exec_lo, 0x22222222
    s_mov_b32 exec_hi, 0x44442222
    ds_read_b64 a[190:191], v18 offset:4264
    s_mov_b32 exec_lo, 0x44444444
    s_mov_b32 exec_hi, 0x88888888
    ds_read_b64 a[192:193], v18 offset:4320
    s_mov_b32 exec_lo, 0x88884444
    s_mov_b32 exec_hi, 0x88888888
    ds_read_b64 a[194:195], v18 offset:4328
    s_mov_b64 exec, -1
    s_waitcnt lgkmcnt(0)
    s_waitcnt vmcnt(15)
    v_mfma_f32_16x16x32_bf16 v[152:155], a[172:175], v[52:55], 0
    s_lshl_b32 s76, s42, 10
    s_add_u32 m0, s76, 135168
    s_nop 0
    buffer_load_dwordx4 v19, s[24:27], s55 offen lds
    v_mfma_f32_16x16x32_bf16 v[152:155], a[176:179], v[56:59], v[152:155]
    v_mfma_f32_16x16x32_bf16 v[152:155], a[180:183], v[60:63], v[152:155]
    v_mfma_f32_16x16x32_bf16 v[156:159], a[184:187], v[60:63], 0
    v_mfma_f32_16x16x32_bf16 v[156:159], a[188:191], v[64:67], v[156:159]
    s_lshl_b32 s76, s42, 10
    s_add_u32 m0, s76, 139264
    s_nop 0
    buffer_load_dwordx4 v20, s[24:27], s55 offen lds
    v_mfma_f32_16x16x32_bf16 v[156:159], a[192:195], v[68:71], v[156:159]
    v_mfma_f32_16x16x32_bf16 v[112:115], a[100:103], v[52:55], 0
    v_mfma_f32_16x16x32_bf16 v[116:119], a[104:107], v[52:55], 0
    v_mfma_f32_16x16x32_bf16 v[116:119], a[108:111], v[56:59], v[116:119]
    s_cmp_ge_u32 s42, 2
    s_cbranch_scc1 KP_X2
    s_lshl_b32 s76, s42, 10
    s_add_u32 m0, s76, 143360
    s_nop 0
    buffer_load_dwordx4 v21, s[24:27], s55 offen lds
KP_X2:
    v_mfma_f32_16x16x32_bf16 v[120:123], a[112:115], v[56:59], 0
    v_mfma_f32_16x16x32_bf16 v[124:127], a[116:119], v[56:59], 0
    v_mfma_f32_16x16x32_bf16 v[124:127], a[120:123], v[60:63], v[124:127]
    v_mfma_f32_16x16x32_bf16 v[128:131], a[124:127], v[60:63], 0
    s_mov_b32 s76, 0
    buffer_load_dwordx4 a[0:3], v5, s[20:23], s76 offen offset:0
    v_mfma_f32_16x16x32_bf16 v[128:131], a[128:131], v[64:67], v[128:131]
    v_mfma_f32_16x16x32_bf16 v[132:135], a[132:135], v[64:67], 0
    v_mfma_f32_16x16x32_bf16 v[136:139], a[136:139], v[64:67], 0
    v_mfma_f32_16x16x32_bf16 v[136:139], a[140:143], v[68:71], v[136:139]
    s_mov_b32 s76, 0
    buffer_load_dwordx4 a[4:7], v5, s[20:23], s76 offen offset:1024
    v_mfma_f32_16x16x32_bf16 v[140:143], a[144:147], v[68:71], 0
    v_mfma_f32_16x16x32_bf16 v[144:147], a[148:151], v[52:55], 0
    v_mfma_f32_16x16x32_bf16 v[144:147], a[152:155], v[56:59], v[144:147]
    v_mfma_f32_16x16x32_bf16 v[144:147], a[156:159], v[60:63], v[144:147]
    s_mov_b32 s76, 0
    buffer_load_dwordx4 a[8:11], v5, s[20:23], s76 offen offset:2048
    v_mfma_f32_16x16x32_bf16 v[148:151], a[160:163], v[60:63], 0
    v_mfma_f32_16x16x32_bf16 v[148:151], a[164:167], v[64:67], v[148:151]
    v_mfma_f32_16x16x32_bf16 v[148:151], a[168:171], v[68:71], v[148:151]
    s_waitcnt vmcnt(15)
    v_mfma_f32_16x16x32_bf16 v[200:203], a[172:175], v[72:75], 0
    s_mov_b32 s76, 0
    buffer_load_dwordx4 a[12:15], v5, s[20:23], s76 offen offset:3072
    v_add_f32 v152, s64, v152
    v_add_f32 v153, s64, v153
    v_add_f32 v154, s64, v154
    v_mfma_f32_16x16x32_bf16 v[200:203], a[176:179], v[76:79], v[200:203]
    v_add_f32 v155, s64, v155
    v_add_f32 v156, s64, v156
    v_add_f32 v157, s64, v157
    v_mfma_f32_16x16x32_bf16 v[200:203], a[180:183], v[80:83], v[200:203]
    s_mov_b32 s76, 4096
    buffer_load_dwordx4 a[16:19], v5, s[20:23], s76 offen offset:0
    v_add_f32 v158, s64, v158
    v_add_f32 v159, s64, v159
    v_rcp_f32 v152, v152
    v_mfma_f32_16x16x32_bf16 v[204:207], a[184:187], v[80:83], 0
    v_rcp_f32 v153, v153
    v_rcp_f32 v154, v154
    v_rcp_f32 v155, v155
    v_mfma_f32_16x16x32_bf16 v[204:207], a[188:191], v[84:87], v[204:207]
    s_mov_b32 s76, 40960
    buffer_load_dwordx4 a[20:23], v5, s[20:23], s76 offen offset:0
    v_rcp_f32 v156, v156
    v_rcp_f32 v157, v157
    v_rcp_f32 v158, v158
    v_mfma_f32_16x16x32_bf16 v[204:207], a[192:195], v[88:91], v[204:207]
    v_rcp_f32 v159, v159
    v_mul_f32 v112, v112, v152
    v_mul_f32 v113, v113, v152
    v_mfma_f32_16x16x32_bf16 v[160:163], a[100:103], v[72:75], 0
    s_mov_b32 s76, 40960
    buffer_load_dwordx4 a[24:27], v5, s[20:23], s76 offen offset:1024
    v_mul_f32 v114, v114, v152
    v_mul_f32 v115, v115, v152
    v_cvt_pk_bf16_f32 v52, v112, v113
    v_mfma_f32_16x16x32_bf16 v[164:167], a[104:107], v[72:75], 0
    v_cvt_pk_bf16_f32 v53, v114, v115
    v_mul_f32 v116, v116, v153
    v_mul_f32 v117, v117, v153
    v_mfma_f32_16x16x32_bf16 v[164:167], a[108:111], v[76:79], v[164:167]
    s_mov_b32 s76, 40960
    buffer_load_dwordx4 a[28:31], v5, s[20:23], s76 offen offset:2048
    v_mul_f32 v118, v118, v153
    v_mul_f32 v119, v119, v153
    v_cvt_pk_bf16_f32 v54, v116, v117
    v_mfma_f32_16x16x32_bf16 v[168:171], a[112:115], v[76:79], 0
    v_cvt_pk_bf16_f32 v55, v118, v119
    v_mul_f32 v120, v120, v154
    v_mul_f32 v121, v121, v154
    v_mfma_f32_16x16x32_bf16 v[172:175], a[116:119], v[76:79], 0
    s_mov_b32 s76, 40960
    buffer_load_dwordx4 a[32:35], v5, s[20:23], s76 offen offset:3072
    v_mul_f32 v122, v122, v154
    v_mul_f32 v123, v123, v154
    v_cvt_pk_bf16_f32 v56, v120, v121
    v_mfma_f32_16x16x32_bf16 v[172:175], a[120:123], v[80:83], v[172:175]
    v_cvt_pk_bf16_f32 v57, v122, v123
    v_mul_f32 v124, v124, v155
    v_mul_f32 v125, v125, v155
    v_mfma_f32_16x16x32_bf16 v[176:179], a[124:127], v[80:83], 0
    s_mov_b32 s76, 45056
    buffer_load_dwordx4 a[36:39], v5, s[20:23], s76 offen offset:0
    v_mul_f32 v126, v126, v155
    v_mul_f32 v127, v127, v155
    v_cvt_pk_bf16_f32 v58, v124, v125
    v_mfma_f32_16x16x32_bf16 v[176:179], a[128:131], v[84:87], v[176:179]
    v_cvt_pk_bf16_f32 v59, v126, v127
    v_mul_f32 v128, v128, v156
    v_mul_f32 v129, v129, v156
    v_mfma_f32_16x16x32_bf16 v[180:183], a[132:135], v[84:87], 0
    s_mov_b32 s76, 81920
    buffer_load_dwordx4 a[40:43], v5, s[20:23], s76 offen offset:0
    v_mul_f32 v130, v130, v156
    v_mul_f32 v131, v131, v156
    v_cvt_pk_bf16_f32 v60, v128, v129
    v_mfma_f32_16x16x32_bf16 v[184:187], a[136:139], v[84:87], 0
    v_cvt_pk_bf16_f32 v61, v130, v131
    v_mul_f32 v132, v132, v157
    v_mul_f32 v133, v133, v157
    v_mfma_f32_16x16x32_bf16 v[184:187], a[140:143], v[88:91], v[184:187]
    s_mov_b32 s76, 81920
    buffer_load_dwordx4 a[44:47], v5, s[20:23], s76 offen offset:1024
    v_mul_f32 v134, v134, v157
    v_mul_f32 v135, v135, v157
    v_cvt_pk_bf16_f32 v62, v132, v133
    v_mfma_f32_16x16x32_bf16 v[188:191], a[144:147], v[88:91], 0
    v_cvt_pk_bf16_f32 v63, v134, v135
    v_mul_f32 v136, v136, v158
    v_mul_f32 v137, v137, v158
    v_mfma_f32_16x16x32_bf16 v[192:195], a[148:151], v[72:75], 0
    s_mov_b32 s76, 81920
    buffer_load_dwordx4 a[48:51], v5, s[20:23], s76 offen offset:2048
    v_mul_f32 v138, v138, v158
    v_mul_f32 v139, v139, v158
    v_cvt_pk_bf16_f32 v64, v136, v137
    v_mfma_f32_16x16x32_bf16 v[192:195], a[152:155], v[76:79], v[192:195]
    v_cvt_pk_bf16_f32 v65, v138, v139
    v_mul_f32 v140, v140, v159
    v_mul_f32 v141, v141, v159
    v_mfma_f32_16x16x32_bf16 v[192:195], a[156:159], v[80:83], v[192:195]
    s_mov_b32 s76, 81920
    buffer_load_dwordx4 a[52:55], v5, s[20:23], s76 offen offset:3072
    v_mul_f32 v142, v142, v159
    v_mul_f32 v143, v143, v159
    v_cvt_pk_bf16_f32 v66, v140, v141
    v_mfma_f32_16x16x32_bf16 v[196:199], a[160:163], v[80:83], 0
    v_cvt_pk_bf16_f32 v67, v142, v143
    v_mul_f32 v144, v144, v152
    v_mul_f32 v145, v145, v153
    v_mfma_f32_16x16x32_bf16 v[196:199], a[164:167], v[84:87], v[196:199]
    s_mov_b32 s76, 86016
    buffer_load_dwordx4 a[56:59], v5, s[20:23], s76 offen offset:0
    v_mul_f32 v146, v146, v154
    v_mul_f32 v147, v147, v155
    v_cvt_pk_bf16_f32 v68, v144, v145
    v_mfma_f32_16x16x32_bf16 v[196:199], a[168:171], v[88:91], v[196:199]
    v_cvt_pk_bf16_f32 v69, v146, v147
    v_mul_f32 v148, v148, v156
    v_mul_f32 v149, v149, v157
    v_mul_f32 v150, v150, v158
    v_mul_f32 v151, v151, v159
    v_cvt_pk_bf16_f32 v70, v148, v149
    v_cvt_pk_bf16_f32 v71, v150, v151
    s_waitcnt vmcnt(22)
    v_mfma_f32_16x16x32_bf16 v[152:155], a[172:175], v[92:95], 0
    s_mov_b32 s76, 122880
    buffer_load_dwordx4 a[60:63], v5, s[20:23], s76 offen offset:0
    v_add_f32 v200, s64, v200
    v_add_f32 v201, s64, v201
    v_add_f32 v202, s64, v202
    v_mfma_f32_16x16x32_bf16 v[152:155], a[176:179], v[96:99], v[152:155]
    v_add_f32 v203, s64, v203
    v_add_f32 v204, s64, v204
    v_add_f32 v205, s64, v205
    v_mfma_f32_16x16x32_bf16 v[152:155], a[180:183], v[100:103], v[152:155]
    s_mov_b32 s76, 122880
    buffer_load_dwordx4 a[64:67], v5, s[20:23], s76 offen offset:1024
    v_add_f32 v206, s64, v206
    v_add_f32 v207, s64, v207
    v_rcp_f32 v200, v200
    v_mfma_f32_16x16x32_bf16 v[156:159], a[184:187], v[100:103], 0
    v_rcp_f32 v201, v201
    v_rcp_f32 v202, v202
    v_rcp_f32 v203, v203
    v_mfma_f32_16x16x32_bf16 v[156:159], a[188:191], v[104:107], v[156:159]
    s_mov_b32 s76, 122880
    buffer_load_dwordx4 a[68:71], v5, s[20:23], s76 offen offset:2048
    v_rcp_f32 v204, v204
    v_rcp_f32 v205, v205
    v_rcp_f32 v206, v206
    v_mfma_f32_16x16x32_bf16 v[156:159], a[192:195], v[108:111], v[156:159]
    v_rcp_f32 v207, v207
    v_mul_f32 v160, v160, v200
    v_mul_f32 v161, v161, v200
    v_mfma_f32_16x16x32_bf16 v[112:115], a[100:103], v[92:95], 0
    s_mov_b32 s76, 122880
    buffer_load_dwordx4 a[72:75], v5, s[20:23], s76 offen offset:3072
    v_mul_f32 v162, v162, v200
    v_mul_f32 v163, v163, v200
    v_cvt_pk_bf16_f32 v72, v160, v161
    v_mfma_f32_16x16x32_bf16 v[116:119], a[104:107], v[92:95], 0
    v_cvt_pk_bf16_f32 v73, v162, v163
    v_mul_f32 v164, v164, v201
    v_mul_f32 v165, v165, v201
    v_mfma_f32_16x16x32_bf16 v[116:119], a[108:111], v[96:99], v[116:119]
    s_mov_b32 s76, 126976
    buffer_load_dwordx4 a[76:79], v5, s[20:23], s76 offen offset:0
    v_mul_f32 v166, v166, v201
    v_mul_f32 v167, v167, v201
    v_cvt_pk_bf16_f32 v74, v164, v165
    v_mfma_f32_16x16x32_bf16 v[120:123], a[112:115], v[96:99], 0
    v_cvt_pk_bf16_f32 v75, v166, v167
    v_mul_f32 v168, v168, v202
    v_mul_f32 v169, v169, v202
    v_mfma_f32_16x16x32_bf16 v[124:127], a[116:119], v[96:99], 0
    s_mov_b32 s76, 163840
    buffer_load_dwordx4 a[80:83], v5, s[20:23], s76 offen offset:0
    v_mul_f32 v170, v170, v202
    v_mul_f32 v171, v171, v202
    v_cvt_pk_bf16_f32 v76, v168, v169
    v_mfma_f32_16x16x32_bf16 v[124:127], a[120:123], v[100:103], v[124:127]
    v_cvt_pk_bf16_f32 v77, v170, v171
    v_mul_f32 v172, v172, v203
    v_mul_f32 v173, v173, v203
    v_mfma_f32_16x16x32_bf16 v[128:131], a[124:127], v[100:103], 0
    s_mov_b32 s76, 163840
    buffer_load_dwordx4 a[84:87], v5, s[20:23], s76 offen offset:1024
    v_mul_f32 v174, v174, v203
    v_mul_f32 v175, v175, v203
    v_cvt_pk_bf16_f32 v78, v172, v173
    v_mfma_f32_16x16x32_bf16 v[128:131], a[128:131], v[104:107], v[128:131]
    v_cvt_pk_bf16_f32 v79, v174, v175
    v_mul_f32 v176, v176, v204
    v_mul_f32 v177, v177, v204
    v_mfma_f32_16x16x32_bf16 v[132:135], a[132:135], v[104:107], 0
    s_mov_b32 s76, 163840
    buffer_load_dwordx4 a[88:91], v5, s[20:23], s76 offen offset:2048
    v_mul_f32 v178, v178, v204
    v_mul_f32 v179, v179, v204
    v_cvt_pk_bf16_f32 v80, v176, v177
    v_mfma_f32_16x16x32_bf16 v[136:139], a[136:139], v[104:107], 0
    v_cvt_pk_bf16_f32 v81, v178, v179
    v_mul_f32 v180, v180, v205
    v_mul_f32 v181, v181, v205
    v_mfma_f32_16x16x32_bf16 v[136:139], a[140:143], v[108:111], v[136:139]
    s_mov_b32 s76, 163840
    buffer_load_dwordx4 a[92:95], v5, s[20:23], s76 offen offset:3072
    v_mul_f32 v182, v182, v205
    v_mul_f32 v183, v183, v205
    v_cvt_pk_bf16_f32 v82, v180, v181
    v_mfma_f32_16x16x32_bf16 v[140:143], a[144:147], v[108:111], 0
    v_cvt_pk_bf16_f32 v83, v182, v183
    v_mul_f32 v184, v184, v206
    v_mul_f32 v185, v185, v206
    v_mfma_f32_16x16x32_bf16 v[144:147], a[148:151], v[92:95], 0
    s_mov_b32 s76, 167936
    buffer_load_dwordx4 a[96:99], v5, s[20:23], s76 offen offset:0
    v_mul_f32 v186, v186, v206
    v_mul_f32 v187, v187, v206
    v_cvt_pk_bf16_f32 v84, v184, v185
    v_mfma_f32_16x16x32_bf16 v[144:147], a[152:155], v[96:99], v[144:147]
    v_cvt_pk_bf16_f32 v85, v186, v187
    v_mul_f32 v188, v188, v207
    v_mul_f32 v189, v189, v207
    v_mfma_f32_16x16x32_bf16 v[144:147], a[156:159], v[100:103], v[144:147]
    s_mov_b32 s76, 17956864
    buffer_load_dwordx2 a[220:221], v15, s[12:15], s76 offen offset:0
    v_mul_f32 v190, v190, v207
    v_mul_f32 v191, v191, v207
    v_cvt_pk_bf16_f32 v86, v188, v189
    v_mfma_f32_16x16x32_bf16 v[148:151], a[160:163], v[100:103], 0
    v_cvt_pk_bf16_f32 v87, v190, v191
    v_mul_f32 v192, v192, v200
    v_mul_f32 v193, v193, v201
    v_mfma_f32_16x16x32_bf16 v[148:151], a[164:167], v[104:107], v[148:151]
    v_mul_f32 v194, v194, v202
    v_mul_f32 v195, v195, v203
    v_cvt_pk_bf16_f32 v88, v192, v193
    v_mfma_f32_16x16x32_bf16 v[148:151], a[168:171], v[108:111], v[148:151]
    v_cvt_pk_bf16_f32 v89, v194, v195
    v_mul_f32 v196, v196, v204
    v_mul_f32 v197, v197, v205
    v_mul_f32 v198, v198, v206
    v_mul_f32 v199, v199, v207
    v_cvt_pk_bf16_f32 v90, v196, v197
    v_cvt_pk_bf16_f32 v91, v198, v199
    s_waitcnt vmcnt(28)
    v_mfma_f32_16x16x32_bf16 v[200:203], a[172:175], v[32:35], 0
    v_add_f32 v152, s64, v152
    v_add_f32 v153, s64, v153
    v_add_f32 v154, s64, v154
    v_mfma_f32_16x16x32_bf16 v[200:203], a[176:179], v[36:39], v[200:203]
    v_add_f32 v155, s64, v155
    v_add_f32 v156, s64, v156
    v_add_f32 v157, s64, v157
    v_mfma_f32_16x16x32_bf16 v[200:203], a[180:183], v[40:43], v[200:203]
    v_add_f32 v158, s64, v158
    v_add_f32 v159, s64, v159
    v_rcp_f32 v152, v152
    v_mfma_f32_16x16x32_bf16 v[204:207], a[184:187], v[40:43], 0
    v_rcp_f32 v153, v153
    v_rcp_f32 v154, v154
    v_rcp_f32 v155, v155
    v_mfma_f32_16x16x32_bf16 v[204:207], a[188:191], v[44:47], v[204:207]
    v_rcp_f32 v156, v156
    v_rcp_f32 v157, v157
    v_rcp_f32 v158, v158
    v_mfma_f32_16x16x32_bf16 v[204:207], a[192:195], v[48:51], v[204:207]
    v_rcp_f32 v159, v159
    v_mul_f32 v112, v112, v152
    v_mul_f32 v113, v113, v152
    v_mfma_f32_16x16x32_bf16 v[160:163], a[100:103], v[32:35], 0
    v_mul_f32 v114, v114, v152
    v_mul_f32 v115, v115, v152
    v_cvt_pk_bf16_f32 v92, v112, v113
    v_mfma_f32_16x16x32_bf16 v[164:167], a[104:107], v[32:35], 0
    v_cvt_pk_bf16_f32 v93, v114, v115
    v_mul_f32 v116, v116, v153
    v_mul_f32 v117, v117, v153
    v_mfma_f32_16x16x32_bf16 v[164:167], a[108:111], v[36:39], v[164:167]
    v_mul_f32 v118, v118, v153
    v_mul_f32 v119, v119, v153
    v_cvt_pk_bf16_f32 v94, v116, v117
    v_mfma_f32_16x16x32_bf16 v[168:171], a[112:115], v[36:39], 0
    v_cvt_pk_bf16_f32 v95, v118, v119
    v_mul_f32 v120, v120, v154
    v_mul_f32 v121, v121, v154
    v_mfma_f32_16x16x32_bf16 v[172:175], a[116:119], v[36:39], 0
    v_mul_f32 v122, v122, v154
    v_mul_f32 v123, v123, v154
    v_cvt_pk_bf16_f32 v96, v120, v121
    v_mfma_f32_16x16x32_bf16 v[172:175], a[120:123], v[40:43], v[172:175]
    v_cvt_pk_bf16_f32 v97, v122, v123
    v_mul_f32 v124, v124, v155
    v_mul_f32 v125, v125, v155
    v_mfma_f32_16x16x32_bf16 v[176:179], a[124:127], v[40:43], 0
    v_mul_f32 v126, v126, v155
    v_mul_f32 v127, v127, v155
    v_cvt_pk_bf16_f32 v98, v124, v125
    v_mfma_f32_16x16x32_bf16 v[176:179], a[128:131], v[44:47], v[176:179]
    v_cvt_pk_bf16_f32 v99, v126, v127
    v_mul_f32 v128, v128, v156
    v_mul_f32 v129, v129, v156
    v_mfma_f32_16x16x32_bf16 v[180:183], a[132:135], v[44:47], 0
    v_mul_f32 v130, v130, v156
    v_mul_f32 v131, v131, v156
    v_cvt_pk_bf16_f32 v100, v128, v129
    v_mfma_f32_16x16x32_bf16 v[184:187], a[136:139], v[44:47], 0
    v_cvt_pk_bf16_f32 v101, v130, v131
    v_mul_f32 v132, v132, v157
    v_mul_f32 v133, v133, v157
    v_mfma_f32_16x16x32_bf16 v[184:187], a[140:143], v[48:51], v[184:187]
    v_mul_f32 v134, v134, v157
    v_mul_f32 v135, v135, v157
    v_cvt_pk_bf16_f32 v102, v132, v133
    v_mfma_f32_16x16x32_bf16 v[188:191], a[144:147], v[48:51], 0
    v_cvt_pk_bf16_f32 v103, v134, v135
    v_mul_f32 v136, v136, v158
    v_mul_f32 v137, v137, v158
    v_mfma_f32_16x16x32_bf16 v[192:195], a[148:151], v[32:35], 0
    v_mul_f32 v138, v138, v158
    v_mul_f32 v139, v139, v158
    v_cvt_pk_bf16_f32 v104, v136, v137
    v_mfma_f32_16x16x32_bf16 v[192:195], a[152:155], v[36:39], v[192:195]
    v_cvt_pk_bf16_f32 v105, v138, v139
    v_mul_f32 v140, v140, v159
    v_mul_f32 v141, v141, v159
    v_mfma_f32_16x16x32_bf16 v[192:195], a[156:159], v[40:43], v[192:195]
    v_mul_f32 v142, v142, v159
    v_mul_f32 v143, v143, v159
    v_cvt_pk_bf16_f32 v106, v140, v141
    v_mfma_f32_16x16x32_bf16 v[196:199], a[160:163], v[40:43], 0
    v_cvt_pk_bf16_f32 v107, v142, v143
    v_mul_f32 v144, v144, v152
    v_mul_f32 v145, v145, v153
    v_mfma_f32_16x16x32_bf16 v[196:199], a[164:167], v[44:47], v[196:199]
    v_mul_f32 v146, v146, v154
    v_mul_f32 v147, v147, v155
    v_cvt_pk_bf16_f32 v108, v144, v145
    v_mfma_f32_16x16x32_bf16 v[196:199], a[168:171], v[48:51], v[196:199]
    v_cvt_pk_bf16_f32 v109, v146, v147
    v_mul_f32 v148, v148, v156
    v_mul_f32 v149, v149, v157
    v_mul_f32 v150, v150, v158
    v_mul_f32 v151, v151, v159
    v_cvt_pk_bf16_f32 v110, v148, v149
    v_cvt_pk_bf16_f32 v111, v150, v151
    s_mul_i32 s48, s42, 2560
    s_add_u32 s48, s48, 135168
    v_mul_u32_u24 v6, 160, v2
    v_lshl_add_u32 v6, v3, 3, v6
    v_add_u32 v6, s48, v6
    s_waitcnt vmcnt(26)
    s_barrier
    s_cmp_lg_u32 s42, 0
    s_cbranch_scc1 KP_XID
    s_mov_b64 exec, 1
    buffer_store_dword v26, v25, s[12:15], 0 offen sc1
    s_mov_b64 exec, -1
KP_XID:
    v_and_b32 v25, 31, v0
    v_lshl_add_u32 v25, v25, 2, s75
    ds_read_b64 v[228:229], v6 offset:0
    ds_read_b64 v[230:231], v6 offset:32
    ds_read_b64 v[232:233], v6 offset:64
    ds_read_b64 v[234:235], v6 offset:96
    ds_read_b64 v[236:237], v6 offset:128
    s_waitcnt lgkmcnt(0)
    s_barrier
    s_lshl_b32 s48, s45, 10
    s_add_u32 s48, s48, 2457600
    s_lshl_b32 s73, s42, 10
    s_add_u32 s72, s48, s73
    s_mul_i32 s49, s42, 110592
    s_add_u32 s78, s48, s49
    s_mul_i32 s79, s42, 3072
    s_mul_i32 s77, s42, 4096
    s_mul_i32 s68, s42, 14
    s_sub_u32 s48, s42, 2
    s_max_i32 s48, s48, 0
    s_sub_u32 s68, s68, s48
    s_mul_i32 s48, s68, 40960
    s_mul_i32 s49, s41, 5120
    s_add_u32 s48, s48, s49
    s_add_u32 s48, s48, 4669440
    v_add_u32 v31, s48, v1
    s_cmp_lt_u32 s42, 2
    s_cselect_b32 s69, 0, 0x7f000000
    s_waitcnt vmcnt(21)
    v_mfma_f32_16x16x32_bf16 v[132:135], a[0:3], v[52:55], 0
    s_mul_i32 s76, s41, 320
    s_add_u32 s76, s76, 18284544
    buffer_load_dwordx4 v[208:211], v29, s[12:15], s76 offen offset:0
    v_add_f32 v200, s64, v200
    v_add_f32 v201, s64, v201
    v_add_f32 v202, s64, v202
    v_add_f32 v203, s64, v203
    v_mfma_f32_16x16x32_bf16 v[136:139], a[4:7], v[52:55], 0
    v_add_f32 v204, s64, v204
    v_add_f32 v205, s64, v205
    v_add_f32 v206, s64, v206
    v_add_f32 v207, s64, v207
    v_mfma_f32_16x16x32_bf16 v[140:143], a[8:11], v[52:55], 0
    v_rcp_f32 v200, v200
    v_rcp_f32 v201, v201
    s_mul_i32 s76, s41, 320
    s_add_u32 s76, s76, 18284544
    buffer_load_dwordx4 v[212:215], v29, s[12:15], s76 offen offset:64
    v_rcp_f32 v202, v202
    v_rcp_f32 v203, v203
    v_mfma_f32_16x16x32_bf16 v[144:147], a[12:15], v[52:55], 0
    v_rcp_f32 v204, v204
    v_rcp_f32 v205, v205
    v_rcp_f32 v206, v206
    v_rcp_f32 v207, v207
    v_mfma_f32_16x16x32_bf16 v[148:151], a[16:19], v[52:55], 0
    s_mul_i32 s76, s41, 320
    s_add_u32 s76, s76, 18284544
    buffer_load_dwordx4 v[216:219], v29, s[12:15], s76 offen offset:128
    v_mul_f32 v160, v160, v200
    v_mul_f32 v161, v161, v200
    v_mul_f32 v162, v162, v200
    v_mul_f32 v163, v163, v200
    s_waitcnt vmcnt(19)
    v_mfma_f32_16x16x32_bf16 v[132:135], a[20:23], v[56:59], v[132:135]
    v_cvt_pk_bf16_f32 v32, v160, v161
    v_cvt_pk_bf16_f32 v33, v162, v163
    v_mul_f32 v164, v164, v201
    v_mul_f32 v165, v165, v201
    v_mfma_f32_16x16x32_bf16 v[136:139], a[24:27], v[56:59], v[136:139]
    v_mul_f32 v166, v166, v201
    v_mul_f32 v167, v167, v201
    v_cvt_pk_bf16_f32 v34, v164, v165
    s_mul_i32 s76, s41, 320
    s_add_u32 s76, s76, 18284544
    buffer_load_dwordx4 v[220:223], v29, s[12:15], s76 offen offset:192
    v_cvt_pk_bf16_f32 v35, v166, v167
    v_mfma_f32_16x16x32_bf16 v[140:143], a[28:31], v[56:59], v[140:143]
    v_mul_f32 v168, v168, v202
    v_mul_f32 v169, v169, v202
    v_mul_f32 v170, v170, v202
    v_mul_f32 v171, v171, v202
    v_mfma_f32_16x16x32_bf16 v[144:147], a[32:35], v[56:59], v[144:147]
    v_cvt_pk_bf16_f32 v36, v168, v169
    v_cvt_pk_bf16_f32 v37, v170, v171
    v_mul_f32 v172, v172, v203
    v_mul_f32 v173, v173, v203
    v_mfma_f32_16x16x32_bf16 v[148:151], a[36:39], v[56:59], v[148:151]
    s_mul_i32 s76, s41, 320
    s_add_u32 s76, s76, 18284544
    buffer_load_dwordx4 v[224:227], v29, s[12:15], s76 offen offset:256
    v_mul_f32 v174, v174, v203
    v_mul_f32 v175, v175, v203
    v_cvt_pk_bf16_f32 v38, v172, v173
    v_cvt_pk_bf16_f32 v39, v174, v175
    s_waitcnt vmcnt(16)
    v_mfma_f32_16x16x32_bf16 v[132:135], a[40:43], v[60:63], v[132:135]
    v_mul_f32 v176, v176, v204
    v_mul_f32 v177, v177, v204
    v_mul_f32 v178, v178, v204
    v_mul_f32 v179, v179, v204
    v_mfma_f32_16x16x32_bf16 v[136:139], a[44:47], v[60:63], v[136:139]
    v_cvt_pk_bf16_f32 v40, v176, v177
    v_cvt_pk_bf16_f32 v41, v178, v179
    v_mul_f32 v180, v180, v205
    s_mov_b32 s76, 819200
    buffer_load_dwordx4 a[100:103], v5, s[20:23], s76 offen offset:0
    v_mul_f32 v181, v181, v205
    v_mfma_f32_16x16x32_bf16 v[140:143], a[48:51], v[60:63], v[140:143]
    v_mul_f32 v182, v182, v205
    v_mul_f32 v183, v183, v205
    v_cvt_pk_bf16_f32 v42, v180, v181
    v_cvt_pk_bf16_f32 v43, v182, v183
    v_mfma_f32_16x16x32_bf16 v[144:147], a[52:55], v[60:63], v[144:147]
    v_mul_f32 v184, v184, v206
    v_mul_f32 v185, v185, v206
    v_mul_f32 v186, v186, v206
    v_mul_f32 v187, v187, v206
    v_mfma_f32_16x16x32_bf16 v[148:151], a[56:59], v[60:63], v[148:151]
    s_mov_b32 s76, 819200
    buffer_load_dwordx4 a[104:107], v5, s[20:23], s76 offen offset:1024
    v_cvt_pk_bf16_f32 v44, v184, v185
    v_cvt_pk_bf16_f32 v45, v186, v187
    v_mul_f32 v188, v188, v207
    v_mul_f32 v189, v189, v207
    s_waitcnt vmcnt(13)
    v_mfma_f32_16x16x32_bf16 v[132:135], a[60:63], v[64:67], v[132:135]
    v_mul_f32 v190, v190, v207
    v_mul_f32 v191, v191, v207
    v_cvt_pk_bf16_f32 v46, v188, v189
    v_cvt_pk_bf16_f32 v47, v190, v191
    v_mfma_f32_16x16x32_bf16 v[136:139], a[64:67], v[64:67], v[136:139]
    v_mul_f32 v192, v192, v200
    v_mul_f32 v193, v193, v201
    v_mul_f32 v194, v194, v202
    s_mov_b32 s76, 819200
    buffer_load_dwordx4 a[108:111], v5, s[20:23], s76 offen offset:2048
    v_mul_f32 v195, v195, v203
    v_mfma_f32_16x16x32_bf16 v[140:143], a[68:71], v[64:67], v[140:143]
    v_cvt_pk_bf16_f32 v48, v192, v193
    v_cvt_pk_bf16_f32 v49, v194, v195
    v_mul_f32 v196, v196, v204
    v_mul_f32 v197, v197, v205
    v_mfma_f32_16x16x32_bf16 v[144:147], a[72:75], v[64:67], v[144:147]
    v_mul_f32 v198, v198, v206
    v_mul_f32 v199, v199, v207
    v_cvt_pk_bf16_f32 v50, v196, v197
    v_cvt_pk_bf16_f32 v51, v198, v199
    v_mfma_f32_16x16x32_bf16 v[148:151], a[76:79], v[64:67], v[148:151]
    s_mov_b32 s76, 819200
    buffer_load_dwordx4 a[112:115], v5, s[20:23], s76 offen offset:3072
    s_waitcnt vmcnt(10)
    v_mfma_f32_16x16x32_bf16 v[132:135], a[80:83], v[68:71], v[132:135]
    v_mfma_f32_16x16x32_bf16 v[136:139], a[84:87], v[68:71], v[136:139]
    v_mfma_f32_16x16x32_bf16 v[140:143], a[88:91], v[68:71], v[140:143]
    v_mfma_f32_16x16x32_bf16 v[144:147], a[92:95], v[68:71], v[144:147]
    v_mfma_f32_16x16x32_bf16 v[148:151], a[96:99], v[68:71], v[148:151]
    s_mov_b32 s76, 823296
    buffer_load_dwordx4 a[116:119], v5, s[20:23], s76 offen offset:0
    v_mfma_f32_16x16x32_bf16 v[152:155], a[0:3], v[72:75], 0
    v_mfma_f32_16x16x32_bf16 v[156:159], a[4:7], v[72:75], 0
    v_mfma_f32_16x16x32_bf16 v[160:163], a[8:11], v[72:75], 0
    v_mfma_f32_16x16x32_bf16 v[164:167], a[12:15], v[72:75], 0
    ds_write_b128 v8, v[132:135] offset:0
    v_mfma_f32_16x16x32_bf16 v[168:171], a[16:19], v[72:75], 0
    s_mov_b32 s76, 860160
    buffer_load_dwordx4 a[120:123], v5, s[20:23], s76 offen offset:0
    v_mfma_f32_16x16x32_bf16 v[152:155], a[20:23], v[76:79], v[152:155]
    v_mfma_f32_16x16x32_bf16 v[156:159], a[24:27], v[76:79], v[156:159]
    v_mfma_f32_16x16x32_bf16 v[160:163], a[28:31], v[76:79], v[160:163]
    ds_write_b128 v8, v[136:139] offset:1024
    v_mfma_f32_16x16x32_bf16 v[164:167], a[32:35], v[76:79], v[164:167]
    v_mfma_f32_16x16x32_bf16 v[168:171], a[36:39], v[76:79], v[168:171]
    s_mov_b32 s76, 860160
    buffer_load_dwordx4 a[124:127], v5, s[20:23], s76 offen offset:1024
    v_mfma_f32_16x16x32_bf16 v[152:155], a[40:43], v[80:83], v[152:155]
    v_mfma_f32_16x16x32_bf16 v[156:159], a[44:47], v[80:83], v[156:159]
    ds_write_b128 v8, v[140:143] offset:2048
    v_mfma_f32_16x16x32_bf16 v[160:163], a[48:51], v[80:83], v[160:163]
    v_mfma_f32_16x16x32_bf16 v[164:167], a[52:55], v[80:83], v[164:167]
    v_mfma_f32_16x16x32_bf16 v[168:171], a[56:59], v[80:83], v[168:171]
    s_mov_b32 s76, 860160
    buffer_load_dwordx4 a[128:131], v5, s[20:23], s76 offen offset:2048
    v_mfma_f32_16x16x32_bf16 v[152:155], a[60:63], v[84:87], v[152:155]
    ds_write_b128 v8, v[144:147] offset:3072
    v_mfma_f32_16x16x32_bf16 v[156:159], a[64:67], v[84:87], v[156:159]
    v_mfma_f32_16x16x32_bf16 v[160:163], a[68:71], v[84:87], v[160:163]
    v_mfma_f32_16x16x32_bf16 v[164:167], a[72:75], v[84:87], v[164:167]
    v_mfma_f32_16x16x32_bf16 v[168:171], a[76:79], v[84:87], v[168:171]
    s_mov_b32 s76, 860160
    buffer_load_dwordx4 a[132:135], v5, s[20:23], s76 offen offset:3072
    ds_write_b128 v8, v[148:151] offset:4096
    v_mfma_f32_16x16x32_bf16 v[152:155], a[80:83], v[88:91], v[152:155]
    v_mfma_f32_16x16x32_bf16 v[156:159], a[84:87], v[88:91], v[156:159]
    v_mfma_f32_16x16x32_bf16 v[160:163], a[88:91], v[88:91], v[160:163]
    v_mfma_f32_16x16x32_bf16 v[164:167], a[92:95], v[88:91], v[164:167]
    v_mfma_f32_16x16x32_bf16 v[168:171], a[96:99], v[88:91], v[168:171]
    s_mov_b32 s76, 864256
    buffer_load_dwordx4 a[136:139], v5, s[20:23], s76 offen offset:0
    v_mfma_f32_16x16x32_bf16 v[172:175], a[0:3], v[92:95], 0
    v_mfma_f32_16x16x32_bf16 v[176:179], a[4:7], v[92:95], 0
    v_mfma_f32_16x16x32_bf16 v[180:183], a[8:11], v[92:95], 0
    v_mfma_f32_16x16x32_bf16 v[184:187], a[12:15], v[92:95], 0
    ds_write_b128 v9, v[152:155] offset:0
    v_mfma_f32_16x16x32_bf16 v[188:191], a[16:19], v[92:95], 0
    s_mov_b32 s76, 901120
    buffer_load_dwordx4 a[140:143], v5, s[20:23], s76 offen offset:0
    v_mfma_f32_16x16x32_bf16 v[172:175], a[20:23], v[96:99], v[172:175]
    v_mfma_f32_16x16x32_bf16 v[176:179], a[24:27], v[96:99], v[176:179]
    v_mfma_f32_16x16x32_bf16 v[180:183], a[28:31], v[96:99], v[180:183]
    ds_write_b128 v9, v[156:159] offset:1024
    v_mfma_f32_16x16x32_bf16 v[184:187], a[32:35], v[96:99], v[184:187]
    v_mfma_f32_16x16x32_bf16 v[188:191], a[36:39], v[96:99], v[188:191]
    s_mov_b32 s76, 901120
    buffer_load_dwordx4 a[144:147], v5, s[20:23], s76 offen offset:1024
    v_mfma_f32_16x16x32_bf16 v[172:175], a[40:43], v[100:103], v[172:175]
    v_mfma_f32_16x16x32_bf16 v[176:179], a[44:47], v[100:103], v[176:179]
    ds_write_b128 v9, v[160:163] offset:2048
    v_mfma_f32_16x16x32_bf16 v[180:183], a[48:51], v[100:103], v[180:183]
    v_mfma_f32_16x16x32_bf16 v[184:187], a[52:55], v[100:103], v[184:187]
    v_mfma_f32_16x16x32_bf16 v[188:191], a[56:59], v[100:103], v[188:191]
    s_mov_b32 s76, 901120
    buffer_load_dwordx4 a[148:151], v5, s[20:23], s76 offen offset:2048
    v_mfma_f32_16x16x32_bf16 v[172:175], a[60:63], v[104:107], v[172:175]
    ds_write_b128 v9, v[164:167] offset:3072
    v_mfma_f32_16x16x32_bf16 v[176:179], a[64:67], v[104:107], v[176:179]
    v_mfma_f32_16x16x32_bf16 v[180:183], a[68:71], v[104:107], v[180:183]
    v_mfma_f32_16x16x32_bf16 v[184:187], a[72:75], v[104:107], v[184:187]
    v_mfma_f32_16x16x32_bf16 v[188:191], a[76:79], v[104:107], v[188:191]
    s_mov_b32 s76, 901120
    buffer_load_dwordx4 a[152:155], v5, s[20:23], s76 offen offset:3072
    ds_write_b128 v9, v[168:171] offset:4096
    v_mfma_f32_16x16x32_bf16 v[172:175], a[80:83], v[108:111], v[172:175]
    v_mfma_f32_16x16x32_bf16 v[176:179], a[84:87], v[108:111], v[176:179]
    v_mfma_f32_16x16x32_bf16 v[180:183], a[88:91], v[108:111], v[180:183]
    v_mfma_f32_16x16x32_bf16 v[184:187], a[92:95], v[108:111], v[184:187]
    v_mfma_f32_16x16x32_bf16 v[188:191], a[96:99], v[108:111], v[188:191]
    s_mov_b32 s76, 905216
    buffer_load_dwordx4 a[156:159], v5, s[20:23], s76 offen offset:0
    v_mfma_f32_16x16x32_bf16 v[112:115], a[0:3], v[32:35], 0
    v_mfma_f32_16x16x32_bf16 v[116:119], a[4:7], v[32:35], 0
    v_mfma_f32_16x16x32_bf16 v[120:123], a[8:11], v[32:35], 0
    v_mfma_f32_16x16x32_bf16 v[124:127], a[12:15], v[32:35], 0
    ds_write_b128 v10, v[172:175] offset:0
    v_mfma_f32_16x16x32_bf16 v[128:131], a[16:19], v[32:35], 0
    s_mov_b32 s76, 942080
    buffer_load_dwordx4 a[160:163], v5, s[20:23], s76 offen offset:0
    v_mfma_f32_16x16x32_bf16 v[112:115], a[20:23], v[36:39], v[112:115]
    v_mfma_f32_16x16x32_bf16 v[116:119], a[24:27], v[36:39], v[116:119]
    v_mfma_f32_16x16x32_bf16 v[120:123], a[28:31], v[36:39], v[120:123]
    ds_write_b128 v10, v[176:179] offset:1024
    v_mfma_f32_16x16x32_bf16 v[124:127], a[32:35], v[36:39], v[124:127]
    v_mfma_f32_16x16x32_bf16 v[128:131], a[36:39], v[36:39], v[128:131]
    s_mov_b32 s76, 942080
    buffer_load_dwordx4 a[164:167], v5, s[20:23], s76 offen offset:1024
    v_mfma_f32_16x16x32_bf16 v[112:115], a[40:43], v[40:43], v[112:115]
    v_mfma_f32_16x16x32_bf16 v[116:119], a[44:47], v[40:43], v[116:119]
    ds_write_b128 v10, v[180:183] offset:2048
    v_mfma_f32_16x16x32_bf16 v[120:123], a[48:51], v[40:43], v[120:123]
    v_mfma_f32_16x16x32_bf16 v[124:127], a[52:55], v[40:43], v[124:127]
    v_mfma_f32_16x16x32_bf16 v[128:131], a[56:59], v[40:43], v[128:131]
    s_mov_b32 s76, 942080
    buffer_load_dwordx4 a[168:171], v5, s[20:23], s76 offen offset:2048
    v_mfma_f32_16x16x32_bf16 v[112:115], a[60:63], v[44:47], v[112:115]
    ds_write_b128 v10, v[184:187] offset:3072
    v_mfma_f32_16x16x32_bf16 v[116:119], a[64:67], v[44:47], v[116:119]
    v_mfma_f32_16x16x32_bf16 v[120:123], a[68:71], v[44:47], v[120:123]
    v_mfma_f32_16x16x32_bf16 v[124:127], a[72:75], v[44:47], v[124:127]
    v_mfma_f32_16x16x32_bf16 v[128:131], a[76:79], v[44:47], v[128:131]
    s_mov_b32 s76, 942080
    buffer_load_dwordx4 a[172:175], v5, s[20:23], s76 offen offset:3072
    ds_write_b128 v10, v[188:191] offset:4096
    v_mfma_f32_16x16x32_bf16 v[112:115], a[80:83], v[48:51], v[112:115]
    v_mfma_f32_16x16x32_bf16 v[116:119], a[84:87], v[48:51], v[116:119]
    v_mfma_f32_16x16x32_bf16 v[120:123], a[88:91], v[48:51], v[120:123]
    v_mfma_f32_16x16x32_bf16 v[124:127], a[92:95], v[48:51], v[124:127]
    v_mfma_f32_16x16x32_bf16 v[128:131], a[96:99], v[48:51], v[128:131]
    s_mov_b32 s76, 946176
    buffer_load_dwordx4 a[176:179], v5, s[20:23], s76 offen offset:0
    buffer_load_dword v26, v25, s[12:15], 0 offen sc1
    s_waitcnt lgkmcnt(0)
    s_barrier
    ds_read_b128 v[132:135], v11 offset:0
    ds_read_b128 v[136:139], v11 offset:1024
    ds_read_b128 v[140:143], v11 offset:2048
    ds_read_b128 v[144:147], v11 offset:3072
    ds_read_b128 v[148:151], v11 offset:4096
    ds_read_b128 v[152:155], v11 offset:5120
    ds_read_b128 v[156:159], v11 offset:6144
    ds_read_b128 v[160:163], v11 offset:7168
    ds_read_b128 v[164:167], v11 offset:8192
    ds_read_b128 v[168:171], v11 offset:9216
    ds_read_b128 v[172:175], v11 offset:10240
    ds_read_b128 v[176:179], v11 offset:11264
    ds_read_b128 v[180:183], v11 offset:12288
    ds_read_b128 v[184:187], v11 offset:13312
    ds_read_b128 v[188:191], v11 offset:14336
    s_waitcnt lgkmcnt(5)
    v_pk_add_f32 v[112:113], v[112:113], v[132:133]
    v_pk_add_f32 v[112:113], v[112:113], v[152:153]
    v_pk_add_f32 v[114:115], v[114:115], v[134:135]
    v_pk_add_f32 v[114:115], v[114:115], v[154:155]
    v_pk_add_f32 v[116:117], v[116:117], v[136:137]
    v_pk_add_f32 v[116:117], v[116:117], v[156:157]
    v_pk_add_f32 v[118:119], v[118:119], v[138:139]
    v_pk_add_f32 v[118:119], v[118:119], v[158:159]
    v_pk_add_f32 v[120:121], v[120:121], v[140:141]
    v_pk_add_f32 v[120:121], v[120:121], v[160:161]
    s_mov_b32 s76, 983040
    buffer_load_dwordx4 a[180:183], v5, s[20:23], s76 offen offset:0
    v_pk_add_f32 v[122:123], v[122:123], v[142:143]
    v_pk_add_f32 v[122:123], v[122:123], v[162:163]
    v_pk_add_f32 v[124:125], v[124:125], v[144:145]
    v_pk_add_f32 v[124:125], v[124:125], v[164:165]
    v_pk_add_f32 v[126:127], v[126:127], v[146:147]
    v_pk_add_f32 v[126:127], v[126:127], v[166:167]
    v_pk_add_f32 v[128:129], v[128:129], v[148:149]
    v_pk_add_f32 v[128:129], v[128:129], v[168:169]
    v_pk_add_f32 v[130:131], v[130:131], v[150:151]
    v_pk_add_f32 v[130:131], v[130:131], v[170:171]
    s_mov_b32 s76, 983040
    buffer_load_dwordx4 a[184:187], v5, s[20:23], s76 offen offset:1024
    s_waitcnt lgkmcnt(0)
    v_pk_add_f32 v[112:113], v[112:113], v[172:173]
    v_pk_add_f32 v[114:115], v[114:115], v[174:175]
    v_pk_add_f32 v[116:117], v[116:117], v[176:177]
    v_pk_add_f32 v[118:119], v[118:119], v[178:179]
    v_pk_add_f32 v[120:121], v[120:121], v[180:181]
    v_pk_add_f32 v[122:123], v[122:123], v[182:183]
    v_pk_add_f32 v[124:125], v[124:125], v[184:185]
    v_pk_add_f32 v[126:127], v[126:127], v[186:187]
    v_pk_add_f32 v[128:129], v[128:129], v[188:189]
    v_pk_add_f32 v[130:131], v[130:131], v[190:191]
    s_mov_b32 s76, 983040
    buffer_load_dwordx4 a[188:191], v5, s[20:23], s76 offen offset:2048
    s_mov_b32 s54, 0
    s_waitcnt vmcnt(3)
    s_nop 1
KP_XP:
    v_cmp_eq_u32 vcc, 0, v26
    s_nop 1
    s_cmp_eq_u64 vcc, 0
    s_cbranch_scc1 KP_XG
    s_add_u32 s54, s54, 1
    s_cmp_ge_u32 s54, 0x80000
    s_cbranch_scc1 KP_XG
    buffer_load_dword v26, v25, s[12:15], 0 offen sc1
    s_waitcnt vmcnt(0)
    s_branch KP_XP
    s_nop 1
KP_XG:
    v_readfirstlane_b32 s48, v26
    s_nop 1
    v_cmp_ne_u32 vcc, s48, v26
    s_nop 1
    s_cmp_eq_u64 vcc, 0
    s_cselect_b32 s74, s48, 0
    v_lshlrev_b32 v204, 16, v228
    v_and_b32 v205, 0xffff0000, v228
    v_pk_add_f32 v[112:113], v[112:113], v[204:205]
    v_lshlrev_b32 v204, 16, v229
    v_and_b32 v205, 0xffff0000, v229
    v_pk_add_f32 v[114:115], v[114:115], v[204:205]
    v_cvt_pk_bf16_f32 v192, v112, v113
    v_cvt_pk_bf16_f32 v193, v114, v115
    v_lshlrev_b32 v204, 16, v230
    v_and_b32 v205, 0xffff0000, v230
    v_pk_add_f32 v[116:117], v[116:117], v[204:205]
    v_lshlrev_b32 v204, 16, v231
    v_and_b32 v205, 0xffff0000, v231
    v_pk_add_f32 v[118:119], v[118:119], v[204:205]
    s_mov_b32 s76, 983040
    buffer_load_dwordx4 a[192:195], v5, s[20:23], s76 offen offset:3072
    v_cvt_pk_bf16_f32 v194, v116, v117
    v_cvt_pk_bf16_f32 v195, v118, v119
    v_lshlrev_b32 v204, 16, v232
    v_and_b32 v205, 0xffff0000, v232
    v_pk_add_f32 v[120:121], v[120:121], v[204:205]
    v_lshlrev_b32 v204, 16, v233
    v_and_b32 v205, 0xffff0000, v233
    v_pk_add_f32 v[122:123], v[122:123], v[204:205]
    v_cvt_pk_bf16_f32 v196, v120, v121
    v_cvt_pk_bf16_f32 v197, v122, v123
    v_lshlrev_b32 v204, 16, v234
    v_and_b32 v205, 0xffff0000, v234
    v_pk_add_f32 v[124:125], v[124:125], v[204:205]
    v_lshlrev_b32 v204, 16, v235
    v_and_b32 v205, 0xffff0000, v235
    v_pk_add_f32 v[126:127], v[126:127], v[204:205]
    s_mov_b32 s76, 987136
    buffer_load_dwordx4 a[196:199], v5, s[20:23], s76 offen offset:0
    v_cvt_pk_bf16_f32 v198, v124, v125
    v_cvt_pk_bf16_f32 v199, v126, v127
    v_lshlrev_b32 v204, 16, v236
    v_and_b32 v205, 0xffff0000, v236
    v_pk_add_f32 v[128:129], v[128:129], v[204:205]
    v_lshlrev_b32 v204, 16, v237
    v_and_b32 v205, 0xffff0000, v237
    v_pk_add_f32 v[130:131], v[130:131], v[204:205]
    v_cvt_pk_bf16_f32 v200, v128, v129
    v_cvt_pk_bf16_f32 v201, v130, v131
    v_accvgpr_write_b32 a232, v192
    v_accvgpr_write_b32 a233, v193
    v_accvgpr_write_b32 a234, v194
    v_accvgpr_write_b32 a235, v195
    v_accvgpr_write_b32 a236, v196
    v_accvgpr_write_b32 a237, v197
    v_accvgpr_write_b32 a238, v198
    v_accvgpr_write_b32 a239, v199
    s_mov_b32 s76, 1638400
    buffer_load_dwordx4 a[0:3], v5, s[20:23], s76 offen offset:0
    v_accvgpr_write_b32 a240, v200
    v_accvgpr_write_b32 a241, v201
    v_lshlrev_b32 v112, 16, v192
    v_and_b32 v113, 0xffff0000, v192
    v_lshlrev_b32 v114, 16, v193
    v_and_b32 v115, 0xffff0000, v193
    v_lshlrev_b32 v116, 16, v194
    v_and_b32 v117, 0xffff0000, v194
    v_lshlrev_b32 v118, 16, v195
    v_and_b32 v119, 0xffff0000, v195
    v_lshlrev_b32 v120, 16, v196
    v_and_b32 v121, 0xffff0000, v196
    v_lshlrev_b32 v122, 16, v197
    v_and_b32 v123, 0xffff0000, v197
    v_lshlrev_b32 v124, 16, v198
    v_and_b32 v125, 0xffff0000, v198
    v_lshlrev_b32 v126, 16, v199
    v_and_b32 v127, 0xffff0000, v199
    v_lshlrev_b32 v128, 16, v200
    v_and_b32 v129, 0xffff0000, v200
    s_mov_b32 s76, 1638400
    buffer_load_dwordx4 a[4:7], v5, s[20:23], s76 offen offset:1024
    v_lshlrev_b32 v130, 16, v201
    v_and_b32 v131, 0xffff0000, v201
    s_mov_b32 s48, 0
    v_permlane16_swap_b32 v192, v194
    v_permlane16_swap_b32 v193, v195
    s_cmp_lg_u32 s74, 0
    s_cbranch_scc1 KP_S1a
    buffer_store_dwordx4 v[192:195], v12, s[12:15], s48 offen offset:0 sc1
    s_branch KP_S1b
KP_S1a:
    buffer_store_dwordx4 v[192:195], v12, s[12:15], s48 offen offset:0
KP_S1b:
    v_permlane16_swap_b32 v196, v198
    v_permlane16_swap_b32 v197, v199
    s_cmp_lg_u32 s74, 0
    s_cbranch_scc1 KP_S2a
    buffer_store_dwordx4 v[196:199], v12, s[12:15], s48 offen offset:1024 sc1
    s_branch KP_S2b
KP_S2a:
    buffer_store_dwordx4 v[196:199], v12, s[12:15], s48 offen offset:1024
KP_S2b:
    s_cmp_lg_u32 s74, 0
    s_cbranch_scc1 KP_S3a
    buffer_store_dwordx2 v[200:201], v13, s[12:15], s48 offen offset:2048 sc1
    s_branch KP_S3b
KP_S3a:
    buffer_store_dwordx2 v[200:201], v13, s[12:15], s48 offen offset:2048
KP_S3b:
    v_pk_mul_f32 v[206:207], v[112:113], v[112:113]
    v_pk_add_f32 v[204:205], v[112:113], v[114:115]
    v_pk_fma_f32 v[206:207], v[114:115], v[114:115], v[206:207]
    v_pk_fma_f32 v[206:207], v[116:117], v[116:117], v[206:207]
    v_pk_add_f32 v[204:205], v[204:205], v[116:117]
    v_pk_fma_f32 v[206:207], v[118:119], v[118:119], v[206:207]
    v_pk_add_f32 v[204:205], v[204:205], v[118:119]
    s_mov_b32 s76, 1638400
    buffer_load_dwordx4 a[8:11], v5, s[20:23], s76 offen offset:2048
    v_pk_fma_f32 v[206:207], v[120:121], v[120:121], v[206:207]
    v_pk_add_f32 v[204:205], v[204:205], v[120:121]
    v_pk_fma_f32 v[206:207], v[122:123], v[122:123], v[206:207]
    v_pk_add_f32 v[204:205], v[204:205], v[122:123]
    v_pk_fma_f32 v[206:207], v[124:125], v[124:125], v[206:207]
    v_pk_add_f32 v[204:205], v[204:205], v[124:125]
    v_pk_fma_f32 v[206:207], v[126:127], v[126:127], v[206:207]
    v_pk_add_f32 v[204:205], v[204:205], v[126:127]
    v_pk_fma_f32 v[206:207], v[128:129], v[128:129], v[206:207]
    v_pk_add_f32 v[204:205], v[204:205], v[128:129]
    s_mov_b32 s76, 1638400
    buffer_load_dwordx4 a[12:15], v5, s[20:23], s76 offen offset:3072
    v_pk_fma_f32 v[206:207], v[130:131], v[130:131], v[206:207]
    v_pk_add_f32 v[204:205], v[204:205], v[130:131]
    v_add_f32 v204, v204, v205
    v_add_f32 v205, v206, v207
    v_mov_b32 v206, v204
    v_mov_b32 v207, v205
    s_nop 0
    v_permlane32_swap_b32 v204, v206
    v_permlane32_swap_b32 v205, v207
    v_add_f32 v204, v204, v206
    v_mov_b32 v206, v204
    v_add_f32 v205, v205, v207
    v_mov_b32 v207, v205
    v_permlane16_swap_b32 v204, v206
    s_nop 0
    v_permlane16_swap_b32 v205, v207
    v_add_f32 v204, v204, v206
    v_add_f32 v205, v205, v207
    s_mov_b32 s48, 17956864
    s_mov_b32 exec_lo, 0xffff
    s_mov_b32 exec_hi, 0x0
    s_cmp_lg_u32 s74, 0
    s_cbranch_scc1 KP_S4a
    buffer_store_dwordx2 v[204:205], v15, s[12:15], s48 offen sc1
    s_branch KP_S4b
KP_S4a:
    buffer_store_dwordx2 v[204:205], v15, s[12:15], s48 offen
KP_S4b:
    s_mov_b64 exec, -1
    s_lshl_b32 s48, s40, 3
    s_add_u32 s48, s48, s41
    s_lshl_b32 s48, s48, 2
    s_add_u32 s48, s48, 18219008
    v_mov_b32 v6, s48
    v_mov_b32 v7, 1
    s_mov_b32 s76, 1642496
    buffer_load_dwordx4 a[16:19], v5, s[20:23], s76 offen offset:0
    s_waitcnt vmcnt(1)
    s_barrier
    s_cmp_lg_u32 s42, 0
    s_cbranch_scc1 KP_PUB0
    s_mov_b64 exec, 1
    s_cmp_lg_u32 s74, 0
    s_cbranch_scc1 KP_S5a
    buffer_store_dword v7, v6, s[12:15], 0 offen sc1
    s_branch KP_S5b
KP_S5a:
    buffer_store_dword v7, v6, s[12:15], 0 offen
KP_S5b:
    s_mov_b64 exec, -1
KP_PUB0:
    s_lshl_b32 s48, s40, 5
    s_add_u32 s48, s48, 18219008
    v_and_b32 v16, 7, v2
    v_lshl_add_u32 v16, v16, 2, s48
    s_mov_b32 s54, 0
    s_nop 3
KP_POLL0:
    buffer_load_dword v7, v16, s[12:15], 0 offen sc1
    s_waitcnt vmcnt(0)
    v_cmp_eq_u32 vcc, 0, v7
    s_nop 1
    s_cmp_eq_u64 vcc, 0
    s_cbranch_scc1 KP_GO0
    s_sleep 1
    s_add_u32 s54, s54, 1
    s_cmp_lt_u32 s54, 0x80000
    s_cbranch_scc1 KP_POLL0
    s_nop 1
KP_GO0:
    s_add_u32 s48, s51, 0
    buffer_load_dwordx4 v[52:55], v4, s[12:15], s48 offen offset:0 sc1
    s_add_u32 s48, s51, 0
    buffer_load_dwordx4 v[56:59], v4, s[12:15], s48 offen offset:1024 sc1
    s_add_u32 s48, s51, 0
    buffer_load_dwordx4 v[60:63], v4, s[12:15], s48 offen offset:2048 sc1
    s_add_u32 s48, s51, 0
    buffer_load_dwordx4 v[64:67], v4, s[12:15], s48 offen offset:3072 sc1
    s_add_u32 s48, s51, 4096
    buffer_load_dwordx4 v[68:71], v4, s[12:15], s48 offen offset:0 sc1
    s_add_u32 s48, s52, 0
    buffer_load_dwordx4 v[72:75], v4, s[12:15], s48 offen offset:0 sc1
    s_add_u32 s48, s52, 0
    buffer_load_dwordx4 v[76:79], v4, s[12:15], s48 offen offset:1024 sc1
    s_add_u32 s48, s52, 0
    buffer_load_dwordx4 v[80:83], v4, s[12:15], s48 offen offset:2048 sc1
    s_add_u32 s48, s52, 0
    buffer_load_dwordx4 v[84:87], v4, s[12:15], s48 offen offset:3072 sc1
    s_add_u32 s48, s52, 4096
    buffer_load_dwordx4 v[88:91], v4, s[12:15], s48 offen offset:0 sc1
    s_waitcnt vmcnt(9)
    v_mfma_f32_16x16x32_bf16 v[132:135], a[100:103], v[52:55], 0
    v_mfma_f32_16x16x32_bf16 v[136:139], a[104:107], v[52:55], 0
    s_add_u32 s48, s53, 0
    buffer_load_dwordx4 v[92:95], v4, s[12:15], s48 offen offset:0 sc1
    v_mfma_f32_16x16x32_bf16 v[140:143], a[108:111], v[52:55], 0
    v_mfma_f32_16x16x32_bf16 v[144:147], a[112:115], v[52:55], 0
    s_add_u32 s48, s53, 0
    buffer_load_dwordx4 v[96:99], v4, s[12:15], s48 offen offset:1024 sc1
    v_mfma_f32_16x16x32_bf16 v[148:151], a[116:119], v[52:55], 0
    s_waitcnt vmcnt(10)
    v_mfma_f32_16x16x32_bf16 v[132:135], a[120:123], v[56:59], v[132:135]
    s_add_u32 s48, s53, 0
    buffer_load_dwordx4 v[100:103], v4, s[12:15], s48 offen offset:2048 sc1
    v_mfma_f32_16x16x32_bf16 v[136:139], a[124:127], v[56:59], v[136:139]
    v_mfma_f32_16x16x32_bf16 v[140:143], a[128:131], v[56:59], v[140:143]
    s_add_u32 s48, s53, 0
    buffer_load_dwordx4 v[104:107], v4, s[12:15], s48 offen offset:3072 sc1
    v_mfma_f32_16x16x32_bf16 v[144:147], a[132:135], v[56:59], v[144:147]
    v_mfma_f32_16x16x32_bf16 v[148:151], a[136:139], v[56:59], v[148:151]
    s_add_u32 s48, s53, 4096
    buffer_load_dwordx4 v[108:111], v4, s[12:15], s48 offen offset:0 sc1
    s_waitcnt vmcnt(12)
    v_mfma_f32_16x16x32_bf16 v[132:135], a[140:143], v[60:63], v[132:135]
    v_mfma_f32_16x16x32_bf16 v[136:139], a[144:147], v[60:63], v[136:139]
    s_add_u32 s48, s50, 0
    buffer_load_dwordx4 v[32:35], v4, s[12:15], s48 offen offset:0 sc1
    v_mfma_f32_16x16x32_bf16 v[140:143], a[148:151], v[60:63], v[140:143]
    v_mfma_f32_16x16x32_bf16 v[144:147], a[152:155], v[60:63], v[144:147]
    s_add_u32 s48, s50, 0
    buffer_load_dwordx4 v[36:39], v4, s[12:15], s48 offen offset:1024 sc1
    v_mfma_f32_16x16x32_bf16 v[148:151], a[156:159], v[60:63], v[148:151]
    s_waitcnt vmcnt(13)
    v_mfma_f32_16x16x32_bf16 v[132:135], a[160:163], v[64:67], v[132:135]
    s_add_u32 s48, s50, 0
    buffer_load_dwordx4 v[40:43], v4, s[12:15], s48 offen offset:2048 sc1
    v_mfma_f32_16x16x32_bf16 v[136:139], a[164:167], v[64:67], v[136:139]
    v_mfma_f32_16x16x32_bf16 v[140:143], a[168:171], v[64:67], v[140:143]
    s_add_u32 s48, s50, 0
    buffer_load_dwordx4 v[44:47], v4, s[12:15], s48 offen offset:3072 sc1
    v_mfma_f32_16x16x32_bf16 v[144:147], a[172:175], v[64:67], v[144:147]
    v_mfma_f32_16x16x32_bf16 v[148:151], a[176:179], v[64:67], v[148:151]
    s_add_u32 s48, s50, 4096
    buffer_load_dwordx4 v[48:51], v4, s[12:15], s48 offen offset:0 sc1
    s_waitcnt vmcnt(15)
    v_mfma_f32_16x16x32_bf16 v[132:135], a[180:183], v[68:71], v[132:135]
    v_mfma_f32_16x16x32_bf16 v[136:139], a[184:187], v[68:71], v[136:139]
    s_mov_b32 s49, 17956864
    buffer_load_dwordx2 v[228:229], v14, s[12:15], s49 offen offset:0 sc1
    v_mfma_f32_16x16x32_bf16 v[140:143], a[188:191], v[68:71], v[140:143]
    v_mfma_f32_16x16x32_bf16 v[144:147], a[192:195], v[68:71], v[144:147]
    s_mov_b32 s49, 17956864
    buffer_load_dwordx2 v[230:231], v14, s[12:15], s49 offen offset:512 sc1
    v_mfma_f32_16x16x32_bf16 v[148:151], a[196:199], v[68:71], v[148:151]
    s_waitcnt vmcnt(16)
    v_mfma_f32_16x16x32_bf16 v[152:155], a[100:103], v[72:75], 0
    v_mfma_f32_16x16x32_bf16 v[156:159], a[104:107], v[72:75], 0
    v_mfma_f32_16x16x32_bf16 v[160:163], a[108:111], v[72:75], 0
    v_mfma_f32_16x16x32_bf16 v[164:167], a[112:115], v[72:75], 0
    ds_write_b128 v8, v[132:135] offset:0
    v_mfma_f32_16x16x32_bf16 v[168:171], a[116:119], v[72:75], 0
    s_waitcnt vmcnt(15)
    v_mfma_f32_16x16x32_bf16 v[152:155], a[120:123], v[76:79], v[152:155]
    v_mfma_f32_16x16x32_bf16 v[156:159], a[124:127], v[76:79], v[156:159]
    v_mfma_f32_16x16x32_bf16 v[160:163], a[128:131], v[76:79], v[160:163]
    ds_write_b128 v8, v[136:139] offset:1024
    v_mfma_f32_16x16x32_bf16 v[164:167], a[132:135], v[76:79], v[164:167]
    v_mfma_f32_16x16x32_bf16 v[168:171], a[136:139], v[76:79], v[168:171]
    s_waitcnt vmcnt(14)
    v_mfma_f32_16x16x32_bf16 v[152:155], a[140:143], v[80:83], v[152:155]
    v_mfma_f32_16x16x32_bf16 v[156:159], a[144:147], v[80:83], v[156:159]
    ds_write_b128 v8, v[140:143] offset:2048
    v_mfma_f32_16x16x32_bf16 v[160:163], a[148:151], v[80:83], v[160:163]
    v_mfma_f32_16x16x32_bf16 v[164:167], a[152:155], v[80:83], v[164:167]
    v_mfma_f32_16x16x32_bf16 v[168:171], a[156:159], v[80:83], v[168:171]
    s_waitcnt vmcnt(13)
    v_mfma_f32_16x16x32_bf16 v[152:155], a[160:163], v[84:87], v[152:155]
    ds_write_b128 v8, v[144:147] offset:3072
    v_mfma_f32_16x16x32_bf16 v[156:159], a[164:167], v[84:87], v[156:159]
    v_mfma_f32_16x16x32_bf16 v[160:163], a[168:171], v[84:87], v[160:163]
    v_mfma_f32_16x16x32_bf16 v[164:167], a[172:175], v[84:87], v[164:167]
    v_mfma_f32_16x16x32_bf16 v[168:171], a[176:179], v[84:87], v[168:171]
    ds_write_b128 v8, v[148:151] offset:4096
    s_waitcnt vmcnt(12)
    v_mfma_f32_16x16x32_bf16 v[152:155], a[180:183], v[88:91], v[152:155]
    v_mfma_f32_16x16x32_bf16 v[156:159], a[184:187], v[88:91], v[156:159]
    v_mfma_f32_16x16x32_bf16 v[160:163], a[188:191], v[88:91], v[160:163]
    v_mfma_f32_16x16x32_bf16 v[164:167], a[192:195], v[88:91], v[164:167]
    v_mfma_f32_16x16x32_bf16 v[168:171], a[196:199], v[88:91], v[168:171]
    s_waitcnt vmcnt(11)
    v_mfma_f32_16x16x32_bf16 v[172:175], a[100:103], v[92:95], 0
    s_mov_b32 s76, 1679360
    buffer_load_dwordx4 a[20:23], v5, s[20:23], s76 offen offset:0
    v_mfma_f32_16x16x32_bf16 v[176:179], a[104:107], v[92:95], 0
    v_mfma_f32_16x16x32_bf16 v[180:183], a[108:111], v[92:95], 0
    v_mfma_f32_16x16x32_bf16 v[184:187], a[112:115], v[92:95], 0
    ds_write_b128 v9, v[152:155] offset:0
    v_mfma_f32_16x16x32_bf16 v[188:191], a[116:119], v[92:95], 0
    s_waitcnt vmcnt(11)
    v_mfma_f32_16x16x32_bf16 v[172:175], a[120:123], v[96:99], v[172:175]
    s_mov_b32 s76, 1679360
    buffer_load_dwordx4 a[24:27], v5, s[20:23], s76 offen offset:1024
    v_mfma_f32_16x16x32_bf16 v[176:179], a[124:127], v[96:99], v[176:179]
    v_mfma_f32_16x16x32_bf16 v[180:183], a[128:131], v[96:99], v[180:183]
    ds_write_b128 v9, v[156:159] offset:1024
    v_mfma_f32_16x16x32_bf16 v[184:187], a[132:135], v[96:99], v[184:187]
    v_mfma_f32_16x16x32_bf16 v[188:191], a[136:139], v[96:99], v[188:191]
    s_waitcnt vmcnt(11)
    v_mfma_f32_16x16x32_bf16 v[172:175], a[140:143], v[100:103], v[172:175]
    s_mov_b32 s76, 1679360
    buffer_load_dwordx4 a[28:31], v5, s[20:23], s76 offen offset:2048
    v_mfma_f32_16x16x32_bf16 v[176:179], a[144:147], v[100:103], v[176:179]
    ds_write_b128 v9, v[160:163] offset:2048
    v_mfma_f32_16x16x32_bf16 v[180:183], a[148:151], v[100:103], v[180:183]
    v_mfma_f32_16x16x32_bf16 v[184:187], a[152:155], v[100:103], v[184:187]
    v_mfma_f32_16x16x32_bf16 v[188:191], a[156:159], v[100:103], v[188:191]
    s_waitcnt vmcnt(11)
    v_mfma_f32_16x16x32_bf16 v[172:175], a[160:163], v[104:107], v[172:175]
    s_mov_b32 s76, 1679360
    buffer_load_dwordx4 a[32:35], v5, s[20:23], s76 offen offset:3072
    ds_write_b128 v9, v[164:167] offset:3072
    v_mfma_f32_16x16x32_bf16 v[176:179], a[164:167], v[104:107], v[176:179]
    v_mfma_f32_16x16x32_bf16 v[180:183], a[168:171], v[104:107], v[180:183]
    v_mfma_f32_16x16x32_bf16 v[184:187], a[172:175], v[104:107], v[184:187]
    v_mfma_f32_16x16x32_bf16 v[188:191], a[176:179], v[104:107], v[188:191]
    ds_write_b128 v9, v[168:171] offset:4096
    s_waitcnt vmcnt(11)
    v_mfma_f32_16x16x32_bf16 v[172:175], a[180:183], v[108:111], v[172:175]
    s_mov_b32 s76, 1683456
    buffer_load_dwordx4 a[36:39], v5, s[20:23], s76 offen offset:0
    v_mfma_f32_16x16x32_bf16 v[176:179], a[184:187], v[108:111], v[176:179]
    v_mfma_f32_16x16x32_bf16 v[180:183], a[188:191], v[108:111], v[180:183]
    v_mfma_f32_16x16x32_bf16 v[184:187], a[192:195], v[108:111], v[184:187]
    v_mfma_f32_16x16x32_bf16 v[188:191], a[196:199], v[108:111], v[188:191]
    s_waitcnt vmcnt(11)
    v_mfma_f32_16x16x32_bf16 v[112:115], a[100:103], v[32:35], 0
    s_mov_b32 s76, 1720320
    buffer_load_dwordx4 a[40:43], v5, s[20:23], s76 offen offset:0
    v_mfma_f32_16x16x32_bf16 v[116:119], a[104:107], v[32:35], 0
    v_mfma_f32_16x16x32_bf16 v[120:123], a[108:111], v[32:35], 0
    v_mfma_f32_16x16x32_bf16 v[124:127], a[112:115], v[32:35], 0
    ds_write_b128 v10, v[172:175] offset:0
    v_mfma_f32_16x16x32_bf16 v[128:131], a[116:119], v[32:35], 0
    s_waitcnt vmcnt(11)
    v_mfma_f32_16x16x32_bf16 v[112:115], a[120:123], v[36:39], v[112:115]
    s_mov_b32 s76, 1720320
    buffer_load_dwordx4 a[44:47], v5, s[20:23], s76 offen offset:1024
    v_mfma_f32_16x16x32_bf16 v[116:119], a[124:127], v[36:39], v[116:119]
    v_mfma_f32_16x16x32_bf16 v[120:123], a[128:131], v[36:39], v[120:123]
    ds_write_b128 v10, v[176:179] offset:1024
    v_mfma_f32_16x16x32_bf16 v[124:127], a[132:135], v[36:39], v[124:127]
    v_mfma_f32_16x16x32_bf16 v[128:131], a[136:139], v[36:39], v[128:131]
    s_waitcnt vmcnt(11)
    v_mfma_f32_16x16x32_bf16 v[112:115], a[140:143], v[40:43], v[112:115]
    s_mov_b32 s76, 1720320
    buffer_load_dwordx4 a[48:51], v5, s[20:23], s76 offen offset:2048
    v_mfma_f32_16x16x32_bf16 v[116:119], a[144:147], v[40:43], v[116:119]
    ds_write_b128 v10, v[180:183] offset:2048
    v_mfma_f32_16x16x32_bf16 v[120:123], a[148:151], v[40:43], v[120:123]
    v_mfma_f32_16x16x32_bf16 v[124:127], a[152:155], v[40:43], v[124:127]
    v_mfma_f32_16x16x32_bf16 v[128:131], a[156:159], v[40:43], v[128:131]
    s_waitcnt vmcnt(11)
    v_mfma_f32_16x16x32_bf16 v[112:115], a[160:163], v[44:47], v[112:115]
    s_mov_b32 s76, 1720320
    buffer_load_dwordx4 a[52:55], v5, s[20:23], s76 offen offset:3072
    ds_write_b128 v10, v[184:187] offset:3072
    v_mfma_f32_16x16x32_bf16 v[116:119], a[164:167], v[44:47], v[116:119]
    v_mfma_f32_16x16x32_bf16 v[120:123], a[168:171], v[44:47], v[120:123]
    v_mfma_f32_16x16x32_bf16 v[124:127], a[172:175], v[44:47], v[124:127]
    v_mfma_f32_16x16x32_bf16 v[128:131], a[176:179], v[44:47], v[128:131]
    ds_write_b128 v10, v[188:191] offset:4096
    s_waitcnt vmcnt(11)
    v_mfma_f32_16x16x32_bf16 v[112:115], a[180:183], v[48:51], v[112:115]
    s_mov_b32 s76, 1724416
    buffer_load_dwordx4 a[56:59], v5, s[20:23], s76 offen offset:0
    v_mfma_f32_16x16x32_bf16 v[116:119], a[184:187], v[48:51], v[116:119]
    v_mfma_f32_16x16x32_bf16 v[120:123], a[188:191], v[48:51], v[120:123]
    v_mfma_f32_16x16x32_bf16 v[124:127], a[192:195], v[48:51], v[124:127]
    v_mfma_f32_16x16x32_bf16 v[128:131], a[196:199], v[48:51], v[128:131]
    s_waitcnt vmcnt(10)
    v_add_f32 v228, v228, v230
    v_add_f32 v229, v229, v231
    s_mov_b32 s76, 1761280
    buffer_load_dwordx4 a[60:63], v5, s[20:23], s76 offen offset:0
    v_mov_b32 v230, v228
    v_mov_b32 v231, v229
    s_nop 0
    v_permlane32_swap_b32 v228, v230
    v_permlane32_swap_b32 v229, v231
    v_add_f32 v228, v228, v230
    v_add_f32 v229, v229, v231
    v_mov_b32 v230, v228
    v_mov_b32 v231, v229
    s_nop 0
    v_permlane16_swap_b32 v228, v230
    v_permlane16_swap_b32 v229, v231
    v_add_f32 v228, v228, v230
    v_add_f32 v229, v229, v231
    v_mul_f32 v232, s62, v228
    v_mul_f32 v233, s62, v229
    v_fma_f32 v233, -v232, v232, v233
    v_max_f32 v233, 0, v233
    v_add_f32 v234, s63, v233
    v_rsq_f32 v234, v234
    s_nop 0
    v_mul_f32 v235, v234, v234
    s_mov_b32 s76, 1761280
    buffer_load_dwordx4 a[64:67], v5, s[20:23], s76 offen offset:1024
    v_fma_f32 v235, v233, v235, s63
    v_rsq_f32 v235, v235
    v_mul_f32 v232, v232, v234
    v_sub_f32 v232, 0, v232
    v_accvgpr_write_b32 a252, v232
    v_accvgpr_write_b32 a253, v234
    v_mul_f32 v234, v235, v234
    v_mul_f32 v235, v235, v232
    s_waitcnt lgkmcnt(0)
    s_barrier
    ds_read_b128 v[132:135], v11 offset:0
    ds_read_b128 v[136:139], v11 offset:1024
    ds_read_b128 v[140:143], v11 offset:2048
    ds_read_b128 v[144:147], v11 offset:3072
    ds_read_b128 v[148:151], v11 offset:4096
    ds_read_b128 v[152:155], v11 offset:5120
    ds_read_b128 v[156:159], v11 offset:6144
    ds_read_b128 v[160:163], v11 offset:7168
    ds_read_b128 v[164:167], v11 offset:8192
    ds_read_b128 v[168:171], v11 offset:9216
    ds_read_b128 v[172:175], v11 offset:10240
    ds_read_b128 v[176:179], v11 offset:11264
    ds_read_b128 v[180:183], v11 offset:12288
    ds_read_b128 v[184:187], v11 offset:13312
    ds_read_b128 v[188:191], v11 offset:14336
    s_waitcnt lgkmcnt(5)
    v_pk_add_f32 v[112:113], v[112:113], v[132:133]
    v_pk_add_f32 v[112:113], v[112:113], v[152:153]
    v_pk_add_f32 v[114:115], v[114:115], v[134:135]
    v_pk_add_f32 v[114:115], v[114:115], v[154:155]
    v_pk_add_f32 v[116:117], v[116:117], v[136:137]
    v_pk_add_f32 v[116:117], v[116:117], v[156:157]
    s_mov_b32 s76, 1761280
    buffer_load_dwordx4 a[68:71], v5, s[20:23], s76 offen offset:2048
    v_pk_add_f32 v[118:119], v[118:119], v[138:139]
    v_pk_add_f32 v[118:119], v[118:119], v[158:159]
    v_pk_add_f32 v[120:121], v[120:121], v[140:141]
    v_pk_add_f32 v[120:121], v[120:121], v[160:161]
    v_pk_add_f32 v[122:123], v[122:123], v[142:143]
    v_pk_add_f32 v[122:123], v[122:123], v[162:163]
    v_pk_add_f32 v[124:125], v[124:125], v[144:145]
    v_pk_add_f32 v[124:125], v[124:125], v[164:165]
    v_pk_add_f32 v[126:127], v[126:127], v[146:147]
    v_pk_add_f32 v[126:127], v[126:127], v[166:167]
    s_mov_b32 s76, 1761280
    buffer_load_dwordx4 a[72:75], v5, s[20:23], s76 offen offset:3072
    v_pk_add_f32 v[128:129], v[128:129], v[148:149]
    v_pk_add_f32 v[128:129], v[128:129], v[168:169]
    v_pk_add_f32 v[130:131], v[130:131], v[150:151]
    v_pk_add_f32 v[130:131], v[130:131], v[170:171]
    s_waitcnt lgkmcnt(0)
    v_pk_add_f32 v[112:113], v[112:113], v[172:173]
    v_pk_add_f32 v[114:115], v[114:115], v[174:175]
    v_pk_add_f32 v[116:117], v[116:117], v[176:177]
    v_pk_add_f32 v[118:119], v[118:119], v[178:179]
    v_pk_add_f32 v[120:121], v[120:121], v[180:181]
    v_pk_add_f32 v[122:123], v[122:123], v[182:183]
    s_mov_b32 s76, 1765376
    buffer_load_dwordx4 a[76:79], v5, s[20:23], s76 offen offset:0
    v_pk_add_f32 v[124:125], v[124:125], v[184:185]
    v_pk_add_f32 v[126:127], v[126:127], v[186:187]
    v_pk_add_f32 v[128:129], v[128:129], v[188:189]
    v_pk_add_f32 v[130:131], v[130:131], v[190:191]
    v_mul_f32 v204, v208, v235
    v_mul_f32 v205, v209, v235
    v_mul_f32 v206, v210, v235
    v_mul_f32 v207, v211, v235
    v_fma_f32 v112, v112, v234, v204
    v_fma_f32 v113, v113, v234, v205
    v_fma_f32 v114, v114, v234, v206
    v_fma_f32 v115, v115, v234, v207
    v_mul_f32 v204, v112, v112
    v_mul_f32 v205, v113, v113
    v_mul_f32 v206, v114, v114
    v_mul_f32 v207, v115, v115
    s_mov_b32 s76, 1802240
    buffer_load_dwordx4 a[80:83], v5, s[20:23], s76 offen offset:0
    v_fma_f32 v204, v204, s58, v28
    v_fma_f32 v205, v205, s58, v28
    v_fma_f32 v206, v206, s58, v28
    v_fma_f32 v207, v207, s58, v28
    v_mul_f32 v204, v204, v112
    v_mul_f32 v205, v205, v113
    v_mul_f32 v206, v206, v114
    v_mul_f32 v207, v207, v115
    v_exp_f32 v204, v204
    v_exp_f32 v205, v205
    v_exp_f32 v206, v206
    v_exp_f32 v207, v207
    v_add_f32 v204, 1.0, v204
    v_add_f32 v205, 1.0, v205
    v_add_f32 v206, 1.0, v206
    v_add_f32 v207, 1.0, v207
    s_mov_b32 s76, 1802240
    buffer_load_dwordx4 a[84:87], v5, s[20:23], s76 offen offset:1024
    v_rcp_f32 v204, v204
    v_rcp_f32 v205, v205
    v_rcp_f32 v206, v206
    v_rcp_f32 v207, v207
    v_mul_f32 v112, v112, v204
    v_mul_f32 v113, v113, v205
    v_mul_f32 v114, v114, v206
    v_mul_f32 v115, v115, v207
    v_cvt_pk_bf16_f32 v192, v112, v113
    v_cvt_pk_bf16_f32 v193, v114, v115
    v_mul_f32 v204, v212, v235
    v_mul_f32 v205, v213, v235
    v_mul_f32 v206, v214, v235
    v_mul_f32 v207, v215, v235
    v_fma_f32 v116, v116, v234, v204
    v_fma_f32 v117, v117, v234, v205
    s_mov_b32 s76, 1802240
    buffer_load_dwordx4 a[88:91], v5, s[20:23], s76 offen offset:2048
    v_fma_f32 v118, v118, v234, v206
    v_fma_f32 v119, v119, v234, v207
    v_mul_f32 v204, v116, v116
    v_mul_f32 v205, v117, v117
    v_mul_f32 v206, v118, v118
    v_mul_f32 v207, v119, v119
    v_fma_f32 v204, v204, s58, v28
    v_fma_f32 v205, v205, s58, v28
    v_fma_f32 v206, v206, s58, v28
    v_fma_f32 v207, v207, s58, v28
    v_mul_f32 v204, v204, v116
    v_mul_f32 v205, v205, v117
    v_mul_f32 v206, v206, v118
    v_mul_f32 v207, v207, v119
    v_exp_f32 v204, v204
    v_exp_f32 v205, v205
    v_exp_f32 v206, v206
    s_mov_b32 s76, 1802240
    buffer_load_dwordx4 a[92:95], v5, s[20:23], s76 offen offset:3072
    v_exp_f32 v207, v207
    v_add_f32 v204, 1.0, v204
    v_add_f32 v205, 1.0, v205
    v_add_f32 v206, 1.0, v206
    v_add_f32 v207, 1.0, v207
    v_rcp_f32 v204, v204
    v_rcp_f32 v205, v205
    v_rcp_f32 v206, v206
    v_rcp_f32 v207, v207
    v_mul_f32 v116, v116, v204
    v_mul_f32 v117, v117, v205
    v_mul_f32 v118, v118, v206
    v_mul_f32 v119, v119, v207
    v_cvt_pk_bf16_f32 v194, v116, v117
    v_cvt_pk_bf16_f32 v195, v118, v119
    s_mov_b32 s76, 1806336
    buffer_load_dwordx4 a[96:99], v5, s[20:23], s76 offen offset:0
    v_mul_f32 v204, v216, v235
    v_mul_f32 v205, v217, v235
    v_mul_f32 v206, v218, v235
    v_mul_f32 v207, v219, v235
    v_fma_f32 v120, v120, v234, v204
    v_fma_f32 v121, v121, v234, v205
    v_fma_f32 v122, v122, v234, v206
    v_fma_f32 v123, v123, v234, v207
    v_mul_f32 v204, v120, v120
    v_mul_f32 v205, v121, v121
    v_mul_f32 v206, v122, v122
    v_mul_f32 v207, v123, v123
    v_fma_f32 v204, v204, s58, v28
    v_fma_f32 v205, v205, s58, v28
    v_fma_f32 v206, v206, s58, v28
    v_fma_f32 v207, v207, s58, v28
    v_mul_f32 v204, v204, v120
    v_mul_f32 v205, v205, v121
    v_mul_f32 v206, v206, v122
    v_mul_f32 v207, v207, v123
    s_add_u32 m0, s73, 0
    s_add_u32 s76, s72, 0
    buffer_load_dwordx4 v1, s[20:23], s76 offen lds
    v_exp_f32 v204, v204
    v_exp_f32 v205, v205
    v_exp_f32 v206, v206
    v_exp_f32 v207, v207
    v_add_f32 v204, 1.0, v204
    v_add_f32 v205, 1.0, v205
    v_add_f32 v206, 1.0, v206
    v_add_f32 v207, 1.0, v207
    v_rcp_f32 v204, v204
    v_rcp_f32 v205, v205
    v_rcp_f32 v206, v206
    v_rcp_f32 v207, v207
    s_add_u32 m0, s73, 4096
    s_add_u32 s76, s72, 110592
    buffer_load_dwordx4 v1, s[20:23], s76 offen lds
    v_mul_f32 v120, v120, v204
    v_mul_f32 v121, v121, v205
    v_mul_f32 v122, v122, v206
    v_mul_f32 v123, v123, v207
    v_cvt_pk_bf16_f32 v196, v120, v121
    v_cvt_pk_bf16_f32 v197, v122, v123
    v_mul_f32 v204, v220, v235
    v_mul_f32 v205, v221, v235
    v_mul_f32 v206, v222, v235
    v_mul_f32 v207, v223, v235
    v_fma_f32 v124, v124, v234, v204
    v_fma_f32 v125, v125, v234, v205
    v_fma_f32 v126, v126, v234, v206
    v_fma_f32 v127, v127, v234, v207
    v_mul_f32 v204, v124, v124
    v_mul_f32 v205, v125, v125
    v_mul_f32 v206, v126, v126
    v_mul_f32 v207, v127, v127
    v_fma_f32 v204, v204, s58, v28
    v_fma_f32 v205, v205, s58, v28
    s_add_u32 m0, s73, 8192
    s_add_u32 s76, s72, 221184
    buffer_load_dwordx4 v1, s[20:23], s76 offen lds
    v_fma_f32 v206, v206, s58, v28
    v_fma_f32 v207, v207, s58, v28
    v_mul_f32 v204, v204, v124
    v_mul_f32 v205, v205, v125
    v_mul_f32 v206, v206, v126
    v_mul_f32 v207, v207, v127
    v_exp_f32 v204, v204
    v_exp_f32 v205, v205
    v_exp_f32 v206, v206
    v_exp_f32 v207, v207
    v_add_f32 v204, 1.0, v204
    v_add_f32 v205, 1.0, v205
    v_add_f32 v206, 1.0, v206
    v_add_f32 v207, 1.0, v207
    v_rcp_f32 v204, v204
    s_add_u32 m0, s73, 12288
    s_add_u32 s76, s72, 331776
    buffer_load_dwordx4 v1, s[20:23], s76 offen lds
    v_rcp_f32 v205, v205
    v_rcp_f32 v206, v206
    v_rcp_f32 v207, v207
    v_mul_f32 v124, v124, v204
    v_mul_f32 v125, v125, v205
    v_mul_f32 v126, v126, v206
    v_mul_f32 v127, v127, v207
    v_cvt_pk_bf16_f32 v198, v124, v125
    v_cvt_pk_bf16_f32 v199, v126, v127
    v_mul_f32 v204, v224, v235
    v_mul_f32 v205, v225, v235
    v_mul_f32 v206, v226, v235
    v_mul_f32 v207, v227, v235
    v_fma_f32 v128, v128, v234, v204
    v_fma_f32 v129, v129, v234, v205
    v_fma_f32 v130, v130, v234, v206
    v_fma_f32 v131, v131, v234, v207
    s_add_u32 m0, s73, 16384
    s_add_u32 s76, s72, 442368
    buffer_load_dwordx4 v1, s[20:23], s76 offen lds
    v_mul_f32 v204, v128, v128
    v_mul_f32 v205, v129, v129
    v_mul_f32 v206, v130, v130
    v_mul_f32 v207, v131, v131
    v_fma_f32 v204, v204, s58, v28
    v_fma_f32 v205, v205, s58, v28
    v_fma_f32 v206, v206, s58, v28
    v_fma_f32 v207, v207, s58, v28
    v_mul_f32 v204, v204, v128
    v_mul_f32 v205, v205, v129
    v_mul_f32 v206, v206, v130
    v_mul_f32 v207, v207, v131
    v_exp_f32 v204, v204
    v_exp_f32 v205, v205
    v_exp_f32 v206, v206
    v_exp_f32 v207, v207
    s_add_u32 m0, s73, 20480
    s_add_u32 s76, s72, 552960
    buffer_load_dwordx4 v1, s[20:23], s76 offen lds
    v_add_f32 v204, 1.0, v204
    v_add_f32 v205, 1.0, v205
    v_add_f32 v206, 1.0, v206
    v_add_f32 v207, 1.0, v207
    v_rcp_f32 v204, v204
    v_rcp_f32 v205, v205
    v_rcp_f32 v206, v206
    v_rcp_f32 v207, v207
    v_mul_f32 v128, v128, v204
    v_mul_f32 v129, v129, v205
    v_mul_f32 v130, v130, v206
    v_mul_f32 v131, v131, v207
    v_cvt_pk_bf16_f32 v200, v128, v129
    v_cvt_pk_bf16_f32 v201, v130, v131
    s_mov_b32 s48, 5242880
    v_permlane16_swap_b32 v192, v194
    v_permlane16_swap_b32 v193, v195
    s_add_u32 m0, s73, 24576
    s_add_u32 s76, s72, 663552
    buffer_load_dwordx4 v1, s[20:23], s76 offen lds
    buffer_store_dwordx4 v[192:195], v12, s[12:15], s48 offen offset:0 sc1
    v_permlane16_swap_b32 v196, v198
    v_permlane16_swap_b32 v197, v199
    buffer_store_dwordx4 v[196:199], v12, s[12:15], s48 offen offset:1024 sc1
    buffer_store_dwordx2 v[200:201], v13, s[12:15], s48 offen offset:2048 sc1
    s_lshl_b32 s48, s40, 3
    s_add_u32 s48, s48, s41
    s_lshl_b32 s48, s48, 2
    s_add_u32 s48, s48, 18220032
    v_mov_b32 v6, s48
    v_mov_b32 v7, 1
    s_waitcnt vmcnt(0)
    s_barrier
    s_cmp_lg_u32 s42, 0
    s_cbranch_scc1 KP_PUB1
    s_mov_b64 exec, 1
    buffer_store_dword v7, v6, s[12:15], 0 offen sc1
    s_mov_b64 exec, -1
KP_PUB1:
    s_max_i32 s48, s40, 1
    s_sub_u32 s48, s48, 1
    s_min_u32 s49, s40, 30
    s_add_u32 s49, s49, 1
    v_mov_b32 v6, s48
    v_mov_b32 v7, s49
    v_and_b32 v16, 2, v2
    v_cmp_eq_u32 vcc, 0, v16
    s_nop 1
    v_cndmask_b32 v6, v7, v6, vcc
    v_mov_b32 v7, s40
    v_cmp_gt_u32 vcc, 8, v2
    s_nop 1
    v_cndmask_b32 v6, v6, v7, vcc
    v_and_b32 v7, 7, v2
    v_lshl_add_u32 v6, v6, 3, v7
    v_lshlrev_b32 v6, 2, v6
    v_add_u32 v16, 18220032, v6
    s_and_b32 s55, s42, 1
    s_cmp_eq_u32 s55, 0
    s_cselect_b32 s48, s48, s49
    v_mov_b32 v6, s48
    v_mov_b32 v7, s40
    v_and_b32 v16, 2, v2
    v_cmp_eq_u32 vcc, 0, v16
    s_add_u32 m0, s73, 28672
    s_add_u32 s76, s72, 774144
    buffer_load_dwordx4 v1, s[20:23], s76 offen lds
    v_cndmask_b32 v6, v6, v7, vcc
    s_lshl_b32 s48, s42, 1
    v_and_b32 v7, 1, v2
    v_lshl_add_u32 v6, v6, 3, v7
    v_add_u32 v6, s48, v6
    v_lshlrev_b32 v6, 2, v6
    v_add_u32 v16, 18220032, v6
    s_and_b32 s48, s42, 1
    s_cmp_eq_u32 s48, 0
    s_cselect_b32 s48, -1, 1
    s_lshr_b32 s49, s42, 1
    s_add_u32 s49, s49, 1
    s_mul_i32 s49, s49, s48
    s_mul_i32 s64, s42, 5120
    s_mov_b32 s65, 20480
    s_add_u32 s55, s42, 0
    s_and_b32 s55, s55, 3
    s_lshl_b32 s55, s55, 4
    s_and_b32 s66, s40, 31
    s_lshl_b32 s66, s66, 6
    s_add_u32 s55, s55, s66
    s_add_i32 s55, s55, s49
    v_add_u32 v6, s55, v2
    v_ashrrev_i32 v7, 4, v6
    v_mul_lo_u32 v7, v7, s65
    v_and_b32 v6, 15, v6
    v_lshl_add_u32 v7, v6, 4, v7
    v_lshl_add_u32 v7, v3, 8, v7
    v_add_u32 v20, s64, v7
    s_add_u32 s55, s42, 1
    s_and_b32 s55, s55, 3
    s_lshl_b32 s55, s55, 4
    s_and_b32 s66, s40, 31
    s_lshl_b32 s66, s66, 6
    s_add_u32 s55, s55, s66
    s_add_i32 s55, s55, s49
    v_add_u32 v6, s55, v2
    v_ashrrev_i32 v7, 4, v6
    v_mul_lo_u32 v7, v7, s65
    v_and_b32 v6, 15, v6
    v_lshl_add_u32 v7, v6, 4, v7
    v_lshl_add_u32 v7, v3, 8, v7
    v_add_u32 v21, s64, v7
    s_add_u32 m0, s73, 32768
    s_add_u32 s76, s72, 884736
    buffer_load_dwordx4 v1, s[20:23], s76 offen lds
    s_add_u32 s55, s42, 2
    s_and_b32 s55, s55, 3
    s_lshl_b32 s55, s55, 4
    s_and_b32 s66, s40, 31
    s_lshl_b32 s66, s66, 6
    s_add_u32 s55, s55, s66
    s_add_i32 s55, s55, s49
    v_add_u32 v6, s55, v2
    v_ashrrev_i32 v7, 4, v6
    v_mul_lo_u32 v7, v7, s65
    v_and_b32 v6, 15, v6
    v_lshl_add_u32 v7, v6, 4, v7
    v_lshl_add_u32 v7, v3, 8, v7
    v_add_u32 v22, s64, v7
    s_add_u32 s55, s42, 3
    s_and_b32 s55, s55, 3
    s_lshl_b32 s55, s55, 4
    s_and_b32 s66, s40, 31
    s_lshl_b32 s66, s66, 6
    s_add_u32 s55, s55, s66
    s_add_i32 s55, s55, s49
    v_add_u32 v6, s55, v2
    v_ashrrev_i32 v7, 4, v6
    v_mul_lo_u32 v7, v7, s65
    v_and_b32 v6, 15, v6
    v_lshl_add_u32 v7, v6, 4, v7
    v_lshl_add_u32 v7, v3, 8, v7
    v_add_u32 v23, s64, v7
    s_mov_b32 s65, 4096
    s_mov_b32 s54, 0
    s_nop 2
KP_POLL1:
    buffer_load_dword v7, v16, s[12:15], 0 offen sc1
    s_waitcnt vmcnt(0)
    v_cmp_eq_u32 vcc, 0, v7
    s_nop 1
    s_cmp_eq_u64 vcc, 0
    s_cbranch_scc1 KP_GO1
    s_sleep 1
    s_add_u32 s54, s54, 1
    s_cmp_lt_u32 s54, 0x80000
    s_cbranch_scc1 KP_POLL1
    s_nop 1
KP_GO1:
    buffer_load_dwordx4 v[52:55], v21, s[16:19], 0 offen offset:0 sc1
    buffer_load_dwordx4 v[56:59], v21, s[16:19], 0 offen offset:1024 sc1
    buffer_load_dwordx4 v[60:63], v21, s[16:19], 0 offen offset:2048 sc1
    buffer_load_dwordx4 v[64:67], v21, s[16:19], 0 offen offset:3072 sc1
    buffer_load_dwordx4 v[68:71], v21, s[16:19], s65 offen offset:0 sc1
    buffer_load_dwordx4 v[72:75], v22, s[16:19], 0 offen offset:0 sc1
    buffer_load_dwordx4 v[76:79], v22, s[16:19], 0 offen offset:1024 sc1
    buffer_load_dwordx4 v[80:83], v22, s[16:19], 0 offen offset:2048 sc1
    buffer_load_dwordx4 v[84:87], v22, s[16:19], 0 offen offset:3072 sc1
    buffer_load_dwordx4 v[88:91], v22, s[16:19], s65 offen offset:0 sc1
    s_waitcnt vmcnt(9)
    v_mfma_f32_16x16x32_bf16 v[132:135], a[0:3], v[52:55], 0
    v_mfma_f32_16x16x32_bf16 v[136:139], a[4:7], v[52:55], 0
    buffer_load_dwordx4 v[92:95], v23, s[16:19], 0 offen offset:0 sc1
    v_mfma_f32_16x16x32_bf16 v[140:143], a[8:11], v[52:55], 0
    v_mfma_f32_16x16x32_bf16 v[144:147], a[12:15], v[52:55], 0
    buffer_load_dwordx4 v[96:99], v23, s[16:19], 0 offen offset:1024 sc1
    v_mfma_f32_16x16x32_bf16 v[148:151], a[16:19], v[52:55], 0
    s_waitcnt vmcnt(10)
    v_mfma_f32_16x16x32_bf16 v[132:135], a[20:23], v[56:59], v[132:135]
    buffer_load_dwordx4 v[100:103], v23, s[16:19], 0 offen offset:2048 sc1
    v_mfma_f32_16x16x32_bf16 v[136:139], a[24:27], v[56:59], v[136:139]
    v_mfma_f32_16x16x32_bf16 v[140:143], a[28:31], v[56:59], v[140:143]
    buffer_load_dwordx4 v[104:107], v23, s[16:19], 0 offen offset:3072 sc1
    v_mfma_f32_16x16x32_bf16 v[144:147], a[32:35], v[56:59], v[144:147]
    v_mfma_f32_16x16x32_bf16 v[148:151], a[36:39], v[56:59], v[148:151]
    buffer_load_dwordx4 v[108:111], v23, s[16:19], s65 offen offset:0 sc1
    s_waitcnt vmcnt(12)
    v_mfma_f32_16x16x32_bf16 v[132:135], a[40:43], v[60:63], v[132:135]
    v_mfma_f32_16x16x32_bf16 v[136:139], a[44:47], v[60:63], v[136:139]
    buffer_load_dwordx4 v[32:35], v20, s[16:19], 0 offen offset:0 sc1
    v_mfma_f32_16x16x32_bf16 v[140:143], a[48:51], v[60:63], v[140:143]
    v_mfma_f32_16x16x32_bf16 v[144:147], a[52:55], v[60:63], v[144:147]
    buffer_load_dwordx4 v[36:39], v20, s[16:19], 0 offen offset:1024 sc1
    v_mfma_f32_16x16x32_bf16 v[148:151], a[56:59], v[60:63], v[148:151]
    s_waitcnt vmcnt(13)
    v_mfma_f32_16x16x32_bf16 v[132:135], a[60:63], v[64:67], v[132:135]
    buffer_load_dwordx4 v[40:43], v20, s[16:19], 0 offen offset:2048 sc1
    v_mfma_f32_16x16x32_bf16 v[136:139], a[64:67], v[64:67], v[136:139]
    v_mfma_f32_16x16x32_bf16 v[140:143], a[68:71], v[64:67], v[140:143]
    buffer_load_dwordx4 v[44:47], v20, s[16:19], 0 offen offset:3072 sc1
    v_mfma_f32_16x16x32_bf16 v[144:147], a[72:75], v[64:67], v[144:147]
    v_mfma_f32_16x16x32_bf16 v[148:151], a[76:79], v[64:67], v[148:151]
    buffer_load_dwordx4 v[48:51], v20, s[16:19], s65 offen offset:0 sc1
    s_waitcnt vmcnt(15)
    v_mfma_f32_16x16x32_bf16 v[132:135], a[80:83], v[68:71], v[132:135]
    v_mfma_f32_16x16x32_bf16 v[136:139], a[84:87], v[68:71], v[136:139]
    v_mfma_f32_16x16x32_bf16 v[140:143], a[88:91], v[68:71], v[140:143]
    v_mfma_f32_16x16x32_bf16 v[144:147], a[92:95], v[68:71], v[144:147]
    v_mfma_f32_16x16x32_bf16 v[148:151], a[96:99], v[68:71], v[148:151]
    s_waitcnt vmcnt(14)
    v_mfma_f32_16x16x32_bf16 v[152:155], a[0:3], v[72:75], 0
    v_mfma_f32_16x16x32_bf16 v[156:159], a[4:7], v[72:75], 0
    v_mfma_f32_16x16x32_bf16 v[160:163], a[8:11], v[72:75], 0
    v_mfma_f32_16x16x32_bf16 v[164:167], a[12:15], v[72:75], 0
    ds_write_b128 v8, v[132:135] offset:0
    v_mfma_f32_16x16x32_bf16 v[168:171], a[16:19], v[72:75], 0
    s_waitcnt vmcnt(13)
    v_mfma_f32_16x16x32_bf16 v[152:155], a[20:23], v[76:79], v[152:155]
    v_mfma_f32_16x16x32_bf16 v[156:159], a[24:27], v[76:79], v[156:159]
    v_mfma_f32_16x16x32_bf16 v[160:163], a[28:31], v[76:79], v[160:163]
    ds_write_b128 v8, v[136:139] offset:1024
    v_mfma_f32_16x16x32_bf16 v[164:167], a[32:35], v[76:79], v[164:167]
    v_mfma_f32_16x16x32_bf16 v[168:171], a[36:39], v[76:79], v[168:171]
    s_waitcnt vmcnt(12)
    v_mfma_f32_16x16x32_bf16 v[152:155], a[40:43], v[80:83], v[152:155]
    v_mfma_f32_16x16x32_bf16 v[156:159], a[44:47], v[80:83], v[156:159]
    ds_write_b128 v8, v[140:143] offset:2048
    v_mfma_f32_16x16x32_bf16 v[160:163], a[48:51], v[80:83], v[160:163]
    v_mfma_f32_16x16x32_bf16 v[164:167], a[52:55], v[80:83], v[164:167]
    v_mfma_f32_16x16x32_bf16 v[168:171], a[56:59], v[80:83], v[168:171]
    s_waitcnt vmcnt(11)
    v_mfma_f32_16x16x32_bf16 v[152:155], a[60:63], v[84:87], v[152:155]
    ds_write_b128 v8, v[144:147] offset:3072
    v_mfma_f32_16x16x32_bf16 v[156:159], a[64:67], v[84:87], v[156:159]
    v_mfma_f32_16x16x32_bf16 v[160:163], a[68:71], v[84:87], v[160:163]
    v_mfma_f32_16x16x32_bf16 v[164:167], a[72:75], v[84:87], v[164:167]
    v_mfma_f32_16x16x32_bf16 v[168:171], a[76:79], v[84:87], v[168:171]
    ds_write_b128 v8, v[148:151] offset:4096
    s_waitcnt vmcnt(10)
    v_mfma_f32_16x16x32_bf16 v[152:155], a[80:83], v[88:91], v[152:155]
    v_mfma_f32_16x16x32_bf16 v[156:159], a[84:87], v[88:91], v[156:159]
    v_mfma_f32_16x16x32_bf16 v[160:163], a[88:91], v[88:91], v[160:163]
    v_mfma_f32_16x16x32_bf16 v[164:167], a[92:95], v[88:91], v[164:167]
    v_mfma_f32_16x16x32_bf16 v[168:171], a[96:99], v[88:91], v[168:171]
    s_waitcnt vmcnt(9)
    v_mfma_f32_16x16x32_bf16 v[172:175], a[0:3], v[92:95], 0
    s_add_u32 m0, s73, 36864
    s_add_u32 s76, s72, 995328
    buffer_load_dwordx4 v1, s[20:23], s76 offen lds
    v_mfma_f32_16x16x32_bf16 v[176:179], a[4:7], v[92:95], 0
    v_mfma_f32_16x16x32_bf16 v[180:183], a[8:11], v[92:95], 0
    v_mfma_f32_16x16x32_bf16 v[184:187], a[12:15], v[92:95], 0
    ds_write_b128 v9, v[152:155] offset:0
    v_mfma_f32_16x16x32_bf16 v[188:191], a[16:19], v[92:95], 0
    s_waitcnt vmcnt(9)
    v_mfma_f32_16x16x32_bf16 v[172:175], a[20:23], v[96:99], v[172:175]
    s_add_u32 m0, s73, 40960
    s_add_u32 s76, s72, 1105920
    buffer_load_dwordx4 v1, s[20:23], s76 offen lds
    v_mfma_f32_16x16x32_bf16 v[176:179], a[24:27], v[96:99], v[176:179]
    v_mfma_f32_16x16x32_bf16 v[180:183], a[28:31], v[96:99], v[180:183]
    ds_write_b128 v9, v[156:159] offset:1024
    v_mfma_f32_16x16x32_bf16 v[184:187], a[32:35], v[96:99], v[184:187]
    v_mfma_f32_16x16x32_bf16 v[188:191], a[36:39], v[96:99], v[188:191]
    s_waitcnt vmcnt(9)
    v_mfma_f32_16x16x32_bf16 v[172:175], a[40:43], v[100:103], v[172:175]
    s_add_u32 m0, s73, 45056
    s_add_u32 s76, s72, 1216512
    buffer_load_dwordx4 v1, s[20:23], s76 offen lds
    v_mfma_f32_16x16x32_bf16 v[176:179], a[44:47], v[100:103], v[176:179]
    ds_write_b128 v9, v[160:163] offset:2048
    v_mfma_f32_16x16x32_bf16 v[180:183], a[48:51], v[100:103], v[180:183]
    v_mfma_f32_16x16x32_bf16 v[184:187], a[52:55], v[100:103], v[184:187]
    v_mfma_f32_16x16x32_bf16 v[188:191], a[56:59], v[100:103], v[188:191]
    s_waitcnt vmcnt(9)
    v_mfma_f32_16x16x32_bf16 v[172:175], a[60:63], v[104:107], v[172:175]
    s_add_u32 m0, s73, 49152
    s_add_u32 s76, s72, 1327104
    buffer_load_dwordx4 v1, s[20:23], s76 offen lds
    ds_write_b128 v9, v[164:167] offset:3072
    v_mfma_f32_16x16x32_bf16 v[176:179], a[64:67], v[104:107], v[176:179]
    v_mfma_f32_16x16x32_bf16 v[180:183], a[68:71], v[104:107], v[180:183]
    v_mfma_f32_16x16x32_bf16 v[184:187], a[72:75], v[104:107], v[184:187]
    v_mfma_f32_16x16x32_bf16 v[188:191], a[76:79], v[104:107], v[188:191]
    ds_write_b128 v9, v[168:171] offset:4096
    s_waitcnt vmcnt(9)
    v_mfma_f32_16x16x32_bf16 v[172:175], a[80:83], v[108:111], v[172:175]
    s_add_u32 m0, s73, 53248
    s_add_u32 s76, s72, 1437696
    buffer_load_dwordx4 v1, s[20:23], s76 offen lds
    v_mfma_f32_16x16x32_bf16 v[176:179], a[84:87], v[108:111], v[176:179]
    v_mfma_f32_16x16x32_bf16 v[180:183], a[88:91], v[108:111], v[180:183]
    v_mfma_f32_16x16x32_bf16 v[184:187], a[92:95], v[108:111], v[184:187]
    v_mfma_f32_16x16x32_bf16 v[188:191], a[96:99], v[108:111], v[188:191]
    s_waitcnt vmcnt(9)
    v_mfma_f32_16x16x32_bf16 v[112:115], a[0:3], v[32:35], 0
    s_add_u32 m0, s73, 57344
    s_add_u32 s76, s72, 1548288
    buffer_load_dwordx4 v1, s[20:23], s76 offen lds
    v_mfma_f32_16x16x32_bf16 v[116:119], a[4:7], v[32:35], 0
    v_mfma_f32_16x16x32_bf16 v[120:123], a[8:11], v[32:35], 0
    v_mfma_f32_16x16x32_bf16 v[124:127], a[12:15], v[32:35], 0
    ds_write_b128 v10, v[172:175] offset:0
    v_mfma_f32_16x16x32_bf16 v[128:131], a[16:19], v[32:35], 0
    s_waitcnt vmcnt(9)
    v_mfma_f32_16x16x32_bf16 v[112:115], a[20:23], v[36:39], v[112:115]
    s_add_u32 m0, s73, 61440
    s_add_u32 s76, s72, 1658880
    buffer_load_dwordx4 v1, s[20:23], s76 offen lds
    v_mfma_f32_16x16x32_bf16 v[116:119], a[24:27], v[36:39], v[116:119]
    v_mfma_f32_16x16x32_bf16 v[120:123], a[28:31], v[36:39], v[120:123]
    ds_write_b128 v10, v[176:179] offset:1024
    v_mfma_f32_16x16x32_bf16 v[124:127], a[32:35], v[36:39], v[124:127]
    v_mfma_f32_16x16x32_bf16 v[128:131], a[36:39], v[36:39], v[128:131]
    s_waitcnt vmcnt(9)
    v_mfma_f32_16x16x32_bf16 v[112:115], a[40:43], v[40:43], v[112:115]
    s_add_u32 m0, s73, 65536
    s_add_u32 s76, s72, 1769472
    buffer_load_dwordx4 v1, s[20:23], s76 offen lds
    v_mfma_f32_16x16x32_bf16 v[116:119], a[44:47], v[40:43], v[116:119]
    ds_write_b128 v10, v[180:183] offset:2048
    v_mfma_f32_16x16x32_bf16 v[120:123], a[48:51], v[40:43], v[120:123]
    v_mfma_f32_16x16x32_bf16 v[124:127], a[52:55], v[40:43], v[124:127]
    v_mfma_f32_16x16x32_bf16 v[128:131], a[56:59], v[40:43], v[128:131]
    s_waitcnt vmcnt(9)
    v_mfma_f32_16x16x32_bf16 v[112:115], a[60:63], v[44:47], v[112:115]
    s_add_u32 m0, s73, 69632
    s_add_u32 s76, s72, 1880064
    buffer_load_dwordx4 v1, s[20:23], s76 offen lds
    ds_write_b128 v10, v[184:187] offset:3072
    v_mfma_f32_16x16x32_bf16 v[116:119], a[64:67], v[44:47], v[116:119]
    v_mfma_f32_16x16x32_bf16 v[120:123], a[68:71], v[44:47], v[120:123]
    v_mfma_f32_16x16x32_bf16 v[124:127], a[72:75], v[44:47], v[124:127]
    v_mfma_f32_16x16x32_bf16 v[128:131], a[76:79], v[44:47], v[128:131]
    ds_write_b128 v10, v[188:191] offset:4096
    s_waitcnt vmcnt(9)
    v_mfma_f32_16x16x32_bf16 v[112:115], a[80:83], v[48:51], v[112:115]
    s_add_u32 m0, s73, 73728
    s_add_u32 s76, s72, 1990656
    buffer_load_dwordx4 v1, s[20:23], s76 offen lds
    v_mfma_f32_16x16x32_bf16 v[116:119], a[84:87], v[48:51], v[116:119]
    v_mfma_f32_16x16x32_bf16 v[120:123], a[88:91], v[48:51], v[120:123]
    v_mfma_f32_16x16x32_bf16 v[124:127], a[92:95], v[48:51], v[124:127]
    v_mfma_f32_16x16x32_bf16 v[128:131], a[96:99], v[48:51], v[128:131]
    v_accvgpr_read_b32 v234, a252
    v_accvgpr_read_b32 v235, a253
    s_add_u32 m0, s73, 77824
    s_add_u32 s76, s72, 2101248
    buffer_load_dwordx4 v1, s[20:23], s76 offen lds
    v_accvgpr_read_b32 v206, a232
    v_lshlrev_b32 v208, 16, v206
    v_and_b32 v209, 0xffff0000, v206
    v_accvgpr_read_b32 v206, a233
    v_lshlrev_b32 v210, 16, v206
    v_and_b32 v211, 0xffff0000, v206
    v_accvgpr_read_b32 v206, a234
    v_lshlrev_b32 v212, 16, v206
    v_and_b32 v213, 0xffff0000, v206
    v_accvgpr_read_b32 v206, a235
    v_lshlrev_b32 v214, 16, v206
    v_and_b32 v215, 0xffff0000, v206
    v_accvgpr_read_b32 v206, a236
    v_lshlrev_b32 v216, 16, v206
    v_and_b32 v217, 0xffff0000, v206
    v_accvgpr_read_b32 v206, a237
    v_lshlrev_b32 v218, 16, v206
    v_and_b32 v219, 0xffff0000, v206
    v_accvgpr_read_b32 v206, a238
    v_lshlrev_b32 v220, 16, v206
    s_mov_b32 s76, 0
    buffer_load_dwordx4 a[100:103], v31, s[20:23], s76 offen offset:0
    v_and_b32 v221, 0xffff0000, v206
    v_accvgpr_read_b32 v206, a239
    v_lshlrev_b32 v222, 16, v206
    v_and_b32 v223, 0xffff0000, v206
    v_accvgpr_read_b32 v206, a240
    v_lshlrev_b32 v224, 16, v206
    v_and_b32 v225, 0xffff0000, v206
    v_accvgpr_read_b32 v206, a241
    v_lshlrev_b32 v226, 16, v206
    v_and_b32 v227, 0xffff0000, v206
    v_fma_f32 v208, v208, v235, v234
    v_fma_f32 v209, v209, v235, v234
    v_fma_f32 v210, v210, v235, v234
    v_fma_f32 v211, v211, v235, v234
    v_fma_f32 v212, v212, v235, v234
    v_fma_f32 v213, v213, v235, v234
    v_fma_f32 v214, v214, v235, v234
    v_fma_f32 v215, v215, v235, v234
    v_fma_f32 v216, v216, v235, v234
    v_fma_f32 v217, v217, v235, v234
    s_mov_b32 s76, 0
    buffer_load_dwordx4 a[104:107], v31, s[20:23], s76 offen offset:1024
    v_fma_f32 v218, v218, v235, v234
    v_fma_f32 v219, v219, v235, v234
    v_fma_f32 v220, v220, v235, v234
    v_fma_f32 v221, v221, v235, v234
    v_fma_f32 v222, v222, v235, v234
    v_fma_f32 v223, v223, v235, v234
    v_fma_f32 v224, v224, v235, v234
    v_fma_f32 v225, v225, v235, v234
    v_fma_f32 v226, v226, v235, v234
    v_fma_f32 v227, v227, v235, v234
    s_waitcnt lgkmcnt(0)
    s_barrier
    ds_read_b128 v[132:135], v11 offset:0
    ds_read_b128 v[136:139], v11 offset:1024
    ds_read_b128 v[140:143], v11 offset:2048
    ds_read_b128 v[144:147], v11 offset:3072
    ds_read_b128 v[148:151], v11 offset:4096
    ds_read_b128 v[152:155], v11 offset:5120
    ds_read_b128 v[156:159], v11 offset:6144
    ds_read_b128 v[160:163], v11 offset:7168
    ds_read_b128 v[164:167], v11 offset:8192
    ds_read_b128 v[168:171], v11 offset:9216
    ds_read_b128 v[172:175], v11 offset:10240
    ds_read_b128 v[176:179], v11 offset:11264
    ds_read_b128 v[180:183], v11 offset:12288
    ds_read_b128 v[184:187], v11 offset:13312
    ds_read_b128 v[188:191], v11 offset:14336
    s_waitcnt lgkmcnt(5)
    v_pk_add_f32 v[112:113], v[112:113], v[132:133]
    v_pk_add_f32 v[112:113], v[112:113], v[152:153]
    v_pk_add_f32 v[114:115], v[114:115], v[134:135]
    v_pk_add_f32 v[114:115], v[114:115], v[154:155]
    v_pk_add_f32 v[116:117], v[116:117], v[136:137]
    s_mov_b32 s76, 0
    buffer_load_dwordx4 a[108:111], v31, s[20:23], s76 offen offset:2048
    v_pk_add_f32 v[116:117], v[116:117], v[156:157]
    v_pk_add_f32 v[118:119], v[118:119], v[138:139]
    v_pk_add_f32 v[118:119], v[118:119], v[158:159]
    v_pk_add_f32 v[120:121], v[120:121], v[140:141]
    v_pk_add_f32 v[120:121], v[120:121], v[160:161]
    v_pk_add_f32 v[122:123], v[122:123], v[142:143]
    v_pk_add_f32 v[122:123], v[122:123], v[162:163]
    v_pk_add_f32 v[124:125], v[124:125], v[144:145]
    v_pk_add_f32 v[124:125], v[124:125], v[164:165]
    v_pk_add_f32 v[126:127], v[126:127], v[146:147]
    s_mov_b32 s76, 0
    buffer_load_dwordx4 a[112:115], v31, s[20:23], s76 offen offset:3072
    v_pk_add_f32 v[126:127], v[126:127], v[166:167]
    v_pk_add_f32 v[128:129], v[128:129], v[148:149]
    v_pk_add_f32 v[128:129], v[128:129], v[168:169]
    v_pk_add_f32 v[130:131], v[130:131], v[150:151]
    v_pk_add_f32 v[130:131], v[130:131], v[170:171]
    s_waitcnt lgkmcnt(0)
    v_pk_add_f32 v[112:113], v[112:113], v[172:173]
    v_pk_add_f32 v[114:115], v[114:115], v[174:175]
    v_pk_add_f32 v[116:117], v[116:117], v[176:177]
    v_pk_add_f32 v[118:119], v[118:119], v[178:179]
    v_pk_add_f32 v[120:121], v[120:121], v[180:181]
    s_mov_b32 s76, 4096
    buffer_load_dwordx4 a[116:119], v31, s[20:23], s76 offen offset:0
    v_pk_add_f32 v[122:123], v[122:123], v[182:183]
    v_pk_add_f32 v[124:125], v[124:125], v[184:185]
    v_pk_add_f32 v[126:127], v[126:127], v[186:187]
    v_pk_add_f32 v[128:129], v[128:129], v[188:189]
    v_pk_add_f32 v[130:131], v[130:131], v[190:191]
    v_pk_add_f32 v[112:113], v[112:113], v[208:209]
    v_pk_add_f32 v[114:115], v[114:115], v[210:211]
    v_cvt_pk_bf16_f32 v192, v112, v113
    v_cvt_pk_bf16_f32 v193, v114, v115
    v_pk_add_f32 v[116:117], v[116:117], v[212:213]
    v_pk_add_f32 v[118:119], v[118:119], v[214:215]
    s_mov_b32 s76, 40960
    buffer_load_dwordx4 a[120:123], v31, s[20:23], s76 offen offset:0
    v_cvt_pk_bf16_f32 v194, v116, v117
    v_cvt_pk_bf16_f32 v195, v118, v119
    v_pk_add_f32 v[120:121], v[120:121], v[216:217]
    v_pk_add_f32 v[122:123], v[122:123], v[218:219]
    v_cvt_pk_bf16_f32 v196, v120, v121
    v_cvt_pk_bf16_f32 v197, v122, v123
    v_pk_add_f32 v[124:125], v[124:125], v[220:221]
    v_pk_add_f32 v[126:127], v[126:127], v[222:223]
    v_cvt_pk_bf16_f32 v198, v124, v125
    v_cvt_pk_bf16_f32 v199, v126, v127
    v_pk_add_f32 v[128:129], v[128:129], v[224:225]
    v_pk_add_f32 v[130:131], v[130:131], v[226:227]
    v_cvt_pk_bf16_f32 v200, v128, v129
    v_cvt_pk_bf16_f32 v201, v130, v131
    s_mov_b32 s76, 40960
    buffer_load_dwordx4 a[124:127], v31, s[20:23], s76 offen offset:1024
    v_accvgpr_write_b32 a242, v192
    v_accvgpr_write_b32 a243, v193
    v_accvgpr_write_b32 a244, v194
    v_accvgpr_write_b32 a245, v195
    v_accvgpr_write_b32 a246, v196
    v_accvgpr_write_b32 a247, v197
    v_accvgpr_write_b32 a248, v198
    v_accvgpr_write_b32 a249, v199
    v_accvgpr_write_b32 a250, v200
    v_accvgpr_write_b32 a251, v201
    v_lshlrev_b32 v112, 16, v192
    v_and_b32 v113, 0xffff0000, v192
    v_lshlrev_b32 v114, 16, v193
    v_and_b32 v115, 0xffff0000, v193
    v_lshlrev_b32 v116, 16, v194
    v_and_b32 v117, 0xffff0000, v194
    v_lshlrev_b32 v118, 16, v195
    v_and_b32 v119, 0xffff0000, v195
    v_lshlrev_b32 v120, 16, v196
    v_and_b32 v121, 0xffff0000, v196
    s_mov_b32 s76, 40960
    buffer_load_dwordx4 a[128:131], v31, s[20:23], s76 offen offset:2048
    v_lshlrev_b32 v122, 16, v197
    v_and_b32 v123, 0xffff0000, v197
    v_lshlrev_b32 v124, 16, v198
    v_and_b32 v125, 0xffff0000, v198
    v_lshlrev_b32 v126, 16, v199
    v_and_b32 v127, 0xffff0000, v199
    v_lshlrev_b32 v128, 16, v200
    v_and_b32 v129, 0xffff0000, v200
    v_lshlrev_b32 v130, 16, v201
    v_and_b32 v131, 0xffff0000, v201
    s_mov_b32 s48, 0
    v_permlane16_swap_b32 v192, v194
    v_permlane16_swap_b32 v193, v195
    s_cmp_lg_u32 s74, 0
    s_cbranch_scc1 KP_S6a
    buffer_store_dwordx4 v[192:195], v12, s[12:15], s48 offen offset:0 sc1
    s_branch KP_S6b
KP_S6a:
    buffer_store_dwordx4 v[192:195], v12, s[12:15], s48 offen offset:0
KP_S6b:
    v_permlane16_swap_b32 v196, v198
    v_permlane16_swap_b32 v197, v199
    s_cmp_lg_u32 s74, 0
    s_cbranch_scc1 KP_S7a
    buffer_store_dwordx4 v[196:199], v12, s[12:15], s48 offen offset:1024 sc1
    s_branch KP_S7b
KP_S7a:
    buffer_store_dwordx4 v[196:199], v12, s[12:15], s48 offen offset:1024
KP_S7b:
    s_cmp_lg_u32 s74, 0
    s_cbranch_scc1 KP_S8a
    buffer_store_dwordx2 v[200:201], v13, s[12:15], s48 offen offset:2048 sc1
    s_branch KP_S8b
KP_S8a:
    buffer_store_dwordx2 v[200:201], v13, s[12:15], s48 offen offset:2048
KP_S8b:
    v_pk_mul_f32 v[206:207], v[112:113], v[112:113]
    v_pk_add_f32 v[204:205], v[112:113], v[114:115]
    v_pk_fma_f32 v[206:207], v[114:115], v[114:115], v[206:207]
    s_mov_b32 s76, 40960
    buffer_load_dwordx4 a[132:135], v31, s[20:23], s76 offen offset:3072
    v_pk_fma_f32 v[206:207], v[116:117], v[116:117], v[206:207]
    v_pk_add_f32 v[204:205], v[204:205], v[116:117]
    v_pk_fma_f32 v[206:207], v[118:119], v[118:119], v[206:207]
    v_pk_add_f32 v[204:205], v[204:205], v[118:119]
    v_pk_fma_f32 v[206:207], v[120:121], v[120:121], v[206:207]
    v_pk_add_f32 v[204:205], v[204:205], v[120:121]
    v_pk_fma_f32 v[206:207], v[122:123], v[122:123], v[206:207]
    v_pk_add_f32 v[204:205], v[204:205], v[122:123]
    v_pk_fma_f32 v[206:207], v[124:125], v[124:125], v[206:207]
    v_pk_add_f32 v[204:205], v[204:205], v[124:125]
    s_mov_b32 s76, 45056
    buffer_load_dwordx4 a[136:139], v31, s[20:23], s76 offen offset:0
    v_pk_fma_f32 v[206:207], v[126:127], v[126:127], v[206:207]
    v_pk_add_f32 v[204:205], v[204:205], v[126:127]
    v_pk_fma_f32 v[206:207], v[128:129], v[128:129], v[206:207]
    v_pk_add_f32 v[204:205], v[204:205], v[128:129]
    v_pk_fma_f32 v[206:207], v[130:131], v[130:131], v[206:207]
    v_pk_add_f32 v[204:205], v[204:205], v[130:131]
    v_add_f32 v204, v204, v205
    v_add_f32 v205, v206, v207
    v_mov_b32 v206, v204
    v_mov_b32 v207, v205
    s_nop 0
    v_permlane32_swap_b32 v204, v206
    v_permlane32_swap_b32 v205, v207
    v_add_f32 v204, v204, v206
    v_mov_b32 v206, v204
    s_mov_b32 s76, 81920
    buffer_load_dwordx4 a[140:143], v31, s[20:23], s76 offen offset:0
    v_add_f32 v205, v205, v207
    v_mov_b32 v207, v205
    v_permlane16_swap_b32 v204, v206
    s_nop 0
    v_permlane16_swap_b32 v205, v207
    v_add_f32 v204, v204, v206
    v_add_f32 v205, v205, v207
    s_mov_b32 s48, 17956864
    s_mov_b32 exec_lo, 0xffff
    s_mov_b32 exec_hi, 0x0
    s_cmp_lg_u32 s74, 0
    s_cbranch_scc1 KP_S9a
    buffer_store_dwordx2 v[204:205], v15, s[12:15], s48 offen sc1
    s_branch KP_S9b
KP_S9a:
    buffer_store_dwordx2 v[204:205], v15, s[12:15], s48 offen
KP_S9b:
    s_mov_b64 exec, -1
    s_lshl_b32 s48, s40, 3
    s_add_u32 s48, s48, s41
    s_lshl_b32 s48, s48, 2
    s_add_u32 s48, s48, 18221056
    v_mov_b32 v6, s48
    v_mov_b32 v7, 1
    s_waitcnt vmcnt(0)
    s_barrier
    s_cmp_lg_u32 s42, 0
    s_cbranch_scc1 KP_PUB2
    s_mov_b64 exec, 1
    s_cmp_lg_u32 s74, 0
    s_cbranch_scc1 KP_S10a
    buffer_store_dword v7, v6, s[12:15], 0 offen sc1
    s_branch KP_S10b
KP_S10a:
    buffer_store_dword v7, v6, s[12:15], 0 offen
KP_S10b:
    s_mov_b64 exec, -1
KP_PUB2:
    s_lshl_b32 s48, s43, 6
    s_add_u32 s48, s48, 18221056
    v_lshl_add_u32 v16, v2, 2, s48
    s_lshl_b32 s48, s43, 3
    s_lshl_b32 s49, s42, 1
    s_add_u32 s55, s48, s49
    s_mul_i32 s48, s55, 20480
    s_add_u32 s48, s48, 0
    v_add_u32 v17, s48, v1
    s_lshl_b32 s48, s43, 1
    s_lshr_b32 s49, s42, 1
    s_add_u32 s48, s48, s49
    s_lshl_b32 s48, s48, 12
    s_and_b32 s49, s42, 1
    s_lshl_b32 s49, s49, 8
    s_add_u32 s48, s48, s49
    s_add_u32 s48, s48, 17956864
    v_lshlrev_b32 v18, 10, v3
    v_lshl_add_u32 v18, v2, 3, v18
    v_add_u32 v18, s48, v18
    v_mov_b32 v19, v1
    v_add_u32 v20, 40960, v1
    v_add_u32 v21, 81920, v1
    s_mul_i32 s48, s55, 55296
    s_lshl_b32 s49, s45, 9
    s_add_u32 s48, s48, s49
    s_add_u32 s48, s48, 10485760
    v_and_b32 v6, 1, v3
    v_lshrrev_b32 v7, 1, v3
    v_lshl_add_u32 v22, v6, 1, v7
    v_lshlrev_b32 v22, 8, v22
    s_add_u32 m0, s79, 81920
    s_add_u32 s76, s78, 4096
    buffer_load_dwordx4 v1, s[20:23], s76 offen lds
    v_lshl_add_u32 v22, v2, 4, v22
    v_add_u32 v22, s48, v22
    v_lshlrev_b32 v23, 8, v7
    v_lshl_add_u32 v23, v6, 3, v23
    v_lshl_add_u32 v23, v2, 4, v23
    v_add_u32 v23, s48, v23
    s_mov_b32 s65, 55296
    s_lshl_b32 s49, s45, 6
    s_add_u32 s49, s49, 18287104
    buffer_load_dwordx4 v[152:155], v29, s[12:15], s49 offen offset:0
    buffer_load_dwordx4 v[156:159], v29, s[12:15], s49 offen offset:64
    buffer_load_dwordx4 v[160:163], v29, s[12:15], s49 offen offset:128
    buffer_load_dwordx4 v[164:167], v29, s[12:15], s49 offen offset:192
    buffer_load_dwordx4 v[168:171], v29, s[12:15], s49 offen offset:256
    buffer_load_dwordx4 v[172:175], v29, s[12:15], s49 offen offset:320
    buffer_load_dwordx4 v[176:179], v29, s[12:15], s49 offen offset:384
    s_lshl_b32 s48, s43, 1
    s_lshr_b32 s49, s42, 1
    s_add_u32 s48, s48, s49
    s_lshl_b32 s48, s48, 5
    s_add_u32 s48, s48, 18221056
    v_and_b32 v16, 7, v2
    v_lshl_add_u32 v16, v16, 2, s48
    s_barrier
    s_mov_b32 s54, 0
    s_nop 2
KP_POLL2:
    buffer_load_dword v7, v16, s[12:15], 0 offen sc1
    s_waitcnt vmcnt(0)
    v_cmp_eq_u32 vcc, 0, v7
    s_nop 1
    s_cmp_eq_u64 vcc, 0
    s_cbranch_scc1 KP_GO2
    s_sleep 1
    s_add_u32 s54, s54, 1
    s_cmp_lt_u32 s54, 0x80000
    s_cbranch_scc1 KP_POLL2
    s_nop 1
KP_GO2:
    s_mov_b32 s48, 0
    buffer_load_dwordx4 v[32:35], v17, s[12:15], s48 offen offset:0 sc1
    s_mov_b32 s48, 20480
    buffer_load_dwordx4 v[36:39], v17, s[12:15], s48 offen offset:0 sc1
    s_mov_b32 s48, 0
    buffer_load_dwordx4 v[40:43], v17, s[12:15], s48 offen offset:1024 sc1
    s_mov_b32 s48, 20480
    buffer_load_dwordx4 v[44:47], v17, s[12:15], s48 offen offset:1024 sc1
    s_mov_b32 s48, 0
    buffer_load_dwordx4 v[48:51], v17, s[12:15], s48 offen offset:2048 sc1
    s_mov_b32 s48, 20480
    buffer_load_dwordx4 v[52:55], v17, s[12:15], s48 offen offset:2048 sc1
    s_mov_b32 s48, 0
    buffer_load_dwordx4 v[56:59], v17, s[12:15], s48 offen offset:3072 sc1
    s_mov_b32 s48, 20480
    buffer_load_dwordx4 v[60:63], v17, s[12:15], s48 offen offset:3072 sc1
    s_mov_b32 s48, 4096
    buffer_load_dwordx4 v[64:67], v17, s[12:15], s48 offen offset:0 sc1
    s_mov_b32 s48, 24576
    buffer_load_dwordx4 v[68:71], v17, s[12:15], s48 offen offset:0 sc1
    s_mov_b32 s48, 4096
    buffer_load_dwordx4 v[72:75], v17, s[12:15], s48 offen offset:1024 sc1
    s_mov_b32 s48, 24576
    buffer_load_dwordx4 v[76:79], v17, s[12:15], s48 offen offset:1024 sc1
    s_mov_b32 s48, 4096
    buffer_load_dwordx4 v[80:83], v17, s[12:15], s48 offen offset:2048 sc1
    s_mov_b32 s48, 24576
    buffer_load_dwordx4 v[84:87], v17, s[12:15], s48 offen offset:2048 sc1
    s_mov_b32 s48, 4096
    buffer_load_dwordx4 v[88:91], v17, s[12:15], s48 offen offset:3072 sc1
    s_mov_b32 s48, 24576
    buffer_load_dwordx4 v[92:95], v17, s[12:15], s48 offen offset:3072 sc1
    s_mov_b32 s48, 8192
    buffer_load_dwordx4 v[96:99], v17, s[12:15], s48 offen offset:0 sc1
    s_mov_b32 s48, 28672
    buffer_load_dwordx4 v[100:103], v17, s[12:15], s48 offen offset:0 sc1
    s_mov_b32 s48, 8192
    buffer_load_dwordx4 v[104:107], v17, s[12:15], s48 offen offset:1024 sc1
    s_mov_b32 s48, 28672
    buffer_load_dwordx4 v[108:111], v17, s[12:15], s48 offen offset:1024 sc1
    ds_read_b128 a[40:43], v19 offset:0
    ds_read_b128 a[44:47], v19 offset:1024
    ds_read_b128 a[48:51], v19 offset:2048
    ds_read_b128 a[52:55], v19 offset:3072
    s_waitcnt vmcnt(18)
    s_waitcnt lgkmcnt(0)
    v_mfma_f32_16x16x32_bf16 v[192:195], a[40:43], v[32:35], 0
    ds_read_b128 a[68:71], v19 offset:4096
    v_mfma_f32_16x16x32_bf16 v[220:223], a[40:43], v[36:39], 0
    ds_read_b128 a[72:75], v19 offset:5120
    s_mov_b32 s48, 8192
    buffer_load_dwordx4 v[112:115], v17, s[12:15], s48 offen offset:2048 sc1
    v_mfma_f32_16x16x32_bf16 v[196:199], a[44:47], v[32:35], 0
    ds_read_b128 a[76:79], v19 offset:6144
    v_mfma_f32_16x16x32_bf16 v[224:227], a[44:47], v[36:39], 0
    ds_read_b128 a[80:83], v19 offset:7168
    s_mov_b32 s48, 28672
    buffer_load_dwordx4 v[116:119], v17, s[12:15], s48 offen offset:2048 sc1
    v_mfma_f32_16x16x32_bf16 v[200:203], a[48:51], v[32:35], 0
    v_mfma_f32_16x16x32_bf16 v[228:231], a[48:51], v[36:39], 0
    s_mov_b32 s48, 8192
    buffer_load_dwordx4 v[120:123], v17, s[12:15], s48 offen offset:3072 sc1
    v_mfma_f32_16x16x32_bf16 v[204:207], a[52:55], v[32:35], 0
    v_mfma_f32_16x16x32_bf16 v[232:235], a[52:55], v[36:39], 0
    s_mov_b32 s48, 28672
    buffer_load_dwordx4 v[124:127], v17, s[12:15], s48 offen offset:3072 sc1
    s_waitcnt vmcnt(20)
    s_waitcnt lgkmcnt(0)
    v_mfma_f32_16x16x32_bf16 v[192:195], a[68:71], v[40:43], v[192:195]
    ds_read_b128 a[40:43], v19 offset:8192
    v_mfma_f32_16x16x32_bf16 v[220:223], a[68:71], v[44:47], v[220:223]
    ds_read_b128 a[44:47], v19 offset:9216
    s_mov_b32 s48, 12288
    buffer_load_dwordx4 v[128:131], v17, s[12:15], s48 offen offset:0 sc1
    v_mfma_f32_16x16x32_bf16 v[196:199], a[72:75], v[40:43], v[196:199]
    ds_read_b128 a[48:51], v19 offset:10240
    v_mfma_f32_16x16x32_bf16 v[224:227], a[72:75], v[44:47], v[224:227]
    ds_read_b128 a[52:55], v19 offset:11264
    s_mov_b32 s48, 32768
    buffer_load_dwordx4 v[132:135], v17, s[12:15], s48 offen offset:0 sc1
    v_mfma_f32_16x16x32_bf16 v[200:203], a[76:79], v[40:43], v[200:203]
    v_mfma_f32_16x16x32_bf16 v[228:231], a[76:79], v[44:47], v[228:231]
    s_mov_b32 s48, 12288
    buffer_load_dwordx4 v[136:139], v17, s[12:15], s48 offen offset:1024 sc1
    v_mfma_f32_16x16x32_bf16 v[204:207], a[80:83], v[40:43], v[204:207]
    v_mfma_f32_16x16x32_bf16 v[232:235], a[80:83], v[44:47], v[232:235]
    s_mov_b32 s48, 32768
    buffer_load_dwordx4 v[140:143], v17, s[12:15], s48 offen offset:1024 sc1
    s_waitcnt vmcnt(22)
    s_waitcnt lgkmcnt(0)
    v_mfma_f32_16x16x32_bf16 v[192:195], a[40:43], v[48:51], v[192:195]
    ds_read_b128 a[68:71], v19 offset:12288
    v_mfma_f32_16x16x32_bf16 v[220:223], a[40:43], v[52:55], v[220:223]
    ds_read_b128 a[72:75], v19 offset:13312
    s_mov_b32 s48, 12288
    buffer_load_dwordx4 v[144:147], v17, s[12:15], s48 offen offset:2048 sc1
    v_mfma_f32_16x16x32_bf16 v[196:199], a[44:47], v[48:51], v[196:199]
    ds_read_b128 a[76:79], v19 offset:14336
    v_mfma_f32_16x16x32_bf16 v[224:227], a[44:47], v[52:55], v[224:227]
    ds_read_b128 a[80:83], v19 offset:15360
    s_mov_b32 s48, 32768
    buffer_load_dwordx4 v[148:151], v17, s[12:15], s48 offen offset:2048 sc1
    v_mfma_f32_16x16x32_bf16 v[200:203], a[48:51], v[48:51], v[200:203]
    v_mfma_f32_16x16x32_bf16 v[228:231], a[48:51], v[52:55], v[228:231]
    s_mov_b32 s48, 12288
    buffer_load_dwordx4 a[0:3], v17, s[12:15], s48 offen offset:3072 sc1
    v_mfma_f32_16x16x32_bf16 v[204:207], a[52:55], v[48:51], v[204:207]
    v_mfma_f32_16x16x32_bf16 v[232:235], a[52:55], v[52:55], v[232:235]
    s_mov_b32 s48, 32768
    buffer_load_dwordx4 a[4:7], v17, s[12:15], s48 offen offset:3072 sc1
    s_waitcnt vmcnt(24)
    s_waitcnt lgkmcnt(0)
    v_mfma_f32_16x16x32_bf16 v[192:195], a[68:71], v[56:59], v[192:195]
    ds_read_b128 a[40:43], v19 offset:16384
    v_mfma_f32_16x16x32_bf16 v[220:223], a[68:71], v[60:63], v[220:223]
    ds_read_b128 a[44:47], v19 offset:17408
    s_mov_b32 s48, 16384
    buffer_load_dwordx4 a[8:11], v17, s[12:15], s48 offen offset:0 sc1
    v_mfma_f32_16x16x32_bf16 v[196:199], a[72:75], v[56:59], v[196:199]
    ds_read_b128 a[48:51], v19 offset:18432
    v_mfma_f32_16x16x32_bf16 v[224:227], a[72:75], v[60:63], v[224:227]
    ds_read_b128 a[52:55], v19 offset:19456
    s_mov_b32 s48, 36864
    buffer_load_dwordx4 a[12:15], v17, s[12:15], s48 offen offset:0 sc1
    v_mfma_f32_16x16x32_bf16 v[200:203], a[76:79], v[56:59], v[200:203]
    v_mfma_f32_16x16x32_bf16 v[228:231], a[76:79], v[60:63], v[228:231]
    s_mov_b32 s48, 16384
    buffer_load_dwordx4 a[16:19], v17, s[12:15], s48 offen offset:1024 sc1
    v_mfma_f32_16x16x32_bf16 v[204:207], a[80:83], v[56:59], v[204:207]
    v_mfma_f32_16x16x32_bf16 v[232:235], a[80:83], v[60:63], v[232:235]
    s_mov_b32 s48, 36864
    buffer_load_dwordx4 a[20:23], v17, s[12:15], s48 offen offset:1024 sc1
    s_waitcnt vmcnt(26)
    s_waitcnt lgkmcnt(0)
    v_mfma_f32_16x16x32_bf16 v[192:195], a[40:43], v[64:67], v[192:195]
    ds_read_b128 a[68:71], v19 offset:20480
    v_mfma_f32_16x16x32_bf16 v[220:223], a[40:43], v[68:71], v[220:223]
    ds_read_b128 a[72:75], v19 offset:21504
    s_mov_b32 s48, 16384
    buffer_load_dwordx4 a[24:27], v17, s[12:15], s48 offen offset:2048 sc1
    v_mfma_f32_16x16x32_bf16 v[196:199], a[44:47], v[64:67], v[196:199]
    ds_read_b128 a[76:79], v19 offset:22528
    v_mfma_f32_16x16x32_bf16 v[224:227], a[44:47], v[68:71], v[224:227]
    ds_read_b128 a[80:83], v19 offset:23552
    s_mov_b32 s48, 36864
    buffer_load_dwordx4 a[28:31], v17, s[12:15], s48 offen offset:2048 sc1
    v_mfma_f32_16x16x32_bf16 v[200:203], a[48:51], v[64:67], v[200:203]
    v_mfma_f32_16x16x32_bf16 v[228:231], a[48:51], v[68:71], v[228:231]
    s_mov_b32 s48, 16384
    buffer_load_dwordx4 a[32:35], v17, s[12:15], s48 offen offset:3072 sc1
    v_mfma_f32_16x16x32_bf16 v[204:207], a[52:55], v[64:67], v[204:207]
    v_mfma_f32_16x16x32_bf16 v[232:235], a[52:55], v[68:71], v[232:235]
    s_mov_b32 s48, 36864
    buffer_load_dwordx4 a[36:39], v17, s[12:15], s48 offen offset:3072 sc1
    s_waitcnt vmcnt(28)
    s_waitcnt lgkmcnt(0)
    v_mfma_f32_16x16x32_bf16 v[192:195], a[68:71], v[72:75], v[192:195]
    ds_read_b128 a[40:43], v19 offset:24576
    v_mfma_f32_16x16x32_bf16 v[220:223], a[68:71], v[76:79], v[220:223]
    ds_read_b128 a[44:47], v19 offset:25600
    buffer_load_dwordx2 v[248:249], v18, s[12:15], 0 offen offset:0 sc1
    v_mfma_f32_16x16x32_bf16 v[196:199], a[72:75], v[72:75], v[196:199]
    ds_read_b128 a[48:51], v19 offset:26624
    v_mfma_f32_16x16x32_bf16 v[224:227], a[72:75], v[76:79], v[224:227]
    ds_read_b128 a[52:55], v19 offset:27648
    buffer_load_dwordx2 v[250:251], v18, s[12:15], 0 offen offset:512 sc1
    v_mfma_f32_16x16x32_bf16 v[200:203], a[76:79], v[72:75], v[200:203]
    v_mfma_f32_16x16x32_bf16 v[228:231], a[76:79], v[76:79], v[228:231]
    buffer_load_dwordx2 v[252:253], v18, s[12:15], 0 offen offset:128 sc1
    v_mfma_f32_16x16x32_bf16 v[204:207], a[80:83], v[72:75], v[204:207]
    v_mfma_f32_16x16x32_bf16 v[232:235], a[80:83], v[76:79], v[232:235]
    buffer_load_dwordx2 v[254:255], v18, s[12:15], 0 offen offset:640 sc1
    s_waitcnt vmcnt(30)
    s_waitcnt lgkmcnt(0)
    v_mfma_f32_16x16x32_bf16 v[192:195], a[40:43], v[80:83], v[192:195]
    s_add_u32 m0, s79, 82944
    s_add_u32 s76, s78, 5120
    buffer_load_dwordx4 v1, s[20:23], s76 offen lds
    ds_read_b128 a[68:71], v19 offset:28672
    v_mfma_f32_16x16x32_bf16 v[220:223], a[40:43], v[84:87], v[220:223]
    ds_read_b128 a[72:75], v19 offset:29696
    v_mfma_f32_16x16x32_bf16 v[196:199], a[44:47], v[80:83], v[196:199]
    ds_read_b128 a[76:79], v19 offset:30720
    v_mfma_f32_16x16x32_bf16 v[224:227], a[44:47], v[84:87], v[224:227]
    ds_read_b128 a[80:83], v19 offset:31744
    v_mfma_f32_16x16x32_bf16 v[200:203], a[48:51], v[80:83], v[200:203]
    v_mfma_f32_16x16x32_bf16 v[228:231], a[48:51], v[84:87], v[228:231]
    s_add_u32 m0, s79, 83968
    s_add_u32 s76, s78, 6144
    buffer_load_dwordx4 v1, s[20:23], s76 offen lds
    v_mfma_f32_16x16x32_bf16 v[204:207], a[52:55], v[80:83], v[204:207]
    v_mfma_f32_16x16x32_bf16 v[232:235], a[52:55], v[84:87], v[232:235]
    s_waitcnt vmcnt(30)
    s_waitcnt lgkmcnt(0)
    v_mfma_f32_16x16x32_bf16 v[192:195], a[68:71], v[88:91], v[192:195]
    ds_read_b128 a[40:43], v19 offset:32768
    v_mfma_f32_16x16x32_bf16 v[220:223], a[68:71], v[92:95], v[220:223]
    ds_read_b128 a[44:47], v19 offset:33792
    v_mfma_f32_16x16x32_bf16 v[196:199], a[72:75], v[88:91], v[196:199]
    s_add_u32 m0, s79, 94208
    s_add_u32 s76, s78, 446464
    buffer_load_dwordx4 v1, s[20:23], s76 offen lds
    ds_read_b128 a[48:51], v19 offset:34816
    v_mfma_f32_16x16x32_bf16 v[224:227], a[72:75], v[92:95], v[224:227]
    ds_read_b128 a[52:55], v19 offset:35840
    v_mfma_f32_16x16x32_bf16 v[200:203], a[76:79], v[88:91], v[200:203]
    v_mfma_f32_16x16x32_bf16 v[228:231], a[76:79], v[92:95], v[228:231]
    v_mfma_f32_16x16x32_bf16 v[204:207], a[80:83], v[88:91], v[204:207]
    v_mfma_f32_16x16x32_bf16 v[232:235], a[80:83], v[92:95], v[232:235]
    s_add_u32 m0, s79, 95232
    s_add_u32 s76, s78, 447488
    buffer_load_dwordx4 v1, s[20:23], s76 offen lds
    s_waitcnt vmcnt(30)
    s_waitcnt lgkmcnt(0)
    v_mfma_f32_16x16x32_bf16 v[192:195], a[40:43], v[96:99], v[192:195]
    ds_read_b128 a[68:71], v19 offset:36864
    v_mfma_f32_16x16x32_bf16 v[220:223], a[40:43], v[100:103], v[220:223]
    ds_read_b128 a[72:75], v19 offset:37888
    v_mfma_f32_16x16x32_bf16 v[196:199], a[44:47], v[96:99], v[196:199]
    ds_read_b128 a[76:79], v19 offset:38912
    v_mfma_f32_16x16x32_bf16 v[224:227], a[44:47], v[100:103], v[224:227]
    ds_read_b128 a[80:83], v19 offset:39936
    v_mfma_f32_16x16x32_bf16 v[200:203], a[48:51], v[96:99], v[200:203]
    s_add_u32 m0, s79, 96256
    s_add_u32 s76, s78, 448512
    buffer_load_dwordx4 v1, s[20:23], s76 offen lds
    v_mfma_f32_16x16x32_bf16 v[228:231], a[48:51], v[100:103], v[228:231]
    v_mfma_f32_16x16x32_bf16 v[204:207], a[52:55], v[96:99], v[204:207]
    v_mfma_f32_16x16x32_bf16 v[232:235], a[52:55], v[100:103], v[232:235]
    s_waitcnt vmcnt(29)
    s_waitcnt lgkmcnt(0)
    v_mfma_f32_16x16x32_bf16 v[192:195], a[68:71], v[104:107], v[192:195]
    ds_read_b128 a[40:43], v20 offset:0
    v_mfma_f32_16x16x32_bf16 v[220:223], a[68:71], v[108:111], v[220:223]
    s_add_u32 m0, s79, 106496
    s_add_u32 s76, s78, 888832
    buffer_load_dwordx4 v1, s[20:23], s76 offen lds
    ds_read_b128 a[44:47], v20 offset:1024
    v_mfma_f32_16x16x32_bf16 v[196:199], a[72:75], v[104:107], v[196:199]
    ds_read_b128 a[48:51], v20 offset:2048
    v_mfma_f32_16x16x32_bf16 v[224:227], a[72:75], v[108:111], v[224:227]
    ds_read_b128 a[52:55], v20 offset:3072
    v_mfma_f32_16x16x32_bf16 v[200:203], a[76:79], v[104:107], v[200:203]
    v_mfma_f32_16x16x32_bf16 v[228:231], a[76:79], v[108:111], v[228:231]
    v_mfma_f32_16x16x32_bf16 v[204:207], a[80:83], v[104:107], v[204:207]
    s_add_u32 m0, s79, 107520
    s_add_u32 s76, s78, 889856
    buffer_load_dwordx4 v1, s[20:23], s76 offen lds
    v_mfma_f32_16x16x32_bf16 v[232:235], a[80:83], v[108:111], v[232:235]
    s_waitcnt vmcnt(29)
    s_waitcnt lgkmcnt(0)
    v_mfma_f32_16x16x32_bf16 v[192:195], a[40:43], v[112:115], v[192:195]
    ds_read_b128 a[68:71], v20 offset:4096
    v_mfma_f32_16x16x32_bf16 v[220:223], a[40:43], v[116:119], v[220:223]
    ds_read_b128 a[72:75], v20 offset:5120
    v_mfma_f32_16x16x32_bf16 v[196:199], a[44:47], v[112:115], v[196:199]
    ds_read_b128 a[76:79], v20 offset:6144
    v_mfma_f32_16x16x32_bf16 v[224:227], a[44:47], v[116:119], v[224:227]
    s_add_u32 m0, s79, 108544
    s_add_u32 s76, s78, 890880
    buffer_load_dwordx4 v1, s[20:23], s76 offen lds
    ds_read_b128 a[80:83], v20 offset:7168
    v_mfma_f32_16x16x32_bf16 v[200:203], a[48:51], v[112:115], v[200:203]
    v_mfma_f32_16x16x32_bf16 v[228:231], a[48:51], v[116:119], v[228:231]
    v_mfma_f32_16x16x32_bf16 v[204:207], a[52:55], v[112:115], v[204:207]
    v_mfma_f32_16x16x32_bf16 v[232:235], a[52:55], v[116:119], v[232:235]
    s_waitcnt vmcnt(28)
    s_waitcnt lgkmcnt(0)
    v_mfma_f32_16x16x32_bf16 v[192:195], a[68:71], v[120:123], v[192:195]
    s_add_u32 m0, s79, 118784
    s_add_u32 s76, s78, 1331200
    buffer_load_dwordx4 v1, s[20:23], s76 offen lds
    ds_read_b128 a[40:43], v20 offset:8192
    v_mfma_f32_16x16x32_bf16 v[220:223], a[68:71], v[124:127], v[220:223]
    ds_read_b128 a[44:47], v20 offset:9216
    v_mfma_f32_16x16x32_bf16 v[196:199], a[72:75], v[120:123], v[196:199]
    ds_read_b128 a[48:51], v20 offset:10240
    v_mfma_f32_16x16x32_bf16 v[224:227], a[72:75], v[124:127], v[224:227]
    ds_read_b128 a[52:55], v20 offset:11264
    v_mfma_f32_16x16x32_bf16 v[200:203], a[76:79], v[120:123], v[200:203]
    v_mfma_f32_16x16x32_bf16 v[228:231], a[76:79], v[124:127], v[228:231]
    s_add_u32 m0, s79, 119808
    s_add_u32 s76, s78, 1332224
    buffer_load_dwordx4 v1, s[20:23], s76 offen lds
    v_mfma_f32_16x16x32_bf16 v[204:207], a[80:83], v[120:123], v[204:207]
    v_mfma_f32_16x16x32_bf16 v[232:235], a[80:83], v[124:127], v[232:235]
    s_waitcnt vmcnt(28)
    s_waitcnt lgkmcnt(0)
    v_mfma_f32_16x16x32_bf16 v[192:195], a[40:43], v[128:131], v[192:195]
    ds_read_b128 a[68:71], v20 offset:12288
    v_mfma_f32_16x16x32_bf16 v[220:223], a[40:43], v[132:135], v[220:223]
    ds_read_b128 a[72:75], v20 offset:13312
    v_mfma_f32_16x16x32_bf16 v[196:199], a[44:47], v[128:131], v[196:199]
    s_add_u32 m0, s79, 120832
    s_add_u32 s76, s78, 1333248
    buffer_load_dwordx4 v1, s[20:23], s76 offen lds
    ds_read_b128 a[76:79], v20 offset:14336
    v_mfma_f32_16x16x32_bf16 v[224:227], a[44:47], v[132:135], v[224:227]
    ds_read_b128 a[80:83], v20 offset:15360
    v_mfma_f32_16x16x32_bf16 v[200:203], a[48:51], v[128:131], v[200:203]
    v_mfma_f32_16x16x32_bf16 v[228:231], a[48:51], v[132:135], v[228:231]
    v_mfma_f32_16x16x32_bf16 v[204:207], a[52:55], v[128:131], v[204:207]
    v_mfma_f32_16x16x32_bf16 v[232:235], a[52:55], v[132:135], v[232:235]
    s_add_u32 m0, s79, 131072
    s_add_u32 s76, s78, 1773568
    buffer_load_dwordx4 v1, s[20:23], s76 offen lds
    s_waitcnt vmcnt(28)
    s_waitcnt lgkmcnt(0)
    v_mfma_f32_16x16x32_bf16 v[192:195], a[68:71], v[136:139], v[192:195]
    ds_read_b128 a[40:43], v20 offset:16384
    v_mfma_f32_16x16x32_bf16 v[220:223], a[68:71], v[140:143], v[220:223]
    ds_read_b128 a[44:47], v20 offset:17408
    v_mfma_f32_16x16x32_bf16 v[196:199], a[72:75], v[136:139], v[196:199]
    ds_read_b128 a[48:51], v20 offset:18432
    v_mfma_f32_16x16x32_bf16 v[224:227], a[72:75], v[140:143], v[224:227]
    ds_read_b128 a[52:55], v20 offset:19456
    v_mfma_f32_16x16x32_bf16 v[200:203], a[76:79], v[136:139], v[200:203]
    s_add_u32 m0, s79, 132096
    s_add_u32 s76, s78, 1774592
    buffer_load_dwordx4 v1, s[20:23], s76 offen lds
    v_mfma_f32_16x16x32_bf16 v[228:231], a[76:79], v[140:143], v[228:231]
    v_mfma_f32_16x16x32_bf16 v[204:207], a[80:83], v[136:139], v[204:207]
    v_mfma_f32_16x16x32_bf16 v[232:235], a[80:83], v[140:143], v[232:235]
    s_waitcnt vmcnt(27)
    s_waitcnt lgkmcnt(0)
    v_mfma_f32_16x16x32_bf16 v[192:195], a[40:43], v[144:147], v[192:195]
    ds_read_b128 a[68:71], v20 offset:20480
    v_mfma_f32_16x16x32_bf16 v[220:223], a[40:43], v[148:151], v[220:223]
    s_add_u32 m0, s79, 133120
    s_add_u32 s76, s78, 1775616
    buffer_load_dwordx4 v1, s[20:23], s76 offen lds
    ds_read_b128 a[72:75], v20 offset:21504
    v_mfma_f32_16x16x32_bf16 v[196:199], a[44:47], v[144:147], v[196:199]
    ds_read_b128 a[76:79], v20 offset:22528
    v_mfma_f32_16x16x32_bf16 v[224:227], a[44:47], v[148:151], v[224:227]
    ds_read_b128 a[80:83], v20 offset:23552
    v_mfma_f32_16x16x32_bf16 v[200:203], a[48:51], v[144:147], v[200:203]
    v_mfma_f32_16x16x32_bf16 v[228:231], a[48:51], v[148:151], v[228:231]
    v_mfma_f32_16x16x32_bf16 v[204:207], a[52:55], v[144:147], v[204:207]
    s_mov_b32 s76, 81920
    buffer_load_dwordx4 a[144:147], v31, s[20:23], s76 offen offset:1024
    v_mfma_f32_16x16x32_bf16 v[232:235], a[52:55], v[148:151], v[232:235]
    s_waitcnt vmcnt(27)
    s_waitcnt lgkmcnt(0)
    v_mfma_f32_16x16x32_bf16 v[192:195], a[68:71], a[0:3], v[192:195]
    ds_read_b128 a[40:43], v20 offset:24576
    v_mfma_f32_16x16x32_bf16 v[220:223], a[68:71], a[4:7], v[220:223]
    ds_read_b128 a[44:47], v20 offset:25600
    v_mfma_f32_16x16x32_bf16 v[196:199], a[72:75], a[0:3], v[196:199]
    ds_read_b128 a[48:51], v20 offset:26624
    v_mfma_f32_16x16x32_bf16 v[224:227], a[72:75], a[4:7], v[224:227]
    s_mov_b32 s76, 81920
    buffer_load_dwordx4 a[148:151], v31, s[20:23], s76 offen offset:2048
    ds_read_b128 a[52:55], v20 offset:27648
    v_mfma_f32_16x16x32_bf16 v[200:203], a[76:79], a[0:3], v[200:203]
    v_mfma_f32_16x16x32_bf16 v[228:231], a[76:79], a[4:7], v[228:231]
    v_mfma_f32_16x16x32_bf16 v[204:207], a[80:83], a[0:3], v[204:207]
    v_mfma_f32_16x16x32_bf16 v[232:235], a[80:83], a[4:7], v[232:235]
    s_waitcnt vmcnt(26)
    s_waitcnt lgkmcnt(0)
    v_mfma_f32_16x16x32_bf16 v[192:195], a[40:43], a[8:11], v[192:195]
    s_mov_b32 s76, 81920
    buffer_load_dwordx4 a[152:155], v31, s[20:23], s76 offen offset:3072
    ds_read_b128 a[68:71], v20 offset:28672
    v_mfma_f32_16x16x32_bf16 v[220:223], a[40:43], a[12:15], v[220:223]
    ds_read_b128 a[72:75], v20 offset:29696
    v_mfma_f32_16x16x32_bf16 v[196:199], a[44:47], a[8:11], v[196:199]
    ds_read_b128 a[76:79], v20 offset:30720
    v_mfma_f32_16x16x32_bf16 v[224:227], a[44:47], a[12:15], v[224:227]
    ds_read_b128 a[80:83], v20 offset:31744
    v_mfma_f32_16x16x32_bf16 v[200:203], a[48:51], a[8:11], v[200:203]
    v_mfma_f32_16x16x32_bf16 v[228:231], a[48:51], a[12:15], v[228:231]
    s_mov_b32 s76, 86016
    buffer_load_dwordx4 a[156:159], v31, s[20:23], s76 offen offset:0
    v_mfma_f32_16x16x32_bf16 v[204:207], a[52:55], a[8:11], v[204:207]
    v_mfma_f32_16x16x32_bf16 v[232:235], a[52:55], a[12:15], v[232:235]
    s_waitcnt vmcnt(26)
    s_waitcnt lgkmcnt(0)
    v_mfma_f32_16x16x32_bf16 v[192:195], a[68:71], a[16:19], v[192:195]
    ds_read_b128 a[40:43], v20 offset:32768
    v_mfma_f32_16x16x32_bf16 v[220:223], a[68:71], a[20:23], v[220:223]
    ds_read_b128 a[44:47], v20 offset:33792
    v_mfma_f32_16x16x32_bf16 v[196:199], a[72:75], a[16:19], v[196:199]
    s_mov_b32 s76, 122880
    buffer_load_dwordx4 a[160:163], v31, s[20:23], s76 offen offset:0
    ds_read_b128 a[48:51], v20 offset:34816
    v_mfma_f32_16x16x32_bf16 v[224:227], a[72:75], a[20:23], v[224:227]
    ds_read_b128 a[52:55], v20 offset:35840
    v_mfma_f32_16x16x32_bf16 v[200:203], a[76:79], a[16:19], v[200:203]
    v_mfma_f32_16x16x32_bf16 v[228:231], a[76:79], a[20:23], v[228:231]
    v_mfma_f32_16x16x32_bf16 v[204:207], a[80:83], a[16:19], v[204:207]
    v_mfma_f32_16x16x32_bf16 v[232:235], a[80:83], a[20:23], v[232:235]
    s_mov_b32 s76, 122880
    buffer_load_dwordx4 a[164:167], v31, s[20:23], s76 offen offset:1024
    s_waitcnt vmcnt(26)
    s_waitcnt lgkmcnt(0)
    v_mfma_f32_16x16x32_bf16 v[192:195], a[40:43], a[24:27], v[192:195]
    ds_read_b128 a[68:71], v20 offset:36864
    v_mfma_f32_16x16x32_bf16 v[220:223], a[40:43], a[28:31], v[220:223]
    ds_read_b128 a[72:75], v20 offset:37888
    v_mfma_f32_16x16x32_bf16 v[196:199], a[44:47], a[24:27], v[196:199]
    ds_read_b128 a[76:79], v20 offset:38912
    v_mfma_f32_16x16x32_bf16 v[224:227], a[44:47], a[28:31], v[224:227]
    ds_read_b128 a[80:83], v20 offset:39936
    v_mfma_f32_16x16x32_bf16 v[200:203], a[48:51], a[24:27], v[200:203]
    s_mov_b32 s76, 122880
    buffer_load_dwordx4 a[168:171], v31, s[20:23], s76 offen offset:2048
    v_mfma_f32_16x16x32_bf16 v[228:231], a[48:51], a[28:31], v[228:231]
    v_mfma_f32_16x16x32_bf16 v[204:207], a[52:55], a[24:27], v[204:207]
    v_mfma_f32_16x16x32_bf16 v[232:235], a[52:55], a[28:31], v[232:235]
    s_waitcnt vmcnt(25)
    s_waitcnt vmcnt(7)
    s_barrier
    s_waitcnt lgkmcnt(0)
    v_mfma_f32_16x16x32_bf16 v[192:195], a[68:71], a[32:35], v[192:195]
    ds_read_b128 a[56:59], v21 offset:0
    v_mfma_f32_16x16x32_bf16 v[220:223], a[68:71], a[36:39], v[220:223]
    s_mov_b32 s76, 122880
    buffer_load_dwordx4 a[172:175], v31, s[20:23], s76 offen offset:3072
    ds_read_b128 a[60:63], v21 offset:1024
    v_mfma_f32_16x16x32_bf16 v[196:199], a[72:75], a[32:35], v[196:199]
    ds_read_b128 a[64:67], v21 offset:2048
    v_mfma_f32_16x16x32_bf16 v[224:227], a[72:75], a[36:39], v[224:227]
    v_mfma_f32_16x16x32_bf16 v[200:203], a[76:79], a[32:35], v[200:203]
    v_mfma_f32_16x16x32_bf16 v[228:231], a[76:79], a[36:39], v[228:231]
    v_mfma_f32_16x16x32_bf16 v[204:207], a[80:83], a[32:35], v[204:207]
    s_mov_b32 s76, 126976
    buffer_load_dwordx4 a[176:179], v31, s[20:23], s76 offen offset:0
    v_mfma_f32_16x16x32_bf16 v[232:235], a[80:83], a[36:39], v[232:235]
    v_add_f32 v248, v248, v250
    v_add_f32 v249, v249, v251
    v_mov_b32 v250, v248
    v_mov_b32 v251, v249
    s_nop 0
    v_permlane32_swap_b32 v248, v250
    v_permlane32_swap_b32 v249, v251
    v_add_f32 v248, v248, v250
    v_add_f32 v249, v249, v251
    v_mov_b32 v250, v248
    v_mov_b32 v251, v249
    s_nop 0
    v_permlane16_swap_b32 v248, v250
    v_permlane16_swap_b32 v249, v251
    v_add_f32 v248, v248, v250
    v_add_f32 v249, v249, v251
    v_mul_f32 v188, s62, v248
    v_mul_f32 v189, s62, v249
    s_mov_b32 s76, 163840
    buffer_load_dwordx4 a[180:183], v31, s[20:23], s76 offen offset:0
    v_fma_f32 v189, -v188, v188, v189
    v_max_f32 v189, 0, v189
    v_add_f32 v189, s63, v189
    v_rsq_f32 v189, v189
    s_nop 0
    v_mul_f32 v188, v188, v189
    v_sub_f32 v188, 0, v188
    v_add_f32 v252, v252, v254
    v_add_f32 v253, v253, v255
    v_mov_b32 v254, v252
    v_mov_b32 v255, v253
    s_nop 0
    v_permlane32_swap_b32 v252, v254
    v_permlane32_swap_b32 v253, v255
    v_add_f32 v252, v252, v254
    v_add_f32 v253, v253, v255
    v_mov_b32 v254, v252
    v_mov_b32 v255, v253
    s_nop 0
    v_permlane16_swap_b32 v252, v254
    v_permlane16_swap_b32 v253, v255
    v_add_f32 v252, v252, v254
    s_mov_b32 s76, 163840
    buffer_load_dwordx4 a[184:187], v31, s[20:23], s76 offen offset:1024
    v_add_f32 v253, v253, v255
    v_mul_f32 v190, s62, v252
    v_mul_f32 v191, s62, v253
    v_fma_f32 v191, -v190, v190, v191
    v_max_f32 v191, 0, v191
    v_add_f32 v191, s63, v191
    v_rsq_f32 v191, v191
    s_nop 0
    v_mul_f32 v190, v190, v191
    v_sub_f32 v190, 0, v190
    s_waitcnt lgkmcnt(0)
    v_mfma_f32_16x16x32_bf16 v[208:211], a[56:59], v[32:35], 0
    ds_read_b128 a[84:87], v21 offset:3072
    v_mul_f32 v180, v152, v188
    v_mfma_f32_16x16x32_bf16 v[236:239], a[56:59], v[36:39], 0
    s_mov_b32 s76, 163840
    buffer_load_dwordx4 a[188:191], v31, s[20:23], s76 offen offset:2048
    ds_read_b128 a[88:91], v21 offset:4096
    v_mul_f32 v181, v153, v188
    v_mfma_f32_16x16x32_bf16 v[212:215], a[60:63], v[32:35], 0
    ds_read_b128 a[92:95], v21 offset:5120
    v_mul_f32 v182, v154, v188
    v_mfma_f32_16x16x32_bf16 v[240:243], a[60:63], v[36:39], 0
    v_mul_f32 v183, v155, v188
    v_fma_f32 v192, v192, v189, v180
    v_mfma_f32_16x16x32_bf16 v[216:219], a[64:67], v[32:35], 0
    v_fma_f32 v193, v193, v189, v181
    v_fma_f32 v194, v194, v189, v182
    v_mfma_f32_16x16x32_bf16 v[244:247], a[64:67], v[36:39], 0
    s_mov_b32 s76, 163840
    buffer_load_dwordx4 a[192:195], v31, s[20:23], s76 offen offset:3072
    v_fma_f32 v195, v195, v189, v183
    v_mul_f32 v180, v192, v192
    s_waitcnt lgkmcnt(0)
    v_mfma_f32_16x16x32_bf16 v[208:211], a[84:87], v[40:43], v[208:211]
    ds_read_b128 a[56:59], v21 offset:6144
    v_mul_f32 v181, v193, v193
    v_mfma_f32_16x16x32_bf16 v[236:239], a[84:87], v[44:47], v[236:239]
    ds_read_b128 a[60:63], v21 offset:7168
    v_mul_f32 v182, v194, v194
    v_mfma_f32_16x16x32_bf16 v[212:215], a[88:91], v[40:43], v[212:215]
    ds_read_b128 a[64:67], v21 offset:8192
    v_mul_f32 v183, v195, v195
    v_mfma_f32_16x16x32_bf16 v[240:243], a[88:91], v[44:47], v[240:243]
    s_mov_b32 s76, 167936
    buffer_load_dwordx4 a[196:199], v31, s[20:23], s76 offen offset:0
    v_fma_f32 v180, v180, s58, v28
    v_fma_f32 v181, v181, s58, v28
    v_mfma_f32_16x16x32_bf16 v[216:219], a[92:95], v[40:43], v[216:219]
    v_fma_f32 v182, v182, s58, v28
    v_fma_f32 v183, v183, s58, v28
    v_mfma_f32_16x16x32_bf16 v[244:247], a[92:95], v[44:47], v[244:247]
    v_mul_f32 v180, v180, v192
    v_mul_f32 v181, v181, v193
    s_waitcnt lgkmcnt(0)
    v_mfma_f32_16x16x32_bf16 v[208:211], a[56:59], v[48:51], v[208:211]
    ds_read_b128 a[84:87], v21 offset:9216
    v_mul_f32 v182, v182, v194
    s_mov_b32 s76, 204800
    buffer_load_dwordx4 a[200:203], v31, s[20:23], s76 offen offset:0
    v_mfma_f32_16x16x32_bf16 v[236:239], a[56:59], v[52:55], v[236:239]
    ds_read_b128 a[88:91], v21 offset:10240
    v_mul_f32 v183, v183, v195
    v_mfma_f32_16x16x32_bf16 v[212:215], a[60:63], v[48:51], v[212:215]
    ds_read_b128 a[92:95], v21 offset:11264
    v_exp_f32 v180, v180
    v_mfma_f32_16x16x32_bf16 v[240:243], a[60:63], v[52:55], v[240:243]
    v_exp_f32 v181, v181
    v_exp_f32 v182, v182
    s_mov_b32 s76, 204800
    buffer_load_dwordx4 a[204:207], v31, s[20:23], s76 offen offset:1024
    v_mfma_f32_16x16x32_bf16 v[216:219], a[64:67], v[48:51], v[216:219]
    v_exp_f32 v183, v183
    v_add_f32 v180, 1.0, v180
    v_mfma_f32_16x16x32_bf16 v[244:247], a[64:67], v[52:55], v[244:247]
    v_add_f32 v181, 1.0, v181
    v_add_f32 v182, 1.0, v182
    s_waitcnt lgkmcnt(0)
    v_mfma_f32_16x16x32_bf16 v[208:211], a[84:87], v[56:59], v[208:211]
    ds_read_b128 a[56:59], v21 offset:12288
    v_add_f32 v183, 1.0, v183
    v_mfma_f32_16x16x32_bf16 v[236:239], a[84:87], v[60:63], v[236:239]
    s_mov_b32 s76, 204800
    buffer_load_dwordx4 a[208:211], v31, s[20:23], s76 offen offset:2048
    ds_read_b128 a[60:63], v21 offset:13312
    v_rcp_f32 v180, v180
    v_mfma_f32_16x16x32_bf16 v[212:215], a[88:91], v[56:59], v[212:215]
    ds_read_b128 a[64:67], v21 offset:14336
    v_rcp_f32 v181, v181
    v_mfma_f32_16x16x32_bf16 v[240:243], a[88:91], v[60:63], v[240:243]
    v_rcp_f32 v182, v182
    v_rcp_f32 v183, v183
    v_mfma_f32_16x16x32_bf16 v[216:219], a[92:95], v[56:59], v[216:219]
    s_mov_b32 s76, 204800
    buffer_load_dwordx4 a[212:215], v31, s[20:23], s76 offen offset:3072
    v_mul_f32 v192, v192, v180
    v_mul_f32 v193, v193, v181
    v_mfma_f32_16x16x32_bf16 v[244:247], a[92:95], v[60:63], v[244:247]
    v_mul_f32 v194, v194, v182
    v_mul_f32 v195, v195, v183
    s_waitcnt lgkmcnt(0)
    v_mfma_f32_16x16x32_bf16 v[208:211], a[56:59], v[64:67], v[208:211]
    ds_read_b128 a[84:87], v21 offset:15360
    v_cvt_pk_bf16_f32 v192, v192, v193
    v_mfma_f32_16x16x32_bf16 v[236:239], a[56:59], v[68:71], v[236:239]
    ds_read_b128 a[88:91], v21 offset:16384
    v_cvt_pk_bf16_f32 v193, v194, v195
    v_mfma_f32_16x16x32_bf16 v[212:215], a[60:63], v[64:67], v[212:215]
    s_mov_b32 s76, 208896
    buffer_load_dwordx4 a[216:219], v31, s[20:23], s76 offen offset:0
    ds_read_b128 a[92:95], v21 offset:17408
    v_mul_f32 v180, v156, v188
    v_mfma_f32_16x16x32_bf16 v[240:243], a[60:63], v[68:71], v[240:243]
    v_mul_f32 v181, v157, v188
    v_mul_f32 v182, v158, v188
    v_mfma_f32_16x16x32_bf16 v[216:219], a[64:67], v[64:67], v[216:219]
    v_mul_f32 v183, v159, v188
    v_fma_f32 v196, v196, v189, v180
    v_mfma_f32_16x16x32_bf16 v[244:247], a[64:67], v[68:71], v[244:247]
    v_fma_f32 v197, v197, v189, v181
    v_fma_f32 v198, v198, v189, v182
    s_waitcnt lgkmcnt(0)
    v_mfma_f32_16x16x32_bf16 v[208:211], a[84:87], v[72:75], v[208:211]
    ds_read_b128 a[56:59], v21 offset:18432
    v_fma_f32 v199, v199, v189, v183
    v_mfma_f32_16x16x32_bf16 v[236:239], a[84:87], v[76:79], v[236:239]
    ds_read_b128 a[60:63], v21 offset:19456
    v_mul_f32 v180, v196, v196
    v_mfma_f32_16x16x32_bf16 v[212:215], a[88:91], v[72:75], v[212:215]
    ds_read_b128 a[64:67], v21 offset:20480
    v_mul_f32 v181, v197, v197
    v_mfma_f32_16x16x32_bf16 v[240:243], a[88:91], v[76:79], v[240:243]
    v_mul_f32 v182, v198, v198
    v_mul_f32 v183, v199, v199
    v_mfma_f32_16x16x32_bf16 v[216:219], a[92:95], v[72:75], v[216:219]
    v_fma_f32 v180, v180, s58, v28
    v_fma_f32 v181, v181, s58, v28
    v_mfma_f32_16x16x32_bf16 v[244:247], a[92:95], v[76:79], v[244:247]
    v_fma_f32 v182, v182, s58, v28
    v_fma_f32 v183, v183, s58, v28
    s_waitcnt lgkmcnt(0)
    v_mfma_f32_16x16x32_bf16 v[208:211], a[56:59], v[80:83], v[208:211]
    ds_read_b128 a[84:87], v21 offset:21504
    v_mul_f32 v180, v180, v196
    v_mfma_f32_16x16x32_bf16 v[236:239], a[56:59], v[84:87], v[236:239]
    ds_read_b128 a[88:91], v21 offset:22528
    v_mul_f32 v181, v181, v197
    v_mfma_f32_16x16x32_bf16 v[212:215], a[60:63], v[80:83], v[212:215]
    ds_read_b128 a[92:95], v21 offset:23552
    v_mul_f32 v182, v182, v198
    v_mfma_f32_16x16x32_bf16 v[240:243], a[60:63], v[84:87], v[240:243]
    v_mul_f32 v183, v183, v199
    v_exp_f32 v180, v180
    v_mfma_f32_16x16x32_bf16 v[216:219], a[64:67], v[80:83], v[216:219]
    v_exp_f32 v181, v181
    v_exp_f32 v182, v182
    v_mfma_f32_16x16x32_bf16 v[244:247], a[64:67], v[84:87], v[244:247]
    v_exp_f32 v183, v183
    v_add_f32 v180, 1.0, v180
    s_waitcnt lgkmcnt(0)
    v_mfma_f32_16x16x32_bf16 v[208:211], a[84:87], v[88:91], v[208:211]
    ds_read_b128 a[56:59], v21 offset:24576
    v_add_f32 v181, 1.0, v181
    v_mfma_f32_16x16x32_bf16 v[236:239], a[84:87], v[92:95], v[236:239]
    ds_read_b128 a[60:63], v21 offset:25600
    v_add_f32 v182, 1.0, v182
    v_mfma_f32_16x16x32_bf16 v[212:215], a[88:91], v[88:91], v[212:215]
    ds_read_b128 a[64:67], v21 offset:26624
    v_add_f32 v183, 1.0, v183
    v_mfma_f32_16x16x32_bf16 v[240:243], a[88:91], v[92:95], v[240:243]
    v_rcp_f32 v180, v180
    v_rcp_f32 v181, v181
    v_mfma_f32_16x16x32_bf16 v[216:219], a[92:95], v[88:91], v[216:219]
    v_rcp_f32 v182, v182
    v_rcp_f32 v183, v183
    v_mfma_f32_16x16x32_bf16 v[244:247], a[92:95], v[92:95], v[244:247]
    v_mul_f32 v196, v196, v180
    v_mul_f32 v197, v197, v181
    s_waitcnt lgkmcnt(0)
    v_mfma_f32_16x16x32_bf16 v[208:211], a[56:59], v[96:99], v[208:211]
    ds_read_b128 a[84:87], v21 offset:27648
    v_mul_f32 v198, v198, v182
    v_mfma_f32_16x16x32_bf16 v[236:239], a[56:59], v[100:103], v[236:239]
    ds_read_b128 a[88:91], v21 offset:28672
    v_mul_f32 v199, v199, v183
    v_mfma_f32_16x16x32_bf16 v[212:215], a[60:63], v[96:99], v[212:215]
    ds_read_b128 a[92:95], v21 offset:29696
    v_cvt_pk_bf16_f32 v194, v196, v197
    v_mfma_f32_16x16x32_bf16 v[240:243], a[60:63], v[100:103], v[240:243]
    v_cvt_pk_bf16_f32 v195, v198, v199
    v_permlane16_swap_b32 v192, v194
    v_mfma_f32_16x16x32_bf16 v[216:219], a[64:67], v[96:99], v[216:219]
    v_permlane16_swap_b32 v193, v195
    buffer_store_dwordx4 v[192:195], v22, s[12:15], 0 offen offset:0 sc1
    v_mfma_f32_16x16x32_bf16 v[244:247], a[64:67], v[100:103], v[244:247]
    v_mul_f32 v180, v160, v188
    v_mul_f32 v181, v161, v188
    s_waitcnt lgkmcnt(0)
    v_mfma_f32_16x16x32_bf16 v[208:211], a[84:87], v[104:107], v[208:211]
    ds_read_b128 a[56:59], v21 offset:30720
    v_mul_f32 v182, v162, v188
    v_mfma_f32_16x16x32_bf16 v[236:239], a[84:87], v[108:111], v[236:239]
    ds_read_b128 a[60:63], v21 offset:31744
    v_mul_f32 v183, v163, v188
    v_mfma_f32_16x16x32_bf16 v[212:215], a[88:91], v[104:107], v[212:215]
    ds_read_b128 a[64:67], v21 offset:32768
    v_fma_f32 v200, v200, v189, v180
    v_mfma_f32_16x16x32_bf16 v[240:243], a[88:91], v[108:111], v[240:243]
    v_fma_f32 v201, v201, v189, v181
    v_fma_f32 v202, v202, v189, v182
    v_mfma_f32_16x16x32_bf16 v[216:219], a[92:95], v[104:107], v[216:219]
    v_fma_f32 v203, v203, v189, v183
    v_mul_f32 v180, v200, v200
    v_mfma_f32_16x16x32_bf16 v[244:247], a[92:95], v[108:111], v[244:247]
    v_mul_f32 v181, v201, v201
    v_mul_f32 v182, v202, v202
    s_waitcnt lgkmcnt(0)
    v_mfma_f32_16x16x32_bf16 v[208:211], a[56:59], v[112:115], v[208:211]
    ds_read_b128 a[84:87], v21 offset:33792
    v_mul_f32 v183, v203, v203
    v_mfma_f32_16x16x32_bf16 v[236:239], a[56:59], v[116:119], v[236:239]
    ds_read_b128 a[88:91], v21 offset:34816
    v_fma_f32 v180, v180, s58, v28
    v_mfma_f32_16x16x32_bf16 v[212:215], a[60:63], v[112:115], v[212:215]
    ds_read_b128 a[92:95], v21 offset:35840
    v_fma_f32 v181, v181, s58, v28
    v_mfma_f32_16x16x32_bf16 v[240:243], a[60:63], v[116:119], v[240:243]
    v_fma_f32 v182, v182, s58, v28
    v_fma_f32 v183, v183, s58, v28
    v_mfma_f32_16x16x32_bf16 v[216:219], a[64:67], v[112:115], v[216:219]
    v_mul_f32 v180, v180, v200
    v_mul_f32 v181, v181, v201
    v_mfma_f32_16x16x32_bf16 v[244:247], a[64:67], v[116:119], v[244:247]
    v_mul_f32 v182, v182, v202
    v_mul_f32 v183, v183, v203
    s_waitcnt lgkmcnt(0)
    v_mfma_f32_16x16x32_bf16 v[208:211], a[84:87], v[120:123], v[208:211]
    ds_read_b128 a[56:59], v21 offset:36864
    v_exp_f32 v180, v180
    v_mfma_f32_16x16x32_bf16 v[236:239], a[84:87], v[124:127], v[236:239]
    ds_read_b128 a[60:63], v21 offset:37888
    v_exp_f32 v181, v181
    v_mfma_f32_16x16x32_bf16 v[212:215], a[88:91], v[120:123], v[212:215]
    ds_read_b128 a[64:67], v21 offset:38912
    v_exp_f32 v182, v182
    v_mfma_f32_16x16x32_bf16 v[240:243], a[88:91], v[124:127], v[240:243]
    v_exp_f32 v183, v183
    v_add_f32 v180, 1.0, v180
    v_mfma_f32_16x16x32_bf16 v[216:219], a[92:95], v[120:123], v[216:219]
    v_add_f32 v181, 1.0, v181
    v_add_f32 v182, 1.0, v182
    v_mfma_f32_16x16x32_bf16 v[244:247], a[92:95], v[124:127], v[244:247]
    v_add_f32 v183, 1.0, v183
    v_rcp_f32 v180, v180
    s_waitcnt lgkmcnt(0)
    v_mfma_f32_16x16x32_bf16 v[208:211], a[56:59], v[128:131], v[208:211]
    ds_read_b128 a[84:87], v21 offset:39936
    v_rcp_f32 v181, v181
    v_mfma_f32_16x16x32_bf16 v[236:239], a[56:59], v[132:135], v[236:239]
    ds_read_b128 a[88:91], v21 offset:40960
    v_rcp_f32 v182, v182
    v_mfma_f32_16x16x32_bf16 v[212:215], a[60:63], v[128:131], v[212:215]
    ds_read_b128 a[92:95], v21 offset:41984
    v_rcp_f32 v183, v183
    v_mfma_f32_16x16x32_bf16 v[240:243], a[60:63], v[132:135], v[240:243]
    v_mul_f32 v200, v200, v180
    v_mul_f32 v201, v201, v181
    v_mfma_f32_16x16x32_bf16 v[216:219], a[64:67], v[128:131], v[216:219]
    v_mul_f32 v202, v202, v182
    v_mul_f32 v203, v203, v183
    v_mfma_f32_16x16x32_bf16 v[244:247], a[64:67], v[132:135], v[244:247]
    v_cvt_pk_bf16_f32 v200, v200, v201
    v_cvt_pk_bf16_f32 v201, v202, v203
    s_waitcnt lgkmcnt(0)
    v_mfma_f32_16x16x32_bf16 v[208:211], a[84:87], v[136:139], v[208:211]
    ds_read_b128 a[56:59], v21 offset:43008
    v_mul_f32 v180, v164, v188
    v_mfma_f32_16x16x32_bf16 v[236:239], a[84:87], v[140:143], v[236:239]
    ds_read_b128 a[60:63], v21 offset:44032
    v_mul_f32 v181, v165, v188
    v_mfma_f32_16x16x32_bf16 v[212:215], a[88:91], v[136:139], v[212:215]
    ds_read_b128 a[64:67], v21 offset:45056
    v_mul_f32 v182, v166, v188
    v_mfma_f32_16x16x32_bf16 v[240:243], a[88:91], v[140:143], v[240:243]
    v_mul_f32 v183, v167, v188
    v_fma_f32 v204, v204, v189, v180
    v_mfma_f32_16x16x32_bf16 v[216:219], a[92:95], v[136:139], v[216:219]
    v_fma_f32 v205, v205, v189, v181
    v_fma_f32 v206, v206, v189, v182
    v_mfma_f32_16x16x32_bf16 v[244:247], a[92:95], v[140:143], v[244:247]
    v_fma_f32 v207, v207, v189, v183
    v_mul_f32 v180, v204, v204
    s_waitcnt lgkmcnt(0)
    v_mfma_f32_16x16x32_bf16 v[208:211], a[56:59], v[144:147], v[208:211]
    ds_read_b128 a[84:87], v21 offset:46080
    v_mul_f32 v181, v205, v205
    v_mfma_f32_16x16x32_bf16 v[236:239], a[56:59], v[148:151], v[236:239]
    ds_read_b128 a[88:91], v21 offset:47104
    v_mul_f32 v182, v206, v206
    v_mfma_f32_16x16x32_bf16 v[212:215], a[60:63], v[144:147], v[212:215]
    ds_read_b128 a[92:95], v21 offset:48128
    v_mul_f32 v183, v207, v207
    v_mfma_f32_16x16x32_bf16 v[240:243], a[60:63], v[148:151], v[240:243]
    v_fma_f32 v180, v180, s58, v28
    v_fma_f32 v181, v181, s58, v28
    v_mfma_f32_16x16x32_bf16 v[216:219], a[64:67], v[144:147], v[216:219]
    v_fma_f32 v182, v182, s58, v28
    v_fma_f32 v183, v183, s58, v28
    v_mfma_f32_16x16x32_bf16 v[244:247], a[64:67], v[148:151], v[244:247]
    v_mul_f32 v180, v180, v204
    v_mul_f32 v181, v181, v205
    s_waitcnt lgkmcnt(0)
    v_mfma_f32_16x16x32_bf16 v[208:211], a[84:87], a[0:3], v[208:211]
    ds_read_b128 a[56:59], v21 offset:49152
    v_mul_f32 v182, v182, v206
    v_mfma_f32_16x16x32_bf16 v[236:239], a[84:87], a[4:7], v[236:239]
    ds_read_b128 a[60:63], v21 offset:50176
    v_mul_f32 v183, v183, v207
    v_mfma_f32_16x16x32_bf16 v[212:215], a[88:91], a[0:3], v[212:215]
    ds_read_b128 a[64:67], v21 offset:51200
    v_exp_f32 v180, v180
    v_mfma_f32_16x16x32_bf16 v[240:243], a[88:91], a[4:7], v[240:243]
    v_exp_f32 v181, v181
    v_exp_f32 v182, v182
    v_mfma_f32_16x16x32_bf16 v[216:219], a[92:95], a[0:3], v[216:219]
    v_exp_f32 v183, v183
    v_add_f32 v180, 1.0, v180
    v_mfma_f32_16x16x32_bf16 v[244:247], a[92:95], a[4:7], v[244:247]
    v_add_f32 v181, 1.0, v181
    v_add_f32 v182, 1.0, v182
    s_waitcnt lgkmcnt(0)
    v_mfma_f32_16x16x32_bf16 v[208:211], a[56:59], a[8:11], v[208:211]
    ds_read_b128 a[84:87], v21 offset:52224
    v_add_f32 v183, 1.0, v183
    v_mfma_f32_16x16x32_bf16 v[236:239], a[56:59], a[12:15], v[236:239]
    ds_read_b128 a[88:91], v21 offset:53248
    v_rcp_f32 v180, v180
    v_mfma_f32_16x16x32_bf16 v[212:215], a[60:63], a[8:11], v[212:215]
    ds_read_b128 a[92:95], v21 offset:54272
    v_rcp_f32 v181, v181
    v_mfma_f32_16x16x32_bf16 v[240:243], a[60:63], a[12:15], v[240:243]
    v_rcp_f32 v182, v182
    v_rcp_f32 v183, v183
    v_mfma_f32_16x16x32_bf16 v[216:219], a[64:67], a[8:11], v[216:219]
    v_mul_f32 v204, v204, v180
    v_mul_f32 v205, v205, v181
    v_mfma_f32_16x16x32_bf16 v[244:247], a[64:67], a[12:15], v[244:247]
    v_mul_f32 v206, v206, v182
    v_mul_f32 v207, v207, v183
    s_waitcnt lgkmcnt(0)
    v_mfma_f32_16x16x32_bf16 v[208:211], a[84:87], a[16:19], v[208:211]
    ds_read_b128 a[56:59], v21 offset:55296
    v_cvt_pk_bf16_f32 v202, v204, v205
    v_mfma_f32_16x16x32_bf16 v[236:239], a[84:87], a[20:23], v[236:239]
    ds_read_b128 a[60:63], v21 offset:56320
    v_cvt_pk_bf16_f32 v203, v206, v207
    v_mfma_f32_16x16x32_bf16 v[212:215], a[88:91], a[16:19], v[212:215]
    ds_read_b128 a[64:67], v21 offset:57344
    v_permlane16_swap_b32 v200, v202
    v_mfma_f32_16x16x32_bf16 v[240:243], a[88:91], a[20:23], v[240:243]
    v_permlane16_swap_b32 v201, v203
    buffer_store_dwordx4 v[200:203], v22, s[12:15], 0 offen offset:1024 sc1
    v_mfma_f32_16x16x32_bf16 v[216:219], a[92:95], a[16:19], v[216:219]
    v_mul_f32 v180, v152, v190
    v_mul_f32 v181, v153, v190
    v_mfma_f32_16x16x32_bf16 v[244:247], a[92:95], a[20:23], v[244:247]
    v_mul_f32 v182, v154, v190
    v_mul_f32 v183, v155, v190
    s_waitcnt lgkmcnt(0)
    v_mfma_f32_16x16x32_bf16 v[208:211], a[56:59], a[24:27], v[208:211]
    ds_read_b128 a[84:87], v21 offset:58368
    v_fma_f32 v220, v220, v191, v180
    v_mfma_f32_16x16x32_bf16 v[236:239], a[56:59], a[28:31], v[236:239]
    ds_read_b128 a[88:91], v21 offset:59392
    v_fma_f32 v221, v221, v191, v181
    v_mfma_f32_16x16x32_bf16 v[212:215], a[60:63], a[24:27], v[212:215]
    ds_read_b128 a[92:95], v21 offset:60416
    v_fma_f32 v222, v222, v191, v182
    v_mfma_f32_16x16x32_bf16 v[240:243], a[60:63], a[28:31], v[240:243]
    v_fma_f32 v223, v223, v191, v183
    v_mul_f32 v180, v220, v220
    v_mfma_f32_16x16x32_bf16 v[216:219], a[64:67], a[24:27], v[216:219]
    v_mul_f32 v181, v221, v221
    v_mul_f32 v182, v222, v222
    v_mfma_f32_16x16x32_bf16 v[244:247], a[64:67], a[28:31], v[244:247]
    v_mul_f32 v183, v223, v223
    v_fma_f32 v180, v180, s58, v28
    s_waitcnt lgkmcnt(0)
    v_mfma_f32_16x16x32_bf16 v[208:211], a[84:87], a[32:35], v[208:211]
    v_fma_f32 v181, v181, s58, v28
    v_fma_f32 v182, v182, s58, v28
    v_mfma_f32_16x16x32_bf16 v[236:239], a[84:87], a[36:39], v[236:239]
    v_fma_f32 v183, v183, s58, v28
    v_mul_f32 v180, v180, v220
    v_mfma_f32_16x16x32_bf16 v[212:215], a[88:91], a[32:35], v[212:215]
    v_mul_f32 v181, v181, v221
    v_mul_f32 v182, v182, v222
    v_mfma_f32_16x16x32_bf16 v[240:243], a[88:91], a[36:39], v[240:243]
    v_mul_f32 v183, v183, v223
    v_exp_f32 v180, v180
    v_mfma_f32_16x16x32_bf16 v[216:219], a[92:95], a[32:35], v[216:219]
    v_exp_f32 v181, v181
    v_exp_f32 v182, v182
    v_mfma_f32_16x16x32_bf16 v[244:247], a[92:95], a[36:39], v[244:247]
    v_exp_f32 v183, v183
    v_add_f32 v180, 1.0, v180
    v_add_f32 v181, 1.0, v181
    s_mov_b32 s76, 245760
    buffer_load_dwordx4 a[0:3], v31, s[20:23], s76 offen offset:0
    v_add_f32 v182, 1.0, v182
    v_add_f32 v183, 1.0, v183
    v_rcp_f32 v180, v180
    v_rcp_f32 v181, v181
    v_rcp_f32 v182, v182
    v_rcp_f32 v183, v183
    v_mul_f32 v220, v220, v180
    v_mul_f32 v221, v221, v181
    v_mul_f32 v222, v222, v182
    v_mul_f32 v223, v223, v183
    v_cvt_pk_bf16_f32 v220, v220, v221
    v_cvt_pk_bf16_f32 v221, v222, v223
    v_mul_f32 v180, v156, v190
    v_mul_f32 v181, v157, v190
    v_mul_f32 v182, v158, v190
    v_mul_f32 v183, v159, v190
    s_mov_b32 s76, 245760
    buffer_load_dwordx4 a[4:7], v31, s[20:23], s76 offen offset:1024
    v_fma_f32 v224, v224, v191, v180
    v_fma_f32 v225, v225, v191, v181
    v_fma_f32 v226, v226, v191, v182
    v_fma_f32 v227, v227, v191, v183
    v_mul_f32 v180, v224, v224
    v_mul_f32 v181, v225, v225
    v_mul_f32 v182, v226, v226
    v_mul_f32 v183, v227, v227
    v_fma_f32 v180, v180, s58, v28
    v_fma_f32 v181, v181, s58, v28
    v_fma_f32 v182, v182, s58, v28
    v_fma_f32 v183, v183, s58, v28
    v_mul_f32 v180, v180, v224
    v_mul_f32 v181, v181, v225
    v_mul_f32 v182, v182, v226
    v_mul_f32 v183, v183, v227
    v_exp_f32 v180, v180
    v_exp_f32 v181, v181
    s_mov_b32 s76, 245760
    buffer_load_dwordx4 a[8:11], v31, s[20:23], s76 offen offset:2048
    v_exp_f32 v182, v182
    v_exp_f32 v183, v183
    v_add_f32 v180, 1.0, v180
    v_add_f32 v181, 1.0, v181
    v_add_f32 v182, 1.0, v182
    v_add_f32 v183, 1.0, v183
    v_rcp_f32 v180, v180
    v_rcp_f32 v181, v181
    v_rcp_f32 v182, v182
    v_rcp_f32 v183, v183
    v_mul_f32 v224, v224, v180
    v_mul_f32 v225, v225, v181
    v_mul_f32 v226, v226, v182
    v_mul_f32 v227, v227, v183
    s_mov_b32 s76, 245760
    buffer_load_dwordx4 a[12:15], v31, s[20:23], s76 offen offset:3072
    v_cvt_pk_bf16_f32 v222, v224, v225
    v_cvt_pk_bf16_f32 v223, v226, v227
    s_nop 0
    v_permlane16_swap_b32 v220, v222
    v_permlane16_swap_b32 v221, v223
    buffer_store_dwordx4 v[220:223], v22, s[12:15], s65 offen offset:0 sc1
    v_mul_f32 v180, v160, v190
    v_mul_f32 v181, v161, v190
    v_mul_f32 v182, v162, v190
    v_mul_f32 v183, v163, v190
    v_fma_f32 v228, v228, v191, v180
    v_fma_f32 v229, v229, v191, v181
    v_fma_f32 v230, v230, v191, v182
    v_fma_f32 v231, v231, v191, v183
    v_mul_f32 v180, v228, v228
    v_mul_f32 v181, v229, v229
    v_mul_f32 v182, v230, v230
    v_mul_f32 v183, v231, v231
    v_fma_f32 v180, v180, s58, v28
    v_fma_f32 v181, v181, s58, v28
    v_fma_f32 v182, v182, s58, v28
    v_fma_f32 v183, v183, s58, v28
    s_mov_b32 s76, 249856
    buffer_load_dwordx4 a[16:19], v31, s[20:23], s76 offen offset:0
    v_mul_f32 v180, v180, v228
    v_mul_f32 v181, v181, v229
    v_mul_f32 v182, v182, v230
    v_mul_f32 v183, v183, v231
    v_exp_f32 v180, v180
    v_exp_f32 v181, v181
    v_exp_f32 v182, v182
    v_exp_f32 v183, v183
    v_add_f32 v180, 1.0, v180
    v_add_f32 v181, 1.0, v181
    v_add_f32 v182, 1.0, v182
    v_add_f32 v183, 1.0, v183
    v_rcp_f32 v180, v180
    v_rcp_f32 v181, v181
    s_mov_b32 s76, 286720
    buffer_load_dwordx4 a[20:23], v31, s[20:23], s76 offen offset:0
    v_rcp_f32 v182, v182
    v_rcp_f32 v183, v183
    v_mul_f32 v228, v228, v180
    v_mul_f32 v229, v229, v181
    v_mul_f32 v230, v230, v182
    v_mul_f32 v231, v231, v183
    v_cvt_pk_bf16_f32 v228, v228, v229
    v_cvt_pk_bf16_f32 v229, v230, v231
    v_mul_f32 v180, v164, v190
    v_mul_f32 v181, v165, v190
    v_mul_f32 v182, v166, v190
    v_mul_f32 v183, v167, v190
    v_fma_f32 v232, v232, v191, v180
    v_fma_f32 v233, v233, v191, v181
    v_fma_f32 v234, v234, v191, v182
    v_fma_f32 v235, v235, v191, v183
    v_mul_f32 v180, v232, v232
    v_mul_f32 v181, v233, v233
    s_mov_b32 s76, 286720
    buffer_load_dwordx4 a[24:27], v31, s[20:23], s76 offen offset:1024
    v_mul_f32 v182, v234, v234
    v_mul_f32 v183, v235, v235
    v_fma_f32 v180, v180, s58, v28
    v_fma_f32 v181, v181, s58, v28
    v_fma_f32 v182, v182, s58, v28
    v_fma_f32 v183, v183, s58, v28
    v_mul_f32 v180, v180, v232
    v_mul_f32 v181, v181, v233
    v_mul_f32 v182, v182, v234
    v_mul_f32 v183, v183, v235
    v_exp_f32 v180, v180
    v_exp_f32 v181, v181
    v_exp_f32 v182, v182
    v_exp_f32 v183, v183
    v_add_f32 v180, 1.0, v180
    v_add_f32 v181, 1.0, v181
    s_mov_b32 s76, 286720
    buffer_load_dwordx4 a[28:31], v31, s[20:23], s76 offen offset:2048
    v_add_f32 v182, 1.0, v182
    v_add_f32 v183, 1.0, v183
    v_rcp_f32 v180, v180
    v_rcp_f32 v181, v181
    v_rcp_f32 v182, v182
    v_rcp_f32 v183, v183
    v_mul_f32 v232, v232, v180
    v_mul_f32 v233, v233, v181
    v_mul_f32 v234, v234, v182
    v_mul_f32 v235, v235, v183
    v_cvt_pk_bf16_f32 v230, v232, v233
    v_cvt_pk_bf16_f32 v231, v234, v235
    s_nop 0
    v_permlane16_swap_b32 v228, v230
    v_permlane16_swap_b32 v229, v231
    buffer_store_dwordx4 v[228:231], v22, s[12:15], s65 offen offset:1024 sc1
    v_mul_f32 v180, v168, v188
    v_mul_f32 v181, v169, v188
    s_mov_b32 s76, 286720
    buffer_load_dwordx4 a[32:35], v31, s[20:23], s76 offen offset:3072
    v_mul_f32 v182, v170, v188
    v_mul_f32 v183, v171, v188
    v_fma_f32 v208, v208, v189, v180
    v_fma_f32 v209, v209, v189, v181
    v_fma_f32 v210, v210, v189, v182
    v_fma_f32 v211, v211, v189, v183
    v_mul_f32 v180, v208, v208
    v_mul_f32 v181, v209, v209
    v_mul_f32 v182, v210, v210
    v_mul_f32 v183, v211, v211
    v_fma_f32 v180, v180, s58, v28
    v_fma_f32 v181, v181, s58, v28
    v_fma_f32 v182, v182, s58, v28
    v_fma_f32 v183, v183, s58, v28
    v_mul_f32 v180, v180, v208
    v_mul_f32 v181, v181, v209
    v_mul_f32 v182, v182, v210
    v_mul_f32 v183, v183, v211
    v_exp_f32 v180, v180
    s_mov_b32 s76, 290816
    buffer_load_dwordx4 a[36:39], v31, s[20:23], s76 offen offset:0
    v_exp_f32 v181, v181
    v_exp_f32 v182, v182
    v_exp_f32 v183, v183
    v_add_f32 v180, 1.0, v180
    v_add_f32 v181, 1.0, v181
    v_add_f32 v182, 1.0, v182
    v_add_f32 v183, 1.0, v183
    v_rcp_f32 v180, v180
    v_rcp_f32 v181, v181
    v_rcp_f32 v182, v182
    v_rcp_f32 v183, v183
    v_mul_f32 v208, v208, v180
    v_mul_f32 v209, v209, v181
    s_mov_b32 s76, 327680
    buffer_load_dwordx4 a[40:43], v31, s[20:23], s76 offen offset:0
    v_mul_f32 v210, v210, v182
    v_mul_f32 v211, v211, v183
    v_cvt_pk_bf16_f32 v208, v208, v209
    v_cvt_pk_bf16_f32 v209, v210, v211
    v_mul_f32 v180, v172, v188
    v_mul_f32 v181, v173, v188
    v_mul_f32 v182, v174, v188
    v_mul_f32 v183, v175, v188
    v_fma_f32 v212, v212, v189, v180
    v_fma_f32 v213, v213, v189, v181
    v_fma_f32 v214, v214, v189, v182
    v_fma_f32 v215, v215, v189, v183
    v_mul_f32 v180, v212, v212
    v_mul_f32 v181, v213, v213
    v_mul_f32 v182, v214, v214
    v_mul_f32 v183, v215, v215
    v_fma_f32 v180, v180, s58, v28
    v_fma_f32 v181, v181, s58, v28
    v_fma_f32 v182, v182, s58, v28
    v_fma_f32 v183, v183, s58, v28
    s_mov_b32 s76, 327680
    buffer_load_dwordx4 a[44:47], v31, s[20:23], s76 offen offset:1024
    v_mul_f32 v180, v180, v212
    v_mul_f32 v181, v181, v213
    v_mul_f32 v182, v182, v214
    v_mul_f32 v183, v183, v215
    v_exp_f32 v180, v180
    v_exp_f32 v181, v181
    v_exp_f32 v182, v182
    v_exp_f32 v183, v183
    v_add_f32 v180, 1.0, v180
    v_add_f32 v181, 1.0, v181
    v_add_f32 v182, 1.0, v182
    v_add_f32 v183, 1.0, v183
    v_rcp_f32 v180, v180
    v_rcp_f32 v181, v181
    s_mov_b32 s76, 327680
    buffer_load_dwordx4 a[48:51], v31, s[20:23], s76 offen offset:2048
    v_rcp_f32 v182, v182
    v_rcp_f32 v183, v183
    v_mul_f32 v212, v212, v180
    v_mul_f32 v213, v213, v181
    v_mul_f32 v214, v214, v182
    v_mul_f32 v215, v215, v183
    v_cvt_pk_bf16_f32 v210, v212, v213
    v_cvt_pk_bf16_f32 v211, v214, v215
    s_nop 0
    v_permlane16_swap_b32 v208, v210
    v_permlane16_swap_b32 v209, v211
    buffer_store_dwordx4 v[208:211], v22, s[12:15], 0 offen offset:2048 sc1
    v_mul_f32 v180, v176, v188
    v_mul_f32 v181, v177, v188
    v_mul_f32 v182, v178, v188
    v_mul_f32 v183, v179, v188
    v_fma_f32 v216, v216, v189, v180
    v_fma_f32 v217, v217, v189, v181
    v_fma_f32 v218, v218, v189, v182
    v_fma_f32 v219, v219, v189, v183
    s_mov_b32 s76, 327680
    buffer_load_dwordx4 a[52:55], v31, s[20:23], s76 offen offset:3072
    v_mul_f32 v180, v216, v216
    v_mul_f32 v181, v217, v217
    v_mul_f32 v182, v218, v218
    v_mul_f32 v183, v219, v219
    v_fma_f32 v180, v180, s58, v28
    v_fma_f32 v181, v181, s58, v28
    v_fma_f32 v182, v182, s58, v28
    v_fma_f32 v183, v183, s58, v28
    v_mul_f32 v180, v180, v216
    v_mul_f32 v181, v181, v217
    v_mul_f32 v182, v182, v218
    v_mul_f32 v183, v183, v219
    v_exp_f32 v180, v180
    v_exp_f32 v181, v181
    v_exp_f32 v182, v182
    v_exp_f32 v183, v183
    s_mov_b32 s76, 331776
    buffer_load_dwordx4 a[56:59], v31, s[20:23], s76 offen offset:0
    v_add_f32 v180, 1.0, v180
    v_add_f32 v181, 1.0, v181
    v_add_f32 v182, 1.0, v182
    v_add_f32 v183, 1.0, v183
    v_rcp_f32 v180, v180
    v_rcp_f32 v181, v181
    v_rcp_f32 v182, v182
    v_rcp_f32 v183, v183
    v_mul_f32 v216, v216, v180
    v_mul_f32 v217, v217, v181
    v_mul_f32 v218, v218, v182
    v_mul_f32 v219, v219, v183
    v_cvt_pk_bf16_f32 v216, v216, v217
    v_cvt_pk_bf16_f32 v217, v218, v219
    buffer_store_dwordx2 v[216:217], v23, s[12:15], 0 offen offset:3072 sc1
    v_mul_f32 v180, v168, v190
    v_mul_f32 v181, v169, v190
    s_mov_b32 s76, 368640
    buffer_load_dwordx4 a[60:63], v31, s[20:23], s76 offen offset:0
    v_mul_f32 v182, v170, v190
    v_mul_f32 v183, v171, v190
    v_fma_f32 v236, v236, v191, v180
    v_fma_f32 v237, v237, v191, v181
    v_fma_f32 v238, v238, v191, v182
    v_fma_f32 v239, v239, v191, v183
    v_mul_f32 v180, v236, v236
    v_mul_f32 v181, v237, v237
    v_mul_f32 v182, v238, v238
    v_mul_f32 v183, v239, v239
    v_fma_f32 v180, v180, s58, v28
    v_fma_f32 v181, v181, s58, v28
    v_fma_f32 v182, v182, s58, v28
    v_fma_f32 v183, v183, s58, v28
    v_mul_f32 v180, v180, v236
    v_mul_f32 v181, v181, v237
    v_mul_f32 v182, v182, v238
    v_mul_f32 v183, v183, v239
    v_exp_f32 v180, v180
    s_mov_b32 s76, 368640
    buffer_load_dwordx4 a[64:67], v31, s[20:23], s76 offen offset:1024
    v_exp_f32 v181, v181
    v_exp_f32 v182, v182
    v_exp_f32 v183, v183
    v_add_f32 v180, 1.0, v180
    v_add_f32 v181, 1.0, v181
    v_add_f32 v182, 1.0, v182
    v_add_f32 v183, 1.0, v183
    v_rcp_f32 v180, v180
    v_rcp_f32 v181, v181
    v_rcp_f32 v182, v182
    v_rcp_f32 v183, v183
    v_mul_f32 v236, v236, v180
    v_mul_f32 v237, v237, v181
    s_mov_b32 s76, 368640
    buffer_load_dwordx4 a[68:71], v31, s[20:23], s76 offen offset:2048
    v_mul_f32 v238, v238, v182
    v_mul_f32 v239, v239, v183
    v_cvt_pk_bf16_f32 v236, v236, v237
    v_cvt_pk_bf16_f32 v237, v238, v239
    v_mul_f32 v180, v172, v190
    v_mul_f32 v181, v173, v190
    v_mul_f32 v182, v174, v190
    v_mul_f32 v183, v175, v190
    v_fma_f32 v240, v240, v191, v180
    v_fma_f32 v241, v241, v191, v181
    v_fma_f32 v242, v242, v191, v182
    v_fma_f32 v243, v243, v191, v183
    v_mul_f32 v180, v240, v240
    v_mul_f32 v181, v241, v241
    v_mul_f32 v182, v242, v242
    v_mul_f32 v183, v243, v243
    v_fma_f32 v180, v180, s58, v28
    v_fma_f32 v181, v181, s58, v28
    v_fma_f32 v182, v182, s58, v28
    v_fma_f32 v183, v183, s58, v28
    s_mov_b32 s76, 368640
    buffer_load_dwordx4 a[72:75], v31, s[20:23], s76 offen offset:3072
    v_mul_f32 v180, v180, v240
    v_mul_f32 v181, v181, v241
    v_mul_f32 v182, v182, v242
    v_mul_f32 v183, v183, v243
    v_exp_f32 v180, v180
    v_exp_f32 v181, v181
    v_exp_f32 v182, v182
    v_exp_f32 v183, v183
    v_add_f32 v180, 1.0, v180
    v_add_f32 v181, 1.0, v181
    v_add_f32 v182, 1.0, v182
    v_add_f32 v183, 1.0, v183
    v_rcp_f32 v180, v180
    v_rcp_f32 v181, v181
    s_mov_b32 s76, 372736
    buffer_load_dwordx4 a[76:79], v31, s[20:23], s76 offen offset:0
    v_rcp_f32 v182, v182
    v_rcp_f32 v183, v183
    v_mul_f32 v240, v240, v180
    v_mul_f32 v241, v241, v181
    v_mul_f32 v242, v242, v182
    v_mul_f32 v243, v243, v183
    v_cvt_pk_bf16_f32 v238, v240, v241
    v_cvt_pk_bf16_f32 v239, v242, v243
    s_nop 0
    v_permlane16_swap_b32 v236, v238
    v_permlane16_swap_b32 v237, v239
    buffer_store_dwordx4 v[236:239], v22, s[12:15], s65 offen offset:2048 sc1
    v_mul_f32 v180, v176, v190
    v_mul_f32 v181, v177, v190
    v_mul_f32 v182, v178, v190
    v_mul_f32 v183, v179, v190
    v_fma_f32 v244, v244, v191, v180
    v_fma_f32 v245, v245, v191, v181
    v_fma_f32 v246, v246, v191, v182
    v_fma_f32 v247, v247, v191, v183
    s_mov_b32 s76, 409600
    buffer_load_dwordx4 a[80:83], v31, s[20:23], s76 offen offset:0
    v_mul_f32 v180, v244, v244
    v_mul_f32 v181, v245, v245
    v_mul_f32 v182, v246, v246
    v_mul_f32 v183, v247, v247
    v_fma_f32 v180, v180, s58, v28
    v_fma_f32 v181, v181, s58, v28
    v_fma_f32 v182, v182, s58, v28
    v_fma_f32 v183, v183, s58, v28
    v_mul_f32 v180, v180, v244
    v_mul_f32 v181, v181, v245
    v_mul_f32 v182, v182, v246
    v_mul_f32 v183, v183, v247
    v_exp_f32 v180, v180
    v_exp_f32 v181, v181
    v_exp_f32 v182, v182
    v_exp_f32 v183, v183
    s_mov_b32 s76, 409600
    buffer_load_dwordx4 a[84:87], v31, s[20:23], s76 offen offset:1024
    v_add_f32 v180, 1.0, v180
    v_add_f32 v181, 1.0, v181
    v_add_f32 v182, 1.0, v182
    v_add_f32 v183, 1.0, v183
    v_rcp_f32 v180, v180
    v_rcp_f32 v181, v181
    v_rcp_f32 v182, v182
    v_rcp_f32 v183, v183
    v_mul_f32 v244, v244, v180
    v_mul_f32 v245, v245, v181
    v_mul_f32 v246, v246, v182
    v_mul_f32 v247, v247, v183
    v_cvt_pk_bf16_f32 v244, v244, v245
    v_cvt_pk_bf16_f32 v245, v246, v247
    buffer_store_dwordx2 v[244:245], v23, s[12:15], s65 offen offset:3072 sc1
    s_lshl_b32 s48, s43, 4
    s_add_u32 s48, s48, s44
    s_lshl_b32 s48, s48, 2
    s_add_u32 s48, s48, 18222080
    v_mov_b32 v6, s48
    v_mov_b32 v7, 1
    s_mov_b32 s76, 409600
    buffer_load_dwordx4 a[88:91], v31, s[20:23], s76 offen offset:2048
    s_waitcnt vmcnt(1)
    s_barrier
    s_cmp_lg_u32 s42, 0
    s_cbranch_scc1 KP_PUB3
    s_mov_b64 exec, 1
    buffer_store_dword v7, v6, s[12:15], 0 offen sc1
    s_mov_b64 exec, -1
KP_PUB3:
    s_lshr_b32 s48, s40, 1
    s_lshl_b32 s48, s48, 6
    s_add_u32 s48, s48, 18222080
    v_lshl_add_u32 v16, v2, 2, s48
    s_mul_i32 s48, s40, 221184
    s_lshl_b32 s49, s68, 10
    s_add_u32 s48, s48, s49
    s_add_u32 s48, s48, 10485760
    v_add_u32 v17, s48, v1
    s_add_u32 s48, s42, 0
    s_and_b32 s48, s48, 3
    s_mul_i32 s50, s48, 55296
    s_add_u32 s48, s42, 1
    s_and_b32 s48, s48, 3
    s_mul_i32 s51, s48, 55296
    s_add_u32 s48, s42, 2
    s_and_b32 s48, s48, 3
    s_mul_i32 s52, s48, 55296
    s_add_u32 s48, s42, 3
    s_and_b32 s48, s48, 3
    s_mul_i32 s53, s48, 55296
    s_lshl_b32 s48, s40, 6
    s_lshl_b32 s49, s42, 4
    s_add_u32 s48, s48, s49
    v_add_u32 v6, s48, v2
    v_mul_u32_u24 v6, 1280, v6
    s_mul_i32 s48, s41, 160
    v_add_u32 v6, s48, v6
    v_and_b32 v7, 1, v3
    v_lshrrev_b32 v18, 1, v3
    v_lshl_add_u32 v19, v7, 1, v18
    v_lshl_add_u32 v19, v19, 4, v6
    v_lshlrev_b32 v18, 4, v18
    v_lshl_add_u32 v18, v7, 3, v18
    v_add_u32 v18, v18, v6
    v_mul_u32_u24 v6, 27, v2
    v_lshrrev_b32 v6, 2, v6
    s_lshl_b32 s48, s68, 1
    s_add_u32 s49, s48, 28
    s_sub_u32 s48, s48, 7
    v_cmp_gt_u32 vcc, s49, v6
    s_nop 1
    s_mov_b64 s[80:81], vcc
    v_cmp_lt_i32 vcc, s48, v6
    s_nop 1
    s_and_b64 vcc, vcc, s[80:81]
    s_ff1_i32_b64 s48, vcc
    v_readlane_b32 s48, v16, s48
    s_nop 1
    v_mov_b32 v6, s48
    v_cndmask_b32 v16, v6, v16, vcc
    v_accvgpr_read_b32 v6, a232
    s_mov_b32 s76, 409600
    buffer_load_dwordx4 a[92:95], v31, s[20:23], s76 offen offset:3072
    v_accvgpr_read_b32 v7, a242
    v_lshlrev_b32 v224, 16, v6
    v_and_b32 v225, 0xffff0000, v6
    v_lshlrev_b32 v244, 16, v7
    v_and_b32 v245, 0xffff0000, v7
    v_pk_add_f32 v[224:225], v[224:225], v[244:245]
    v_accvgpr_read_b32 v6, a233
    v_accvgpr_read_b32 v7, a243
    v_lshlrev_b32 v226, 16, v6
    v_and_b32 v227, 0xffff0000, v6
    v_lshlrev_b32 v244, 16, v7
    v_and_b32 v245, 0xffff0000, v7
    v_pk_add_f32 v[226:227], v[226:227], v[244:245]
    v_accvgpr_read_b32 v6, a234
    v_accvgpr_read_b32 v7, a244
    v_lshlrev_b32 v228, 16, v6
    v_and_b32 v229, 0xffff0000, v6
    v_lshlrev_b32 v244, 16, v7
    s_mov_b32 s76, 413696
    buffer_load_dwordx4 a[96:99], v31, s[20:23], s76 offen offset:0
    v_and_b32 v245, 0xffff0000, v7
    v_pk_add_f32 v[228:229], v[228:229], v[244:245]
    v_accvgpr_read_b32 v6, a235
    v_accvgpr_read_b32 v7, a245
    v_lshlrev_b32 v230, 16, v6
    v_and_b32 v231, 0xffff0000, v6
    v_lshlrev_b32 v244, 16, v7
    v_and_b32 v245, 0xffff0000, v7
    v_pk_add_f32 v[230:231], v[230:231], v[244:245]
    v_accvgpr_read_b32 v6, a236
    v_accvgpr_read_b32 v7, a246
    v_lshlrev_b32 v232, 16, v6
    v_and_b32 v233, 0xffff0000, v6
    v_lshlrev_b32 v244, 16, v7
    v_and_b32 v245, 0xffff0000, v7
    v_pk_add_f32 v[232:233], v[232:233], v[244:245]
    v_accvgpr_read_b32 v6, a237
    v_accvgpr_read_b32 v7, a247
    v_lshlrev_b32 v234, 16, v6
    v_and_b32 v235, 0xffff0000, v6
    v_lshlrev_b32 v244, 16, v7
    v_and_b32 v245, 0xffff0000, v7
    v_pk_add_f32 v[234:235], v[234:235], v[244:245]
    v_accvgpr_read_b32 v6, a238
    v_accvgpr_read_b32 v7, a248
    v_lshlrev_b32 v236, 16, v6
    v_and_b32 v237, 0xffff0000, v6
    v_lshlrev_b32 v244, 16, v7
    v_and_b32 v245, 0xffff0000, v7
    v_pk_add_f32 v[236:237], v[236:237], v[244:245]
    v_accvgpr_read_b32 v6, a239
    v_accvgpr_read_b32 v7, a249
    v_lshlrev_b32 v238, 16, v6
    v_and_b32 v239, 0xffff0000, v6
    v_lshlrev_b32 v244, 16, v7
    v_and_b32 v245, 0xffff0000, v7
    v_pk_add_f32 v[238:239], v[238:239], v[244:245]
    v_accvgpr_read_b32 v6, a240
    v_accvgpr_read_b32 v7, a250
    v_lshlrev_b32 v240, 16, v6
    v_and_b32 v241, 0xffff0000, v6
    v_lshlrev_b32 v244, 16, v7
    v_and_b32 v245, 0xffff0000, v7
    v_pk_add_f32 v[240:241], v[240:241], v[244:245]
    v_accvgpr_read_b32 v6, a241
    v_accvgpr_read_b32 v7, a251
    v_lshlrev_b32 v242, 16, v6
    v_and_b32 v243, 0xffff0000, v6
    v_lshlrev_b32 v244, 16, v7
    v_and_b32 v245, 0xffff0000, v7
    v_pk_add_f32 v[242:243], v[242:243], v[244:245]
    s_mov_b32 s54, 0
    s_nop 3
KP_POLL3:
    buffer_load_dword v7, v16, s[12:15], 0 offen sc1
    s_waitcnt vmcnt(0)
    v_cmp_eq_u32 vcc, 0, v7
    s_nop 1
    s_cmp_eq_u64 vcc, 0
    s_cbranch_scc1 KP_GO3
    s_sleep 1
    s_add_u32 s54, s54, 1
    s_cmp_lt_u32 s54, 0x80000
    s_cbranch_scc1 KP_POLL3
    s_nop 1
KP_GO3:
    s_add_u32 s48, s51, 0
    buffer_load_dwordx4 v[36:39], v17, s[12:15], s48 offen offset:0 sc1
    s_add_u32 s48, s52, 0
    buffer_load_dwordx4 v[40:43], v17, s[12:15], s48 offen offset:0 sc1
    s_add_u32 s48, s53, 0
    buffer_load_dwordx4 v[44:47], v17, s[12:15], s48 offen offset:0 sc1
    s_add_u32 s48, s50, 0
    buffer_load_dwordx4 v[32:35], v17, s[12:15], s48 offen offset:0 sc1
    s_add_u32 s48, s51, 0
    buffer_load_dwordx4 v[52:55], v17, s[12:15], s48 offen offset:1024 sc1
    s_add_u32 s48, s52, 0
    buffer_load_dwordx4 v[56:59], v17, s[12:15], s48 offen offset:1024 sc1
    s_add_u32 s48, s53, 0
    buffer_load_dwordx4 v[60:63], v17, s[12:15], s48 offen offset:1024 sc1
    s_add_u32 s48, s50, 0
    buffer_load_dwordx4 v[48:51], v17, s[12:15], s48 offen offset:1024 sc1
    s_add_u32 s48, s51, 0
    buffer_load_dwordx4 v[68:71], v17, s[12:15], s48 offen offset:2048 sc1
    s_add_u32 s48, s52, 0
    buffer_load_dwordx4 v[72:75], v17, s[12:15], s48 offen offset:2048 sc1
    s_add_u32 s48, s53, 0
    buffer_load_dwordx4 v[76:79], v17, s[12:15], s48 offen offset:2048 sc1
    s_add_u32 s48, s50, 0
    buffer_load_dwordx4 v[64:67], v17, s[12:15], s48 offen offset:2048 sc1
    s_add_u32 s48, s51, 0
    buffer_load_dwordx4 v[84:87], v17, s[12:15], s48 offen offset:3072 sc1
    s_add_u32 s48, s52, 0
    buffer_load_dwordx4 v[88:91], v17, s[12:15], s48 offen offset:3072 sc1
    s_add_u32 s48, s53, 0
    buffer_load_dwordx4 v[92:95], v17, s[12:15], s48 offen offset:3072 sc1
    s_add_u32 s48, s50, 0
    buffer_load_dwordx4 v[80:83], v17, s[12:15], s48 offen offset:3072 sc1
    s_add_u32 s48, s51, 4096
    buffer_load_dwordx4 v[100:103], v17, s[12:15], s48 offen offset:0 sc1
    s_add_u32 s48, s52, 4096
    buffer_load_dwordx4 v[104:107], v17, s[12:15], s48 offen offset:0 sc1
    s_add_u32 s48, s53, 4096
    buffer_load_dwordx4 v[108:111], v17, s[12:15], s48 offen offset:0 sc1
    s_add_u32 s48, s50, 4096
    buffer_load_dwordx4 v[96:99], v17, s[12:15], s48 offen offset:0 sc1
    s_waitcnt vmcnt(16)
    v_mfma_f32_16x16x32_bf16 v[132:135], a[100:103], v[36:39], 0
    v_mfma_f32_16x16x32_bf16 v[136:139], a[104:107], v[36:39], 0
    s_add_u32 s48, s51, 4096
    buffer_load_dwordx4 v[196:199], v17, s[12:15], s48 offen offset:1024 sc1
    v_mfma_f32_16x16x32_bf16 v[140:143], a[108:111], v[36:39], 0
    v_mfma_f32_16x16x32_bf16 v[144:147], a[112:115], v[36:39], 0
    s_add_u32 s48, s52, 4096
    buffer_load_dwordx4 v[200:203], v17, s[12:15], s48 offen offset:1024 sc1
    v_mfma_f32_16x16x32_bf16 v[148:151], a[116:119], v[36:39], 0
    v_mfma_f32_16x16x32_bf16 v[152:155], a[100:103], v[40:43], 0
    s_add_u32 s48, s53, 4096
    buffer_load_dwordx4 v[204:207], v17, s[12:15], s48 offen offset:1024 sc1
    v_mfma_f32_16x16x32_bf16 v[156:159], a[104:107], v[40:43], 0
    v_mfma_f32_16x16x32_bf16 v[160:163], a[108:111], v[40:43], 0
    s_add_u32 s48, s50, 4096
    buffer_load_dwordx4 v[192:195], v17, s[12:15], s48 offen offset:1024 sc1
    v_mfma_f32_16x16x32_bf16 v[164:167], a[112:115], v[40:43], 0
    v_mfma_f32_16x16x32_bf16 v[168:171], a[116:119], v[40:43], 0
    s_add_u32 s48, s51, 4096
    buffer_load_dwordx4 v[212:215], v17, s[12:15], s48 offen offset:2048 sc1
    v_mfma_f32_16x16x32_bf16 v[172:175], a[100:103], v[44:47], 0
    v_mfma_f32_16x16x32_bf16 v[176:179], a[104:107], v[44:47], 0
    s_add_u32 s48, s52, 4096
    buffer_load_dwordx4 v[216:219], v17, s[12:15], s48 offen offset:2048 sc1
    v_mfma_f32_16x16x32_bf16 v[180:183], a[108:111], v[44:47], 0
    v_mfma_f32_16x16x32_bf16 v[184:187], a[112:115], v[44:47], 0
    s_add_u32 s48, s53, 4096
    buffer_load_dwordx4 v[220:223], v17, s[12:15], s48 offen offset:2048 sc1
    v_mfma_f32_16x16x32_bf16 v[188:191], a[116:119], v[44:47], 0
    v_mfma_f32_16x16x32_bf16 v[112:115], a[100:103], v[32:35], 0
    s_add_u32 s48, s50, 4096
    buffer_load_dwordx4 v[208:211], v17, s[12:15], s48 offen offset:2048 sc1
    v_mfma_f32_16x16x32_bf16 v[116:119], a[104:107], v[32:35], 0
    v_mfma_f32_16x16x32_bf16 v[120:123], a[108:111], v[32:35], 0
    v_mfma_f32_16x16x32_bf16 v[124:127], a[112:115], v[32:35], 0
    v_mfma_f32_16x16x32_bf16 v[128:131], a[116:119], v[32:35], 0
    s_waitcnt vmcnt(20)
    v_mfma_f32_16x16x32_bf16 v[132:135], a[120:123], v[52:55], v[132:135]
    v_mfma_f32_16x16x32_bf16 v[136:139], a[124:127], v[52:55], v[136:139]
    s_add_u32 s48, s51, 4096
    buffer_load_dwordx4 v[36:39], v17, s[12:15], s48 offen offset:3072 sc1
    v_mfma_f32_16x16x32_bf16 v[140:143], a[128:131], v[52:55], v[140:143]
    v_mfma_f32_16x16x32_bf16 v[144:147], a[132:135], v[52:55], v[144:147]
    s_add_u32 s48, s52, 4096
    buffer_load_dwordx4 v[40:43], v17, s[12:15], s48 offen offset:3072 sc1
    v_mfma_f32_16x16x32_bf16 v[148:151], a[136:139], v[52:55], v[148:151]
    v_mfma_f32_16x16x32_bf16 v[152:155], a[120:123], v[56:59], v[152:155]
    s_add_u32 s48, s53, 4096
    buffer_load_dwordx4 v[44:47], v17, s[12:15], s48 offen offset:3072 sc1
    v_mfma_f32_16x16x32_bf16 v[156:159], a[124:127], v[56:59], v[156:159]
    v_mfma_f32_16x16x32_bf16 v[160:163], a[128:131], v[56:59], v[160:163]
    s_add_u32 s48, s50, 4096
    buffer_load_dwordx4 v[32:35], v17, s[12:15], s48 offen offset:3072 sc1
    v_mfma_f32_16x16x32_bf16 v[164:167], a[132:135], v[56:59], v[164:167]
    v_mfma_f32_16x16x32_bf16 v[168:171], a[136:139], v[56:59], v[168:171]
    s_mov_b32 s76, 450560
    buffer_load_dwordx4 a[100:103], v31, s[20:23], s76 offen offset:0
    v_mfma_f32_16x16x32_bf16 v[172:175], a[120:123], v[60:63], v[172:175]
    v_mfma_f32_16x16x32_bf16 v[176:179], a[124:127], v[60:63], v[176:179]
    s_mov_b32 s76, 450560
    buffer_load_dwordx4 a[104:107], v31, s[20:23], s76 offen offset:1024
    v_mfma_f32_16x16x32_bf16 v[180:183], a[128:131], v[60:63], v[180:183]
    v_mfma_f32_16x16x32_bf16 v[184:187], a[132:135], v[60:63], v[184:187]
    s_mov_b32 s76, 450560
    buffer_load_dwordx4 a[108:111], v31, s[20:23], s76 offen offset:2048
    v_mfma_f32_16x16x32_bf16 v[188:191], a[136:139], v[60:63], v[188:191]
    v_mfma_f32_16x16x32_bf16 v[112:115], a[120:123], v[48:51], v[112:115]
    s_mov_b32 s76, 450560
    buffer_load_dwordx4 a[112:115], v31, s[20:23], s76 offen offset:3072
    v_mfma_f32_16x16x32_bf16 v[116:119], a[124:127], v[48:51], v[116:119]
    v_mfma_f32_16x16x32_bf16 v[120:123], a[128:131], v[48:51], v[120:123]
    s_mov_b32 s76, 454656
    buffer_load_dwordx4 a[116:119], v31, s[20:23], s76 offen offset:0
    v_mfma_f32_16x16x32_bf16 v[124:127], a[132:135], v[48:51], v[124:127]
    v_mfma_f32_16x16x32_bf16 v[128:131], a[136:139], v[48:51], v[128:131]
    s_waitcnt vmcnt(25)
    v_mfma_f32_16x16x32_bf16 v[132:135], a[140:143], v[68:71], v[132:135]
    v_mfma_f32_16x16x32_bf16 v[136:139], a[144:147], v[68:71], v[136:139]
    s_add_u32 s48, s51, 8192
    buffer_load_dwordx4 v[52:55], v17, s[12:15], s48 offen offset:0 sc1
    v_mfma_f32_16x16x32_bf16 v[140:143], a[148:151], v[68:71], v[140:143]
    v_mfma_f32_16x16x32_bf16 v[144:147], a[152:155], v[68:71], v[144:147]
    s_add_u32 s48, s52, 8192
    buffer_load_dwordx4 v[56:59], v17, s[12:15], s48 offen offset:0 sc1
    v_mfma_f32_16x16x32_bf16 v[148:151], a[156:159], v[68:71], v[148:151]
    v_mfma_f32_16x16x32_bf16 v[152:155], a[140:143], v[72:75], v[152:155]
    s_add_u32 s48, s53, 8192
    buffer_load_dwordx4 v[60:63], v17, s[12:15], s48 offen offset:0 sc1
    v_mfma_f32_16x16x32_bf16 v[156:159], a[144:147], v[72:75], v[156:159]
    v_mfma_f32_16x16x32_bf16 v[160:163], a[148:151], v[72:75], v[160:163]
    s_add_u32 s48, s50, 8192
    buffer_load_dwordx4 v[48:51], v17, s[12:15], s48 offen offset:0 sc1
    v_mfma_f32_16x16x32_bf16 v[164:167], a[152:155], v[72:75], v[164:167]
    v_mfma_f32_16x16x32_bf16 v[168:171], a[156:159], v[72:75], v[168:171]
    s_mov_b32 s76, 491520
    buffer_load_dwordx4 a[120:123], v31, s[20:23], s76 offen offset:0
    v_mfma_f32_16x16x32_bf16 v[172:175], a[140:143], v[76:79], v[172:175]
    v_mfma_f32_16x16x32_bf16 v[176:179], a[144:147], v[76:79], v[176:179]
    s_mov_b32 s76, 491520
    buffer_load_dwordx4 a[124:127], v31, s[20:23], s76 offen offset:1024
    v_mfma_f32_16x16x32_bf16 v[180:183], a[148:151], v[76:79], v[180:183]
    v_mfma_f32_16x16x32_bf16 v[184:187], a[152:155], v[76:79], v[184:187]
    s_mov_b32 s76, 491520
    buffer_load_dwordx4 a[128:131], v31, s[20:23], s76 offen offset:2048
    v_mfma_f32_16x16x32_bf16 v[188:191], a[156:159], v[76:79], v[188:191]
    v_mfma_f32_16x16x32_bf16 v[112:115], a[140:143], v[64:67], v[112:115]
    s_mov_b32 s76, 491520
    buffer_load_dwordx4 a[132:135], v31, s[20:23], s76 offen offset:3072
    v_mfma_f32_16x16x32_bf16 v[116:119], a[144:147], v[64:67], v[116:119]
    v_mfma_f32_16x16x32_bf16 v[120:123], a[148:151], v[64:67], v[120:123]
    s_mov_b32 s76, 495616
    buffer_load_dwordx4 a[136:139], v31, s[20:23], s76 offen offset:0
    v_mfma_f32_16x16x32_bf16 v[124:127], a[152:155], v[64:67], v[124:127]
    v_mfma_f32_16x16x32_bf16 v[128:131], a[156:159], v[64:67], v[128:131]
    s_waitcnt vmcnt(30)
    v_mfma_f32_16x16x32_bf16 v[132:135], a[160:163], v[84:87], v[132:135]
    v_mfma_f32_16x16x32_bf16 v[136:139], a[164:167], v[84:87], v[136:139]
    s_add_u32 s48, s51, 8192
    buffer_load_dwordx4 v[68:71], v17, s[12:15], s48 offen offset:1024 sc1
    v_mfma_f32_16x16x32_bf16 v[140:143], a[168:171], v[84:87], v[140:143]
    v_mfma_f32_16x16x32_bf16 v[144:147], a[172:175], v[84:87], v[144:147]
    s_add_u32 s48, s52, 8192
    buffer_load_dwordx4 v[72:75], v17, s[12:15], s48 offen offset:1024 sc1
    v_mfma_f32_16x16x32_bf16 v[148:151], a[176:179], v[84:87], v[148:151]
    v_mfma_f32_16x16x32_bf16 v[152:155], a[160:163], v[88:91], v[152:155]
    s_add_u32 s48, s53, 8192
    buffer_load_dwordx4 v[76:79], v17, s[12:15], s48 offen offset:1024 sc1
    v_mfma_f32_16x16x32_bf16 v[156:159], a[164:167], v[88:91], v[156:159]
    v_mfma_f32_16x16x32_bf16 v[160:163], a[168:171], v[88:91], v[160:163]
    s_add_u32 s48, s50, 8192
    buffer_load_dwordx4 v[64:67], v17, s[12:15], s48 offen offset:1024 sc1
    v_mfma_f32_16x16x32_bf16 v[164:167], a[172:175], v[88:91], v[164:167]
    v_mfma_f32_16x16x32_bf16 v[168:171], a[176:179], v[88:91], v[168:171]
    s_add_u32 s76, s69, 532480
    buffer_load_dwordx4 a[140:143], v31, s[20:23], s76 offen offset:0
    v_mfma_f32_16x16x32_bf16 v[172:175], a[160:163], v[92:95], v[172:175]
    v_mfma_f32_16x16x32_bf16 v[176:179], a[164:167], v[92:95], v[176:179]
    s_add_u32 s76, s69, 532480
    buffer_load_dwordx4 a[144:147], v31, s[20:23], s76 offen offset:1024
    v_mfma_f32_16x16x32_bf16 v[180:183], a[168:171], v[92:95], v[180:183]
    v_mfma_f32_16x16x32_bf16 v[184:187], a[172:175], v[92:95], v[184:187]
    s_add_u32 s76, s69, 532480
    buffer_load_dwordx4 a[148:151], v31, s[20:23], s76 offen offset:2048
    v_mfma_f32_16x16x32_bf16 v[188:191], a[176:179], v[92:95], v[188:191]
    v_mfma_f32_16x16x32_bf16 v[112:115], a[160:163], v[80:83], v[112:115]
    s_add_u32 s76, s69, 532480
    buffer_load_dwordx4 a[152:155], v31, s[20:23], s76 offen offset:3072
    v_mfma_f32_16x16x32_bf16 v[116:119], a[164:167], v[80:83], v[116:119]
    v_mfma_f32_16x16x32_bf16 v[120:123], a[168:171], v[80:83], v[120:123]
    s_add_u32 s76, s69, 536576
    buffer_load_dwordx4 a[156:159], v31, s[20:23], s76 offen offset:0
    v_mfma_f32_16x16x32_bf16 v[124:127], a[172:175], v[80:83], v[124:127]
    v_mfma_f32_16x16x32_bf16 v[128:131], a[176:179], v[80:83], v[128:131]
    s_waitcnt vmcnt(35)
    v_mfma_f32_16x16x32_bf16 v[132:135], a[180:183], v[100:103], v[132:135]
    v_mfma_f32_16x16x32_bf16 v[136:139], a[184:187], v[100:103], v[136:139]
    s_add_u32 s48, s51, 8192
    buffer_load_dwordx4 v[84:87], v17, s[12:15], s48 offen offset:2048 sc1
    v_mfma_f32_16x16x32_bf16 v[140:143], a[188:191], v[100:103], v[140:143]
    v_mfma_f32_16x16x32_bf16 v[144:147], a[192:195], v[100:103], v[144:147]
    s_add_u32 s48, s52, 8192
    buffer_load_dwordx4 v[88:91], v17, s[12:15], s48 offen offset:2048 sc1
    v_mfma_f32_16x16x32_bf16 v[148:151], a[196:199], v[100:103], v[148:151]
    v_mfma_f32_16x16x32_bf16 v[152:155], a[180:183], v[104:107], v[152:155]
    s_add_u32 s48, s53, 8192
    buffer_load_dwordx4 v[92:95], v17, s[12:15], s48 offen offset:2048 sc1
    v_mfma_f32_16x16x32_bf16 v[156:159], a[184:187], v[104:107], v[156:159]
    v_mfma_f32_16x16x32_bf16 v[160:163], a[188:191], v[104:107], v[160:163]
    s_add_u32 s48, s50, 8192
    buffer_load_dwordx4 v[80:83], v17, s[12:15], s48 offen offset:2048 sc1
    v_mfma_f32_16x16x32_bf16 v[164:167], a[192:195], v[104:107], v[164:167]
    v_mfma_f32_16x16x32_bf16 v[168:171], a[196:199], v[104:107], v[168:171]
    v_mfma_f32_16x16x32_bf16 v[172:175], a[180:183], v[108:111], v[172:175]
    v_mfma_f32_16x16x32_bf16 v[176:179], a[184:187], v[108:111], v[176:179]
    v_mfma_f32_16x16x32_bf16 v[180:183], a[188:191], v[108:111], v[180:183]
    v_mfma_f32_16x16x32_bf16 v[184:187], a[192:195], v[108:111], v[184:187]
    v_mfma_f32_16x16x32_bf16 v[188:191], a[196:199], v[108:111], v[188:191]
    v_mfma_f32_16x16x32_bf16 v[112:115], a[180:183], v[96:99], v[112:115]
    v_mfma_f32_16x16x32_bf16 v[116:119], a[184:187], v[96:99], v[116:119]
    v_mfma_f32_16x16x32_bf16 v[120:123], a[188:191], v[96:99], v[120:123]
    v_mfma_f32_16x16x32_bf16 v[124:127], a[192:195], v[96:99], v[124:127]
    v_mfma_f32_16x16x32_bf16 v[128:131], a[196:199], v[96:99], v[128:131]
    s_waitcnt vmcnt(35)
    v_mfma_f32_16x16x32_bf16 v[132:135], a[200:203], v[196:199], v[132:135]
    v_mfma_f32_16x16x32_bf16 v[136:139], a[204:207], v[196:199], v[136:139]
    s_add_u32 s48, s51, 8192
    buffer_load_dwordx4 v[100:103], v17, s[12:15], s48 offen offset:3072 sc1
    v_mfma_f32_16x16x32_bf16 v[140:143], a[208:211], v[196:199], v[140:143]
    v_mfma_f32_16x16x32_bf16 v[144:147], a[212:215], v[196:199], v[144:147]
    s_add_u32 s48, s52, 8192
    buffer_load_dwordx4 v[104:107], v17, s[12:15], s48 offen offset:3072 sc1
    v_mfma_f32_16x16x32_bf16 v[148:151], a[216:219], v[196:199], v[148:151]
    v_mfma_f32_16x16x32_bf16 v[152:155], a[200:203], v[200:203], v[152:155]
    s_add_u32 s48, s53, 8192
    buffer_load_dwordx4 v[108:111], v17, s[12:15], s48 offen offset:3072 sc1
    v_mfma_f32_16x16x32_bf16 v[156:159], a[204:207], v[200:203], v[156:159]
    v_mfma_f32_16x16x32_bf16 v[160:163], a[208:211], v[200:203], v[160:163]
    s_add_u32 s48, s50, 8192
    buffer_load_dwordx4 v[96:99], v17, s[12:15], s48 offen offset:3072 sc1
    v_mfma_f32_16x16x32_bf16 v[164:167], a[212:215], v[200:203], v[164:167]
    v_mfma_f32_16x16x32_bf16 v[168:171], a[216:219], v[200:203], v[168:171]
    v_mfma_f32_16x16x32_bf16 v[172:175], a[200:203], v[204:207], v[172:175]
    v_mfma_f32_16x16x32_bf16 v[176:179], a[204:207], v[204:207], v[176:179]
    v_mfma_f32_16x16x32_bf16 v[180:183], a[208:211], v[204:207], v[180:183]
    v_mfma_f32_16x16x32_bf16 v[184:187], a[212:215], v[204:207], v[184:187]
    v_mfma_f32_16x16x32_bf16 v[188:191], a[216:219], v[204:207], v[188:191]
    v_mfma_f32_16x16x32_bf16 v[112:115], a[200:203], v[192:195], v[112:115]
    v_mfma_f32_16x16x32_bf16 v[116:119], a[204:207], v[192:195], v[116:119]
    v_mfma_f32_16x16x32_bf16 v[120:123], a[208:211], v[192:195], v[120:123]
    v_mfma_f32_16x16x32_bf16 v[124:127], a[212:215], v[192:195], v[124:127]
    v_mfma_f32_16x16x32_bf16 v[128:131], a[216:219], v[192:195], v[128:131]
    s_waitcnt vmcnt(35)
    v_mfma_f32_16x16x32_bf16 v[132:135], a[0:3], v[212:215], v[132:135]
    v_mfma_f32_16x16x32_bf16 v[136:139], a[4:7], v[212:215], v[136:139]
    s_add_u32 s48, s51, 12288
    buffer_load_dwordx4 v[196:199], v17, s[12:15], s48 offen offset:0 sc1
    v_mfma_f32_16x16x32_bf16 v[140:143], a[8:11], v[212:215], v[140:143]
    v_mfma_f32_16x16x32_bf16 v[144:147], a[12:15], v[212:215], v[144:147]
    s_add_u32 s48, s52, 12288
    buffer_load_dwordx4 v[200:203], v17, s[12:15], s48 offen offset:0 sc1
    v_mfma_f32_16x16x32_bf16 v[148:151], a[16:19], v[212:215], v[148:151]
    v_mfma_f32_16x16x32_bf16 v[152:155], a[0:3], v[216:219], v[152:155]
    s_add_u32 s48, s53, 12288
    buffer_load_dwordx4 v[204:207], v17, s[12:15], s48 offen offset:0 sc1
    v_mfma_f32_16x16x32_bf16 v[156:159], a[4:7], v[216:219], v[156:159]
    v_mfma_f32_16x16x32_bf16 v[160:163], a[8:11], v[216:219], v[160:163]
    s_add_u32 s48, s50, 12288
    buffer_load_dwordx4 v[192:195], v17, s[12:15], s48 offen offset:0 sc1
    v_mfma_f32_16x16x32_bf16 v[164:167], a[12:15], v[216:219], v[164:167]
    v_mfma_f32_16x16x32_bf16 v[168:171], a[16:19], v[216:219], v[168:171]
    v_mfma_f32_16x16x32_bf16 v[172:175], a[0:3], v[220:223], v[172:175]
    v_mfma_f32_16x16x32_bf16 v[176:179], a[4:7], v[220:223], v[176:179]
    v_mfma_f32_16x16x32_bf16 v[180:183], a[8:11], v[220:223], v[180:183]
    v_mfma_f32_16x16x32_bf16 v[184:187], a[12:15], v[220:223], v[184:187]
    v_mfma_f32_16x16x32_bf16 v[188:191], a[16:19], v[220:223], v[188:191]
    v_mfma_f32_16x16x32_bf16 v[112:115], a[0:3], v[208:211], v[112:115]
    v_mfma_f32_16x16x32_bf16 v[116:119], a[4:7], v[208:211], v[116:119]
    v_mfma_f32_16x16x32_bf16 v[120:123], a[8:11], v[208:211], v[120:123]
    v_mfma_f32_16x16x32_bf16 v[124:127], a[12:15], v[208:211], v[124:127]
    v_mfma_f32_16x16x32_bf16 v[128:131], a[16:19], v[208:211], v[128:131]
    s_waitcnt vmcnt(35)
    v_mfma_f32_16x16x32_bf16 v[132:135], a[20:23], v[36:39], v[132:135]
    v_mfma_f32_16x16x32_bf16 v[136:139], a[24:27], v[36:39], v[136:139]
    s_add_u32 s48, s51, 12288
    s_add_u32 s48, s48, s69
    buffer_load_dwordx4 v[212:215], v17, s[12:15], s48 offen offset:1024 sc1
    v_mfma_f32_16x16x32_bf16 v[140:143], a[28:31], v[36:39], v[140:143]
    v_mfma_f32_16x16x32_bf16 v[144:147], a[32:35], v[36:39], v[144:147]
    s_add_u32 s48, s52, 12288
    s_add_u32 s48, s48, s69
    buffer_load_dwordx4 v[216:219], v17, s[12:15], s48 offen offset:1024 sc1
    v_mfma_f32_16x16x32_bf16 v[148:151], a[36:39], v[36:39], v[148:151]
    v_mfma_f32_16x16x32_bf16 v[152:155], a[20:23], v[40:43], v[152:155]
    s_add_u32 s48, s53, 12288
    s_add_u32 s48, s48, s69
    buffer_load_dwordx4 v[220:223], v17, s[12:15], s48 offen offset:1024 sc1
    v_mfma_f32_16x16x32_bf16 v[156:159], a[24:27], v[40:43], v[156:159]
    v_mfma_f32_16x16x32_bf16 v[160:163], a[28:31], v[40:43], v[160:163]
    s_add_u32 s48, s50, 12288
    s_add_u32 s48, s48, s69
    buffer_load_dwordx4 v[208:211], v17, s[12:15], s48 offen offset:1024 sc1
    v_mfma_f32_16x16x32_bf16 v[164:167], a[32:35], v[40:43], v[164:167]
    v_mfma_f32_16x16x32_bf16 v[168:171], a[36:39], v[40:43], v[168:171]
    v_mfma_f32_16x16x32_bf16 v[172:175], a[20:23], v[44:47], v[172:175]
    v_mfma_f32_16x16x32_bf16 v[176:179], a[24:27], v[44:47], v[176:179]
    v_mfma_f32_16x16x32_bf16 v[180:183], a[28:31], v[44:47], v[180:183]
    v_mfma_f32_16x16x32_bf16 v[184:187], a[32:35], v[44:47], v[184:187]
    v_mfma_f32_16x16x32_bf16 v[188:191], a[36:39], v[44:47], v[188:191]
    v_mfma_f32_16x16x32_bf16 v[112:115], a[20:23], v[32:35], v[112:115]
    v_mfma_f32_16x16x32_bf16 v[116:119], a[24:27], v[32:35], v[116:119]
    v_mfma_f32_16x16x32_bf16 v[120:123], a[28:31], v[32:35], v[120:123]
    v_mfma_f32_16x16x32_bf16 v[124:127], a[32:35], v[32:35], v[124:127]
    v_mfma_f32_16x16x32_bf16 v[128:131], a[36:39], v[32:35], v[128:131]
    s_waitcnt vmcnt(30)
    v_mfma_f32_16x16x32_bf16 v[132:135], a[40:43], v[52:55], v[132:135]
    v_mfma_f32_16x16x32_bf16 v[136:139], a[44:47], v[52:55], v[136:139]
    v_mfma_f32_16x16x32_bf16 v[140:143], a[48:51], v[52:55], v[140:143]
    v_mfma_f32_16x16x32_bf16 v[144:147], a[52:55], v[52:55], v[144:147]
    v_mfma_f32_16x16x32_bf16 v[148:151], a[56:59], v[52:55], v[148:151]
    v_mfma_f32_16x16x32_bf16 v[152:155], a[40:43], v[56:59], v[152:155]
    v_mfma_f32_16x16x32_bf16 v[156:159], a[44:47], v[56:59], v[156:159]
    v_mfma_f32_16x16x32_bf16 v[160:163], a[48:51], v[56:59], v[160:163]
    v_mfma_f32_16x16x32_bf16 v[164:167], a[52:55], v[56:59], v[164:167]
    v_mfma_f32_16x16x32_bf16 v[168:171], a[56:59], v[56:59], v[168:171]
    v_mfma_f32_16x16x32_bf16 v[172:175], a[40:43], v[60:63], v[172:175]
    v_mfma_f32_16x16x32_bf16 v[176:179], a[44:47], v[60:63], v[176:179]
    v_mfma_f32_16x16x32_bf16 v[180:183], a[48:51], v[60:63], v[180:183]
    v_mfma_f32_16x16x32_bf16 v[184:187], a[52:55], v[60:63], v[184:187]
    v_mfma_f32_16x16x32_bf16 v[188:191], a[56:59], v[60:63], v[188:191]
    v_mfma_f32_16x16x32_bf16 v[112:115], a[40:43], v[48:51], v[112:115]
    v_mfma_f32_16x16x32_bf16 v[116:119], a[44:47], v[48:51], v[116:119]
    v_mfma_f32_16x16x32_bf16 v[120:123], a[48:51], v[48:51], v[120:123]
    v_mfma_f32_16x16x32_bf16 v[124:127], a[52:55], v[48:51], v[124:127]
    v_mfma_f32_16x16x32_bf16 v[128:131], a[56:59], v[48:51], v[128:131]
    s_waitcnt vmcnt(21)
    v_mfma_f32_16x16x32_bf16 v[132:135], a[60:63], v[68:71], v[132:135]
    v_mfma_f32_16x16x32_bf16 v[136:139], a[64:67], v[68:71], v[136:139]
    v_mfma_f32_16x16x32_bf16 v[140:143], a[68:71], v[68:71], v[140:143]
    v_mfma_f32_16x16x32_bf16 v[144:147], a[72:75], v[68:71], v[144:147]
    v_mfma_f32_16x16x32_bf16 v[148:151], a[76:79], v[68:71], v[148:151]
    v_mfma_f32_16x16x32_bf16 v[152:155], a[60:63], v[72:75], v[152:155]
    v_mfma_f32_16x16x32_bf16 v[156:159], a[64:67], v[72:75], v[156:159]
    v_mfma_f32_16x16x32_bf16 v[160:163], a[68:71], v[72:75], v[160:163]
    v_mfma_f32_16x16x32_bf16 v[164:167], a[72:75], v[72:75], v[164:167]
    v_mfma_f32_16x16x32_bf16 v[168:171], a[76:79], v[72:75], v[168:171]
    v_mfma_f32_16x16x32_bf16 v[172:175], a[60:63], v[76:79], v[172:175]
    v_mfma_f32_16x16x32_bf16 v[176:179], a[64:67], v[76:79], v[176:179]
    v_mfma_f32_16x16x32_bf16 v[180:183], a[68:71], v[76:79], v[180:183]
    v_mfma_f32_16x16x32_bf16 v[184:187], a[72:75], v[76:79], v[184:187]
    v_mfma_f32_16x16x32_bf16 v[188:191], a[76:79], v[76:79], v[188:191]
    v_mfma_f32_16x16x32_bf16 v[112:115], a[60:63], v[64:67], v[112:115]
    v_mfma_f32_16x16x32_bf16 v[116:119], a[64:67], v[64:67], v[116:119]
    v_mfma_f32_16x16x32_bf16 v[120:123], a[68:71], v[64:67], v[120:123]
    v_mfma_f32_16x16x32_bf16 v[124:127], a[72:75], v[64:67], v[124:127]
    v_mfma_f32_16x16x32_bf16 v[128:131], a[76:79], v[64:67], v[128:131]
    s_waitcnt vmcnt(12)
    v_mfma_f32_16x16x32_bf16 v[132:135], a[80:83], v[84:87], v[132:135]
    v_mfma_f32_16x16x32_bf16 v[136:139], a[84:87], v[84:87], v[136:139]
    v_mfma_f32_16x16x32_bf16 v[140:143], a[88:91], v[84:87], v[140:143]
    v_mfma_f32_16x16x32_bf16 v[144:147], a[92:95], v[84:87], v[144:147]
    v_mfma_f32_16x16x32_bf16 v[148:151], a[96:99], v[84:87], v[148:151]
    v_mfma_f32_16x16x32_bf16 v[152:155], a[80:83], v[88:91], v[152:155]
    v_mfma_f32_16x16x32_bf16 v[156:159], a[84:87], v[88:91], v[156:159]
    v_mfma_f32_16x16x32_bf16 v[160:163], a[88:91], v[88:91], v[160:163]
    v_mfma_f32_16x16x32_bf16 v[164:167], a[92:95], v[88:91], v[164:167]
    v_mfma_f32_16x16x32_bf16 v[168:171], a[96:99], v[88:91], v[168:171]
    v_mfma_f32_16x16x32_bf16 v[172:175], a[80:83], v[92:95], v[172:175]
    v_mfma_f32_16x16x32_bf16 v[176:179], a[84:87], v[92:95], v[176:179]
    v_mfma_f32_16x16x32_bf16 v[180:183], a[88:91], v[92:95], v[180:183]
    v_mfma_f32_16x16x32_bf16 v[184:187], a[92:95], v[92:95], v[184:187]
    v_mfma_f32_16x16x32_bf16 v[188:191], a[96:99], v[92:95], v[188:191]
    v_mfma_f32_16x16x32_bf16 v[112:115], a[80:83], v[80:83], v[112:115]
    v_mfma_f32_16x16x32_bf16 v[116:119], a[84:87], v[80:83], v[116:119]
    v_mfma_f32_16x16x32_bf16 v[120:123], a[88:91], v[80:83], v[120:123]
    v_mfma_f32_16x16x32_bf16 v[124:127], a[92:95], v[80:83], v[124:127]
    v_mfma_f32_16x16x32_bf16 v[128:131], a[96:99], v[80:83], v[128:131]
    s_waitcnt vmcnt(8)
    v_mfma_f32_16x16x32_bf16 v[132:135], a[100:103], v[100:103], v[132:135]
    v_mfma_f32_16x16x32_bf16 v[136:139], a[104:107], v[100:103], v[136:139]
    v_mfma_f32_16x16x32_bf16 v[140:143], a[108:111], v[100:103], v[140:143]
    v_mfma_f32_16x16x32_bf16 v[144:147], a[112:115], v[100:103], v[144:147]
    v_mfma_f32_16x16x32_bf16 v[148:151], a[116:119], v[100:103], v[148:151]
    v_mfma_f32_16x16x32_bf16 v[152:155], a[100:103], v[104:107], v[152:155]
    v_mfma_f32_16x16x32_bf16 v[156:159], a[104:107], v[104:107], v[156:159]
    v_mfma_f32_16x16x32_bf16 v[160:163], a[108:111], v[104:107], v[160:163]
    v_mfma_f32_16x16x32_bf16 v[164:167], a[112:115], v[104:107], v[164:167]
    v_mfma_f32_16x16x32_bf16 v[168:171], a[116:119], v[104:107], v[168:171]
    v_mfma_f32_16x16x32_bf16 v[172:175], a[100:103], v[108:111], v[172:175]
    v_mfma_f32_16x16x32_bf16 v[176:179], a[104:107], v[108:111], v[176:179]
    v_mfma_f32_16x16x32_bf16 v[180:183], a[108:111], v[108:111], v[180:183]
    v_mfma_f32_16x16x32_bf16 v[184:187], a[112:115], v[108:111], v[184:187]
    v_mfma_f32_16x16x32_bf16 v[188:191], a[116:119], v[108:111], v[188:191]
    v_mfma_f32_16x16x32_bf16 v[112:115], a[100:103], v[96:99], v[112:115]
    v_mfma_f32_16x16x32_bf16 v[116:119], a[104:107], v[96:99], v[116:119]
    v_mfma_f32_16x16x32_bf16 v[120:123], a[108:111], v[96:99], v[120:123]
    v_mfma_f32_16x16x32_bf16 v[124:127], a[112:115], v[96:99], v[124:127]
    v_mfma_f32_16x16x32_bf16 v[128:131], a[116:119], v[96:99], v[128:131]
    s_waitcnt vmcnt(0)
    v_mfma_f32_16x16x32_bf16 v[132:135], a[120:123], v[196:199], v[132:135]
    v_mfma_f32_16x16x32_bf16 v[136:139], a[124:127], v[196:199], v[136:139]
    v_mfma_f32_16x16x32_bf16 v[140:143], a[128:131], v[196:199], v[140:143]
    v_mfma_f32_16x16x32_bf16 v[144:147], a[132:135], v[196:199], v[144:147]
    v_mfma_f32_16x16x32_bf16 v[148:151], a[136:139], v[196:199], v[148:151]
    v_mfma_f32_16x16x32_bf16 v[132:135], a[140:143], v[212:215], v[132:135]
    v_mfma_f32_16x16x32_bf16 v[136:139], a[144:147], v[212:215], v[136:139]
    v_mfma_f32_16x16x32_bf16 v[140:143], a[148:151], v[212:215], v[140:143]
    v_mfma_f32_16x16x32_bf16 v[144:147], a[152:155], v[212:215], v[144:147]
    v_mfma_f32_16x16x32_bf16 v[148:151], a[156:159], v[212:215], v[148:151]
    v_mfma_f32_16x16x32_bf16 v[152:155], a[120:123], v[200:203], v[152:155]
    v_mfma_f32_16x16x32_bf16 v[156:159], a[124:127], v[200:203], v[156:159]
    v_mfma_f32_16x16x32_bf16 v[160:163], a[128:131], v[200:203], v[160:163]
    v_mfma_f32_16x16x32_bf16 v[164:167], a[132:135], v[200:203], v[164:167]
    v_mfma_f32_16x16x32_bf16 v[168:171], a[136:139], v[200:203], v[168:171]
    ds_write_b128 v8, v[132:135] offset:0
    v_mfma_f32_16x16x32_bf16 v[152:155], a[140:143], v[216:219], v[152:155]
    ds_write_b128 v8, v[136:139] offset:1024
    v_mfma_f32_16x16x32_bf16 v[156:159], a[144:147], v[216:219], v[156:159]
    ds_write_b128 v8, v[140:143] offset:2048
    v_mfma_f32_16x16x32_bf16 v[160:163], a[148:151], v[216:219], v[160:163]
    ds_write_b128 v8, v[144:147] offset:3072
    v_mfma_f32_16x16x32_bf16 v[164:167], a[152:155], v[216:219], v[164:167]
    ds_write_b128 v8, v[148:151] offset:4096
    v_mfma_f32_16x16x32_bf16 v[168:171], a[156:159], v[216:219], v[168:171]
    v_mfma_f32_16x16x32_bf16 v[172:175], a[120:123], v[204:207], v[172:175]
    v_mfma_f32_16x16x32_bf16 v[176:179], a[124:127], v[204:207], v[176:179]
    v_mfma_f32_16x16x32_bf16 v[180:183], a[128:131], v[204:207], v[180:183]
    v_mfma_f32_16x16x32_bf16 v[184:187], a[132:135], v[204:207], v[184:187]
    v_mfma_f32_16x16x32_bf16 v[188:191], a[136:139], v[204:207], v[188:191]
    ds_write_b128 v9, v[152:155] offset:0
    v_mfma_f32_16x16x32_bf16 v[172:175], a[140:143], v[220:223], v[172:175]
    ds_write_b128 v9, v[156:159] offset:1024
    v_mfma_f32_16x16x32_bf16 v[176:179], a[144:147], v[220:223], v[176:179]
    ds_write_b128 v9, v[160:163] offset:2048
    v_mfma_f32_16x16x32_bf16 v[180:183], a[148:151], v[220:223], v[180:183]
    ds_write_b128 v9, v[164:167] offset:3072
    v_mfma_f32_16x16x32_bf16 v[184:187], a[152:155], v[220:223], v[184:187]
    ds_write_b128 v9, v[168:171] offset:4096
    v_mfma_f32_16x16x32_bf16 v[188:191], a[156:159], v[220:223], v[188:191]
    v_mfma_f32_16x16x32_bf16 v[112:115], a[120:123], v[192:195], v[112:115]
    v_mfma_f32_16x16x32_bf16 v[116:119], a[124:127], v[192:195], v[116:119]
    v_mfma_f32_16x16x32_bf16 v[120:123], a[128:131], v[192:195], v[120:123]
    v_mfma_f32_16x16x32_bf16 v[124:127], a[132:135], v[192:195], v[124:127]
    v_mfma_f32_16x16x32_bf16 v[128:131], a[136:139], v[192:195], v[128:131]
    ds_write_b128 v10, v[172:175] offset:0
    v_mfma_f32_16x16x32_bf16 v[112:115], a[140:143], v[208:211], v[112:115]
    ds_write_b128 v10, v[176:179] offset:1024
    v_mfma_f32_16x16x32_bf16 v[116:119], a[144:147], v[208:211], v[116:119]
    ds_write_b128 v10, v[180:183] offset:2048
    v_mfma_f32_16x16x32_bf16 v[120:123], a[148:151], v[208:211], v[120:123]
    ds_write_b128 v10, v[184:187] offset:3072
    v_mfma_f32_16x16x32_bf16 v[124:127], a[152:155], v[208:211], v[124:127]
    ds_write_b128 v10, v[188:191] offset:4096
    v_mfma_f32_16x16x32_bf16 v[128:131], a[156:159], v[208:211], v[128:131]
    s_waitcnt lgkmcnt(0)
    s_barrier
    ds_read_b128 v[132:135], v11 offset:0
    ds_read_b128 v[136:139], v11 offset:1024
    ds_read_b128 v[140:143], v11 offset:2048
    ds_read_b128 v[144:147], v11 offset:3072
    ds_read_b128 v[148:151], v11 offset:4096
    ds_read_b128 v[152:155], v11 offset:5120
    ds_read_b128 v[156:159], v11 offset:6144
    ds_read_b128 v[160:163], v11 offset:7168
    ds_read_b128 v[164:167], v11 offset:8192
    ds_read_b128 v[168:171], v11 offset:9216
    ds_read_b128 v[172:175], v11 offset:10240
    ds_read_b128 v[176:179], v11 offset:11264
    ds_read_b128 v[180:183], v11 offset:12288
    ds_read_b128 v[184:187], v11 offset:13312
    ds_read_b128 v[188:191], v11 offset:14336
    s_waitcnt lgkmcnt(5)
    v_pk_add_f32 v[112:113], v[112:113], v[132:133]
    v_pk_add_f32 v[112:113], v[112:113], v[152:153]
    v_pk_add_f32 v[114:115], v[114:115], v[134:135]
    v_pk_add_f32 v[114:115], v[114:115], v[154:155]
    v_pk_add_f32 v[116:117], v[116:117], v[136:137]
    v_pk_add_f32 v[116:117], v[116:117], v[156:157]
    v_pk_add_f32 v[118:119], v[118:119], v[138:139]
    v_pk_add_f32 v[118:119], v[118:119], v[158:159]
    v_pk_add_f32 v[120:121], v[120:121], v[140:141]
    v_pk_add_f32 v[120:121], v[120:121], v[160:161]
    v_pk_add_f32 v[122:123], v[122:123], v[142:143]
    v_pk_add_f32 v[122:123], v[122:123], v[162:163]
    v_pk_add_f32 v[124:125], v[124:125], v[144:145]
    v_pk_add_f32 v[124:125], v[124:125], v[164:165]
    v_pk_add_f32 v[126:127], v[126:127], v[146:147]
    v_pk_add_f32 v[126:127], v[126:127], v[166:167]
    v_pk_add_f32 v[128:129], v[128:129], v[148:149]
    v_pk_add_f32 v[128:129], v[128:129], v[168:169]
    v_pk_add_f32 v[130:131], v[130:131], v[150:151]
    v_pk_add_f32 v[130:131], v[130:131], v[170:171]
    s_waitcnt lgkmcnt(0)
    v_pk_add_f32 v[112:113], v[112:113], v[172:173]
    v_pk_add_f32 v[114:115], v[114:115], v[174:175]
    v_pk_add_f32 v[116:117], v[116:117], v[176:177]
    v_pk_add_f32 v[118:119], v[118:119], v[178:179]
    v_pk_add_f32 v[120:121], v[120:121], v[180:181]
    v_pk_add_f32 v[122:123], v[122:123], v[182:183]
    v_pk_add_f32 v[124:125], v[124:125], v[184:185]
    v_pk_add_f32 v[126:127], v[126:127], v[186:187]
    v_pk_add_f32 v[128:129], v[128:129], v[188:189]
    v_pk_add_f32 v[130:131], v[130:131], v[190:191]
    v_pk_add_f32 v[112:113], v[112:113], v[224:225]
    v_pk_add_f32 v[114:115], v[114:115], v[226:227]
    v_cvt_pk_bf16_f32 v192, v112, v113
    v_cvt_pk_bf16_f32 v193, v114, v115
    v_pk_add_f32 v[116:117], v[116:117], v[228:229]
    v_pk_add_f32 v[118:119], v[118:119], v[230:231]
    v_cvt_pk_bf16_f32 v194, v116, v117
    v_cvt_pk_bf16_f32 v195, v118, v119
    v_pk_add_f32 v[120:121], v[120:121], v[232:233]
    v_pk_add_f32 v[122:123], v[122:123], v[234:235]
    v_cvt_pk_bf16_f32 v196, v120, v121
    v_cvt_pk_bf16_f32 v197, v122, v123
    v_pk_add_f32 v[124:125], v[124:125], v[236:237]
    v_pk_add_f32 v[126:127], v[126:127], v[238:239]
    v_cvt_pk_bf16_f32 v198, v124, v125
    v_cvt_pk_bf16_f32 v199, v126, v127
    v_pk_add_f32 v[128:129], v[128:129], v[240:241]
    v_pk_add_f32 v[130:131], v[130:131], v[242:243]
    v_cvt_pk_bf16_f32 v200, v128, v129
    v_cvt_pk_bf16_f32 v201, v130, v131
    v_permlane16_swap_b32 v192, v194
    v_permlane16_swap_b32 v193, v195
    buffer_store_dwordx4 v[192:195], v19, s[28:31], 0 offen offset:0
    v_permlane16_swap_b32 v196, v198
    v_permlane16_swap_b32 v197, v199
    buffer_store_dwordx4 v[196:199], v19, s[28:31], 0 offen offset:64
    buffer_store_dwordx2 v[200:201], v18, s[28:31], 0 offen offset:128
KP_END:
    s_endpgm
.section .rodata,"a"
.p2align 6
.amdhsa_kernel k1_kernel
  .amdhsa_next_free_vgpr 232
  .amdhsa_next_free_sgpr 102
  .amdhsa_accum_offset 168
  .amdhsa_group_segment_fixed_size 0
  .amdhsa_kernarg_size 88
  .amdhsa_user_sgpr_count 2
  .amdhsa_user_sgpr_kernarg_segment_ptr 1
  .amdhsa_system_sgpr_workgroup_id_x 1
.end_amdhsa_kernel
.p2align 6
.amdhsa_kernel kp_kernel
  .amdhsa_next_free_vgpr 512
  .amdhsa_next_free_sgpr 102
  .amdhsa_accum_offset 256
  .amdhsa_group_segment_fixed_size 0
  .amdhsa_kernarg_size 88
  .amdhsa_user_sgpr_count 2
  .amdhsa_user_sgpr_kernarg_segment_ptr 1
  .amdhsa_system_sgpr_workgroup_id_x 1
.end_amdhsa_kernel
```
